```python
import torch

def _softmax(x, axis=-1):
    return torch.softmax(x, dim=axis)
def _gelu(x):
    return torch.nn.functional.gelu(x, approximate="tanh")
def _silu(x):
    return torch.nn.functional.silu(x)
def _sigmoid(x):
    return torch.sigmoid(x)
def _layernorm(x, axis=-1, eps=1e-5):
    m = x.mean(dim=axis, keepdim=True)
    v = x.var(dim=axis, keepdim=True, unbiased=False)
    return (x - m) / torch.sqrt(v + eps)
def _scatter_add(tgt, idx, src, axis=0):
    return tgt.clone().index_add_(axis, idx, src)
def _segment_sum(src, seg, n):
    out = torch.zeros((n,) + src.shape[1:], dtype=src.dtype)
    return out.index_add_(0, seg, src)
def _pad(x, pw):
    flat = tuple(v for pair in reversed(pw) for v in pair)
    return torch.nn.functional.pad(x, flat)

kernel_name = 'gated_mix__ssm_conv_s5__dense_activation_squared_relu__prompt'

def setup_inputs():

    _w = (lambda a: (lambda t: t.to(torch.bfloat16) if t.is_floating_point() else t)(torch.as_tensor(a)))
    def _A_setup():
        B, S, D = 1, 2048, 640
        P = D
        Lambda_re = -0.5 * (lambda _x: torch.exp(torch.as_tensor(_x)))((lambda *s: torch.randn(*s, dtype=torch.bfloat16) * 0.4)(P))
        Lambda_im = (lambda *s: torch.randn(*s, dtype=torch.bfloat16) * 0.8)(P) * 1.0
        B_re = (lambda *s: torch.randn(*s, dtype=torch.bfloat16) * 0.4)(P, D) * (D ** -0.5)
        B_im = (lambda *s: torch.randn(*s, dtype=torch.bfloat16) * 0.8)(P, D) * (D ** -0.5)
        C_re = (lambda *s: torch.randn(*s, dtype=torch.bfloat16) * 0.4)(D, P) * (P ** -0.5)
        C_im = (lambda *s: torch.randn(*s, dtype=torch.bfloat16) * 0.4)(D, P) * (P ** -0.5)
        log_dt = (lambda *s: torch.randn(*s, dtype=torch.bfloat16) * 0.4)(P) * 0.3 - 2.0
        Dskip = (lambda *s: torch.randn(*s, dtype=torch.bfloat16) * 0.1)(D)
        return {
            "x": _w((lambda *s: torch.randn(*s, dtype=torch.bfloat16) * 0.05)(B, S, D)),
            "Lambda_re": _w(Lambda_re),
            "Lambda_im": _w(Lambda_im),
            "B_re": _w(B_re),
            "B_im": _w(B_im),
            "C_re": _w(C_re),
            "C_im": _w(C_im),
            "log_dt": _w(log_dt),
            "Dskip": _w(Dskip),
        }
    _A_in = _A_setup()

    def _B_setup():
        B, S, D, F = 1, 2048, 640, 1728
        return {
            "x": _w((lambda *s: torch.randn(*s, dtype=torch.bfloat16) * 0.05)(B, S, D)),
            "w1": _w((lambda *s: torch.randn(*s, dtype=torch.bfloat16) * 0.05)(D, F)),
            "b1": _w((lambda *s: torch.randn(*s, dtype=torch.bfloat16) * 0.05)(F)),
            "w2": _w((lambda *s: torch.randn(*s, dtype=torch.bfloat16) * 0.05)(F, D)),
            "b2": _w((lambda *s: torch.randn(*s, dtype=torch.bfloat16) * 0.05)(D)),
        }
    _B_in = _B_setup()

    return {
        "A_x": _A_in["x"],
        "A_Lambda_re": _A_in["Lambda_re"],
        "A_Lambda_im": _A_in["Lambda_im"],
        "A_B_re": _A_in["B_re"],
        "A_B_im": _A_in["B_im"],
        "A_C_re": _A_in["C_re"],
        "A_C_im": _A_in["C_im"],
        "A_log_dt": _A_in["log_dt"],
        "A_Dskip": _A_in["Dskip"],
        "B_x": _B_in["x"],
        "B_w1": _B_in["w1"],
        "B_b1": _B_in["b1"],
        "B_w2": _B_in["w2"],
        "B_b2": _B_in["b2"],
        "gate_w": _w((lambda *s: torch.randn(*s, dtype=torch.bfloat16) * 0.05)(640) * 16.0),
    }

def reference(A_x, A_Lambda_re, A_Lambda_im, A_B_re, A_B_im, A_C_re, A_C_im, A_log_dt, A_Dskip, B_x, B_w1, B_b1, B_w2, B_b2, gate_w):
    def _A_ref(x, Lambda_re, Lambda_im, B_re, B_im, C_re, C_im, log_dt, Dskip):
        Bsz, L, H = x.shape
        Lam = Lambda_re + 1j * Lambda_im
        Bmat = B_re + 1j * B_im
        Cmat = C_re + 1j * C_im
        dt = torch.exp(log_dt)
        Lam_bar = torch.exp(dt * Lam)
        B_bar = ((Lam_bar - 1.0) / Lam)[:, None] * Bmat
        Bu = torch.einsum("bld,pd->blp", x + 0j, B_bar)
        h = torch.zeros_like(Bu[:, 0, :])
        hs = []
        for t in range(L):
            h = Lam_bar[None, :] * h + Bu[:, t, :]
            hs.append(h)
        hseq = torch.stack(hs, 1)
        y = 2.0 * torch.einsum("blp,dp->bld", hseq, Cmat).real + x * Dskip[None, None, :]
        return y

    def _B_ref(x, w1, b1, w2, b2):
        h = torch.einsum("bsd,df->bsf", x, w1) + b1
        zero = torch.zeros_like(h)
        r = torch.where(h > zero, h, zero)
        h = r * r
        out = torch.einsum("bsf,fd->bsd", h, w2) + b2
        return out

    x = A_x
    g = _sigmoid((x * gate_w).sum(-1, keepdims=True))
    a = _A_ref(x, A_Lambda_re, A_Lambda_im, A_B_re, A_B_im, A_C_re, A_C_im, A_log_dt, A_Dskip)
    b = _B_ref(x, B_w1, B_b1, B_w2, B_b2)
    return g * a + (1 - g) * b
```

```asm
; @launch grid=(256,1,1) block=(512,1,1) lds=163840
.amdgcn_target "amdgcn-amd-amdhsa--gfx950"
.text
.globl gated_mix__ssm_conv_s5__dense_activation_squared_relu__prompt_kernel
.p2align 8
.type gated_mix__ssm_conv_s5__dense_activation_squared_relu__prompt_kernel,@function
gated_mix__ssm_conv_s5__dense_activation_squared_relu__prompt_kernel:
  s_cmp_ge_u32 s2, 256
  s_cbranch_scc1 L_END
  s_load_dwordx16 s[36:51], s[0:1], 0
  s_load_dwordx16 s[52:67], s[0:1], 64
  s_load_dwordx4 s[68:71], s[0:1], 128
  v_lshrrev_b32 v1, 6, v0
  v_and_b32 v0, 63, v0
  v_readfirstlane_b32 s72, v1
  s_nop 0
  s_and_b32 s82, s72, 6
  s_cmp_eq_u32 s82, 2
  s_cbranch_scc0 L_CPF_done
  s_getpc_b64 s[80:81]
L_CPF_pc:
  s_sub_u32 s80, s80, L_CPF_pc-gated_mix__ssm_conv_s5__dense_activation_squared_relu__prompt_kernel
  s_subb_u32 s81, s81, 0
  v_lshlrev_b32 v10, 7, v0
  s_cmp_eq_u32 s72, 3
  s_cbranch_scc0 L_CPF_w2
  s_lshr_b32 s82, s2, 3
  s_lshl_b32 s82, s82, 11
  v_add_u32 v11, s82, v10
  v_add_u32 v12, L_LOADER-gated_mix__ssm_conv_s5__dense_activation_squared_relu__prompt_kernel-2048, v10
  v_cmp_gt_u32 vcc, 16, v0
  s_nop 1
  v_cndmask_b32 v11, v12, v11, vcc
  v_add_u32 v12, L_CONS_START-gated_mix__ssm_conv_s5__dense_activation_squared_relu__prompt_kernel-6144, v10
  v_cmp_le_u32 vcc, 48, v0
  s_nop 1
  v_cndmask_b32 v11, v11, v12, vcc
  s_branch L_CPF_go
L_CPF_w2:
  v_add_u32 v11, L_CONS_U-gated_mix__ssm_conv_s5__dense_activation_squared_relu__prompt_kernel, v10
  v_add_u32 v12, L_CONS_F-gated_mix__ssm_conv_s5__dense_activation_squared_relu__prompt_kernel-4096, v10
  v_cmp_le_u32 vcc, 32, v0
  s_nop 1
  v_cndmask_b32 v11, v11, v12, vcc
L_CPF_go:
  v_min_u32 v11, L_CODE_END-gated_mix__ssm_conv_s5__dense_activation_squared_relu__prompt_kernel-4, v11
  global_load_dword v19, v11, s[80:81]
L_CPF_done:
  s_and_b32 s80, s2, 7
  s_lshr_b32 s81, s2, 3
  s_and_b32 s82, s80, 1
  s_lshl_b32 s82, s82, 3
  s_and_b32 s83, s81, 7
  s_add_u32 s73, s82, s83
  s_lshr_b32 s82, s80, 1
  s_lshr_b32 s83, s81, 3
  s_lshl_b32 s84, s82, 1
  s_add_u32 s84, s84, s83
  s_add_u32 s85, s84, 9
  s_sub_u32 s84, s84, 2
  s_cmp_lt_u32 s83, 2
  s_cselect_b32 s84, s85, s84
  s_add_u32 s85, s83, 5
  s_cmp_eq_u32 s83, 0
  s_cselect_b32 s85, 15, s85
  s_cmp_eq_u32 s82, 3
  s_cselect_b32 s74, s85, s84
  s_lshr_b32 s82, s80, 1
  s_lshl_b32 s82, s82, 3
  s_lshr_b32 s83, s81, 2
  s_add_u32 s76, s82, s83
  s_and_b32 s82, s80, 1
  s_lshl_b32 s82, s82, 2
  s_and_b32 s83, s81, 3
  s_add_u32 s77, s82, s83
  s_sub_u32 s82, s74, 9
  s_cmp_ge_u32 s74, 9
  s_cselect_b32 s79, 1, 0
  s_cselect_b32 s75, s82, s74
  s_waitcnt lgkmcnt(0)
  s_mov_b32 s16, s70
  s_mov_b32 s17, s71
  s_mov_b32 s18, 268435456
  s_mov_b32 s19, 0x20000
  s_mov_b32 s4, s36
  s_mov_b32 s5, s37
  s_mov_b32 s6, 2621440
  s_mov_b32 s7, 0x20000
  s_cmp_eq_u32 s2, 0
  s_cbranch_scc0 L_no_nonce
  s_cmp_eq_u32 s72, 4
  s_cbranch_scc0 L_no_nonce
  s_memrealtime s[80:81]
  s_mov_b32 s20, s68
  s_mov_b32 s21, s69
  s_mov_b32 s22, 256
  s_mov_b32 s23, 0x20000
  s_waitcnt lgkmcnt(0)
  s_or_b32 s80, s80, 1
  v_mov_b32 v12, s80
  v_mov_b32 v13, 0
  s_mov_b64 exec, 1
  buffer_store_dword v12, v13, s[20:23], 0 offen sc0 sc1
  s_mov_b64 exec, -1
L_no_nonce:
  s_cmp_ge_u32 s72, 4
  s_cbranch_scc1 L_LOADER
  v_mov_b32 v10, 152576
  v_mov_b32 v12, 0
  v_mov_b32 v13, 0
  v_mov_b32 v14, 0
  v_mov_b32 v15, 0
  ds_write_b128 v10, v[12:15]
  ds_write_b128 v10, v[12:15] offset:16
  ds_write_b128 v10, v[12:15] offset:32
L_CONS_START:
  s_lshr_b32 s80, s2, 3
  s_and_b32 s81, s80, 7
  s_lshr_b32 s80, s80, 3
  v_mov_b32 v17, 0x10000000
  s_mov_b32 s83, 0
  s_mov_b32 s85, 128
  s_mov_b32 s28, s4
  s_mov_b32 s29, s5
  s_mov_b32 s30, 2621440
  s_mov_b32 s31, 0x20000
  s_cmp_eq_u32 s72, 0
  s_cbranch_scc0 L_GS_1C
  s_lshl_b32 s80, s80, 5
  s_lshl_b32 s82, s73, 7
  s_add_u32 s80, s80, s82
  v_add_u32 v16, s80, v0
  v_mul_u32_u24 v16, 1280, v16
  v_cmp_gt_u32 vcc, 32, v0
  s_nop 1
  v_cndmask_b32 v17, v17, v16, vcc
  s_branch L_GS_doneC
L_GS_1C:
  s_cmp_ge_u32 s72, 3
  s_cbranch_scc1 L_GS_doneC
  s_cmp_eq_u32 s79, 1
  s_cbranch_scc1 L_GS_UC
  s_cmp_eq_u32 s72, 1
  s_cbranch_scc0 L_GS_doneC
  s_mov_b32 s28, s56
  s_mov_b32 s29, s57
  s_mov_b32 s30, 2211840
  s_mul_i32 s83, s75, 384
  s_add_u32 s83, s83, 0
  s_mov_b32 s85, 221184
  v_mul_u32_u24 v16, 43, v0
  v_lshrrev_b32 v16, 7, v16
  v_mul_u32_u24 v15, 3, v16
  v_sub_u32 v15, v0, v15
  s_lshl_b32 s81, s81, 3
  v_add_u32 v16, s81, v16
  v_mul_u32_u24 v16, 3456, v16
  v_lshlrev_b32 v15, 7, v15
  v_add_u32 v16, v16, v15
  v_cmp_gt_u32 vcc, 24, v0
  s_nop 1
  v_cndmask_b32 v17, v17, v16, vcc
  s_branch L_GS_doneC
L_GS_UC:
  s_cmp_eq_u32 s72, 1
  s_cselect_b32 s28, s42, s44
  s_cselect_b32 s29, s43, s45
  s_mov_b32 s30, 819200
  s_mul_i32 s80, s75, 96
  s_mul_i32 s81, s81, 12
  s_add_u32 s80, s80, s81
  v_add_u32 v16, s80, v0
  v_min_u32 v16, 639, v16
  v_mul_u32_u24 v16, 1280, v16
  v_cmp_gt_u32 vcc, 12, v0
  s_nop 1
  v_cndmask_b32 v17, v17, v16, vcc
L_GS_doneC:
  buffer_load_dword v18, v17, s[28:31], s83 offen
  s_add_u32 s83, s83, s85
  buffer_load_dword v18, v17, s[28:31], s83 offen
  s_add_u32 s83, s83, s85
  buffer_load_dword v18, v17, s[28:31], s83 offen
  s_add_u32 s83, s83, s85
  s_cmp_ge_u32 s2, 108
  s_cbranch_scc1 L_UID_C
  s_lshr_b32 s3, s2, 1
  s_and_b32 s35, s2, 1
  s_lshl_b32 s35, s35, 2
  s_add_u32 s35, s35, s72
  s_branch L_UID_done
L_UID_C:
  s_sub_u32 s80, s2, 108
  s_and_b32 s35, s80, 7
  s_lshr_b32 s80, s80, 3
  s_lshl_b32 s3, s80, 2
  s_add_u32 s3, s3, s72
  s_add_u32 s3, s3, 54
L_UID_done:
  s_cmp_ge_u32 s3, 54
  s_cbranch_scc1 L_PREP_C
  s_mov_b32 s20, s60
  s_mov_b32 s21, s61
  s_mov_b32 s22, 2211840
  s_mov_b32 s23, 0x20000
  s_mul_i32 s80, s3, 40960
  s_mul_i32 s81, s35, 160
  s_add_u32 s80, s80, s81
  s_mul_i32 s81, s72, 5120
  s_add_u32 s81, s81, 122880
  v_add_u32 v10, 0, v0
  v_mul_u32_u24 v11, 205, v10
  v_lshrrev_b32 v11, 11, v11
  v_mul_u32_u24 v12, 10, v11
  v_sub_u32 v12, v10, v12
  v_mul_u32_u24 v11, 1280, v11
  v_lshlrev_b32 v12, 4, v12
  v_add_u32 v11, v11, v12
  s_add_u32 m0, s81, 0
  s_nop 0
  buffer_load_dwordx4 v11, s[20:23], s80 offen nt lds
  v_add_u32 v10, 64, v0
  v_mul_u32_u24 v11, 205, v10
  v_lshrrev_b32 v11, 11, v11
  v_mul_u32_u24 v12, 10, v11
  v_sub_u32 v12, v10, v12
  v_mul_u32_u24 v11, 1280, v11
  v_lshlrev_b32 v12, 4, v12
  v_add_u32 v11, v11, v12
  s_add_u32 m0, s81, 1024
  s_nop 0
  buffer_load_dwordx4 v11, s[20:23], s80 offen nt lds
  v_add_u32 v10, 128, v0
  v_mul_u32_u24 v11, 205, v10
  v_lshrrev_b32 v11, 11, v11
  v_mul_u32_u24 v12, 10, v11
  v_sub_u32 v12, v10, v12
  v_mul_u32_u24 v11, 1280, v11
  v_lshlrev_b32 v12, 4, v12
  v_add_u32 v11, v11, v12
  s_add_u32 m0, s81, 2048
  s_nop 0
  buffer_load_dwordx4 v11, s[20:23], s80 offen nt lds
  v_add_u32 v10, 192, v0
  v_mul_u32_u24 v11, 205, v10
  v_lshrrev_b32 v11, 11, v11
  v_mul_u32_u24 v12, 10, v11
  v_sub_u32 v12, v10, v12
  v_mul_u32_u24 v11, 1280, v11
  v_lshlrev_b32 v12, 4, v12
  v_add_u32 v11, v11, v12
  s_add_u32 m0, s81, 3072
  s_nop 0
  buffer_load_dwordx4 v11, s[20:23], s80 offen nt lds
  v_add_u32 v10, 256, v0
  v_mul_u32_u24 v11, 205, v10
  v_lshrrev_b32 v11, 11, v11
  v_mul_u32_u24 v12, 10, v11
  v_sub_u32 v12, v10, v12
  v_mul_u32_u24 v11, 1280, v11
  v_lshlrev_b32 v12, 4, v12
  v_add_u32 v11, v11, v12
  s_add_u32 m0, s81, 4096
  s_nop 0
  buffer_load_dwordx4 v11, s[20:23], s80 offen nt lds
  v_mov_b32 v11, 0x10000000
  buffer_load_dword v16, v11, s[20:23], s80 offen
  buffer_load_dword v16, v11, s[20:23], s80 offen
  buffer_load_dword v16, v11, s[20:23], s80 offen
  buffer_load_dword v16, v11, s[20:23], s80 offen
  buffer_load_dword v16, v11, s[20:23], s80 offen
  s_branch L_PREP_issued
L_PREP_C:
  s_mov_b32 s20, s46
  s_mov_b32 s21, s47
  s_mov_b32 s22, 819200
  s_mov_b32 s23, 0x20000
  s_mov_b32 s24, s48
  s_mov_b32 s25, s49
  s_mov_b32 s26, 819200
  s_mov_b32 s27, 0x20000
  v_and_b32 v10, 15, v0
  v_mul_u32_u24 v10, 1280, v10
  v_lshrrev_b32 v11, 4, v0
  v_lshlrev_b32 v11, 3, v11
  v_add_u32 v10, v10, v11
  s_sub_u32 s80, s3, 54
  s_min_u32 s80, s80, 39
  s_lshl_b32 s80, s80, 5
  s_mul_i32 s81, s35, 102400
  s_add_u32 s80, s80, s81
  buffer_load_dwordx2 v[16:17], v10, s[20:23], s80 offen nt
  buffer_load_dwordx2 v[18:19], v10, s[24:27], s80 offen nt
  s_add_u32 s80, s80, 20480
  buffer_load_dwordx2 v[20:21], v10, s[20:23], s80 offen nt
  buffer_load_dwordx2 v[22:23], v10, s[24:27], s80 offen nt
  s_add_u32 s80, s80, 20480
  buffer_load_dwordx2 v[24:25], v10, s[20:23], s80 offen nt
  buffer_load_dwordx2 v[26:27], v10, s[24:27], s80 offen nt
  s_add_u32 s80, s80, 20480
  buffer_load_dwordx2 v[28:29], v10, s[20:23], s80 offen nt
  buffer_load_dwordx2 v[30:31], v10, s[24:27], s80 offen nt
  s_add_u32 s80, s80, 20480
  buffer_load_dwordx2 v[32:33], v10, s[20:23], s80 offen nt
  buffer_load_dwordx2 v[34:35], v10, s[24:27], s80 offen nt
L_PREP_issued:
  s_cmp_eq_u32 s79, 1
  s_cbranch_scc1 L_CONS_U
L_CONS_F:
  s_mov_b32 s24, s58
  s_mov_b32 s25, s59
  s_mov_b32 s26, 3456
  s_mov_b32 s27, 0x20000
  s_mul_i32 s80, s75, 384
  s_and_b32 s81, s72, 1
  s_mul_i32 s81, s81, 192
  s_add_u32 s80, s80, s81
  v_lshrrev_b32 v10, 4, v0
  v_lshlrev_b32 v10, 3, v10
  buffer_load_dwordx2 v[224:225], v10, s[24:27], s80 offen offset:0
  buffer_load_dwordx2 v[226:227], v10, s[24:27], s80 offen offset:32
  buffer_load_dwordx2 v[228:229], v10, s[24:27], s80 offen offset:64
  buffer_load_dwordx2 v[230:231], v10, s[24:27], s80 offen offset:96
  buffer_load_dwordx2 v[232:233], v10, s[24:27], s80 offen offset:128
  buffer_load_dwordx2 v[234:235], v10, s[24:27], s80 offen offset:160
  s_lshr_b32 s80, s72, 1
  s_lshl_b32 s80, s80, 13
  v_and_b32 v10, 15, v0
  v_lshlrev_b32 v10, 7, v10
  v_lshrrev_b32 v11, 4, v0
  v_and_b32 v12, 7, v0
  v_xor_b32 v11, v11, v12
  v_lshlrev_b32 v11, 4, v11
  v_add_u32 v10, v10, v11
  v_add_u32 v2, s80, v10
  v_xor_b32 v3, 64, v2
  v_lshrrev_b32 v10, 4, v0
  v_bfe_u32 v11, v0, 2, 2
  v_lshlrev_b32 v12, 3, v10
  v_add_u32 v12, v12, v11
  v_mul_u32_u24 v12, 384, v12
  v_bfe_u32 v13, v0, 3, 1
  v_lshlrev_b32 v13, 1, v13
  v_and_b32 v14, 1, v10
  v_lshlrev_b32 v14, 2, v14
  v_or_b32 v13, v13, v14
  v_bfe_u32 v14, v0, 1, 1
  s_and_b32 s81, s72, 1
  s_mul_i32 s81, s81, 12
  v_add_u32 v14, s81, v14
  v_and_b32 v15, 1, v0
  v_lshlrev_b32 v15, 3, v15
  v_add_u32 v12, v12, v15
  v_add_u32 v12, 16384, v12
  v_add_u32 v10, 0, v14
  v_xor_b32 v10, v10, v13
  v_lshlrev_b32 v10, 4, v10
  v_add_u32 v4, v12, v10
  v_add_u32 v10, 2, v14
  v_xor_b32 v10, v10, v13
  v_lshlrev_b32 v10, 4, v10
  v_add_u32 v5, v12, v10
  v_add_u32 v10, 4, v14
  v_xor_b32 v10, v10, v13
  v_lshlrev_b32 v10, 4, v10
  v_add_u32 v6, v12, v10
  v_add_u32 v10, 6, v14
  v_xor_b32 v10, v10, v13
  v_lshlrev_b32 v10, 4, v10
  v_add_u32 v7, v12, v10
  v_add_u32 v10, 8, v14
  v_xor_b32 v10, v10, v13
  v_lshlrev_b32 v10, 4, v10
  v_add_u32 v8, v12, v10
  v_add_u32 v10, 10, v14
  v_xor_b32 v10, v10, v13
  v_lshlrev_b32 v10, 4, v10
  v_add_u32 v9, v12, v10
  s_waitcnt vmcnt(0)
  s_cmp_ge_u32 s3, 54
  s_cbranch_scc1 L_PF_storeF
  v_lshrrev_b32 v10, 4, v0
  v_lshlrev_b32 v10, 2, v10
  v_bfe_u32 v11, v0, 2, 2
  v_add_u32 v10, v10, v11
  v_mul_u32_u24 v10, 160, v10
  v_and_b32 v11, 3, v0
  v_lshlrev_b32 v11, 3, v11
  v_add_u32 v10, v10, v11
  s_mul_i32 s81, s72, 5120
  s_add_u32 s81, s81, 122880
  v_add_u32 v10, s81, v10
  ds_read_b64_tr_b16 v[16:17], v10 offset:0
  ds_read_b64_tr_b16 v[18:19], v10 offset:2560
  ds_read_b64_tr_b16 v[20:21], v10 offset:32
  ds_read_b64_tr_b16 v[22:23], v10 offset:2592
  ds_read_b64_tr_b16 v[24:25], v10 offset:64
  ds_read_b64_tr_b16 v[26:27], v10 offset:2624
  ds_read_b64_tr_b16 v[28:29], v10 offset:96
  ds_read_b64_tr_b16 v[30:31], v10 offset:2656
  ds_read_b64_tr_b16 v[32:33], v10 offset:128
  ds_read_b64_tr_b16 v[34:35], v10 offset:2688
  s_waitcnt lgkmcnt(0)
L_PF_storeF:
  s_mul_i32 s80, s35, 94
  s_add_u32 s80, s80, s3
  s_mul_i32 s80, s80, 5120
  s_add_u32 s80, s80, 12582912
  v_lshlrev_b32 v10, 4, v0
  v_mov_b32 v11, 0x10000000
  s_cmp_ge_u32 s3, 94
  s_cselect_b32 s81, 1, 0
  v_mov_b32 v12, s81
  v_cmp_eq_u32 vcc, 1, v12
  s_nop 1
  v_cndmask_b32 v10, v10, v11, vcc
  buffer_store_dwordx4 v[16:19], v10, s[16:19], s80 offen offset:0 sc1
  buffer_store_dwordx4 v[20:23], v10, s[16:19], s80 offen offset:1024 sc1
  buffer_store_dwordx4 v[24:27], v10, s[16:19], s80 offen offset:2048 sc1
  buffer_store_dwordx4 v[28:31], v10, s[16:19], s80 offen offset:3072 sc1
  s_add_u32 s80, s80, 4096
  buffer_store_dwordx4 v[32:35], v10, s[16:19], s80 offen sc1
  s_mov_b32 s20, s68
  s_mov_b32 s21, s69
  s_mov_b32 s22, 256
  s_mov_b32 s23, 0x20000
  v_mov_b32 v248, 0
  v_lshlrev_b32 v36, 16, v224
  v_and_b32 v37, 0xffff0000, v224
  v_lshlrev_b32 v38, 16, v225
  v_and_b32 v39, 0xffff0000, v225
  v_lshlrev_b32 v40, 16, v226
  v_and_b32 v41, 0xffff0000, v226
  v_lshlrev_b32 v42, 16, v227
  v_and_b32 v43, 0xffff0000, v227
  v_lshlrev_b32 v44, 16, v228
  v_and_b32 v45, 0xffff0000, v228
  v_lshlrev_b32 v46, 16, v229
  v_and_b32 v47, 0xffff0000, v229
  v_lshlrev_b32 v48, 16, v230
  v_and_b32 v49, 0xffff0000, v230
  v_lshlrev_b32 v50, 16, v231
  v_and_b32 v51, 0xffff0000, v231
  v_lshlrev_b32 v52, 16, v232
  v_and_b32 v53, 0xffff0000, v232
  v_lshlrev_b32 v54, 16, v233
  v_and_b32 v55, 0xffff0000, v233
  v_lshlrev_b32 v56, 16, v234
  v_and_b32 v57, 0xffff0000, v234
  v_lshlrev_b32 v58, 16, v235
  v_and_b32 v59, 0xffff0000, v235
  s_mov_b32 s86, 1
  s_mov_b32 s88, 0
  s_mov_b32 s89, 40960
  s_mov_b32 s90, 4294885376
  s_waitcnt lgkmcnt(0)
  s_barrier
  ds_read_b64_tr_b16 v[176:177], v4 offset:0
  ds_read_b64_tr_b16 v[178:179], v4 offset:1536
  ds_read_b128 v[160:163], v2 offset:0
  ds_read_b128 v[164:167], v2 offset:2048
  ds_read_b128 v[168:171], v2 offset:4096
  ds_read_b128 v[172:175], v2 offset:6144
  ds_read_b64_tr_b16 v[180:181], v5 offset:0
  ds_read_b64_tr_b16 v[182:183], v5 offset:1536
  ds_read_b64_tr_b16 v[184:185], v6 offset:0
  ds_read_b64_tr_b16 v[186:187], v6 offset:1536
  ds_read_b64_tr_b16 v[188:189], v7 offset:0
  ds_read_b64_tr_b16 v[190:191], v7 offset:1536
  ds_read_b64_tr_b16 v[192:193], v8 offset:0
  ds_read_b64_tr_b16 v[194:195], v8 offset:1536
  ds_read_b64_tr_b16 v[196:197], v9 offset:0
  ds_read_b64_tr_b16 v[198:199], v9 offset:1536
  s_waitcnt lgkmcnt(0)
  v_mfma_f32_16x16x32_bf16 v[64:67], v[176:179], v[160:163], v[36:39]
  ds_read_b64_tr_b16 v[216:217], v4 offset:12288
  v_mfma_f32_16x16x32_bf16 v[68:71], v[176:179], v[164:167], v[36:39]
  ds_read_b64_tr_b16 v[218:219], v4 offset:13824
  v_mfma_f32_16x16x32_bf16 v[72:75], v[176:179], v[168:171], v[36:39]
  ds_read_b128 v[200:203], v3 offset:0
  v_mfma_f32_16x16x32_bf16 v[76:79], v[176:179], v[172:175], v[36:39]
  ds_read_b128 v[204:207], v3 offset:2048
  v_mfma_f32_16x16x32_bf16 v[80:83], v[180:183], v[160:163], v[40:43]
  ds_read_b128 v[208:211], v3 offset:4096
  v_mfma_f32_16x16x32_bf16 v[84:87], v[180:183], v[164:167], v[40:43]
  ds_read_b128 v[212:215], v3 offset:6144
  v_mfma_f32_16x16x32_bf16 v[88:91], v[180:183], v[168:171], v[40:43]
  ds_read_b64_tr_b16 v[220:221], v5 offset:12288
  v_mfma_f32_16x16x32_bf16 v[92:95], v[180:183], v[172:175], v[40:43]
  ds_read_b64_tr_b16 v[222:223], v5 offset:13824
  v_mfma_f32_16x16x32_bf16 v[96:99], v[184:187], v[160:163], v[44:47]
  ds_read_b64_tr_b16 v[224:225], v6 offset:12288
  v_mfma_f32_16x16x32_bf16 v[100:103], v[184:187], v[164:167], v[44:47]
  ds_read_b64_tr_b16 v[226:227], v6 offset:13824
  v_mfma_f32_16x16x32_bf16 v[104:107], v[184:187], v[168:171], v[44:47]
  ds_read_b64_tr_b16 v[228:229], v7 offset:12288
  v_mfma_f32_16x16x32_bf16 v[108:111], v[184:187], v[172:175], v[44:47]
  ds_read_b64_tr_b16 v[230:231], v7 offset:13824
  v_mfma_f32_16x16x32_bf16 v[112:115], v[188:191], v[160:163], v[48:51]
  ds_read_b64_tr_b16 v[232:233], v8 offset:12288
  v_mfma_f32_16x16x32_bf16 v[116:119], v[188:191], v[164:167], v[48:51]
  ds_read_b64_tr_b16 v[234:235], v8 offset:13824
  v_mfma_f32_16x16x32_bf16 v[120:123], v[188:191], v[168:171], v[48:51]
  ds_read_b64_tr_b16 v[236:237], v9 offset:12288
  v_mfma_f32_16x16x32_bf16 v[124:127], v[188:191], v[172:175], v[48:51]
  ds_read_b64_tr_b16 v[238:239], v9 offset:13824
  v_mfma_f32_16x16x32_bf16 v[128:131], v[192:195], v[160:163], v[52:55]
  s_add_u32 s88, s88, 1
  s_cmp_eq_u32 s88, 3
  v_mfma_f32_16x16x32_bf16 v[132:135], v[192:195], v[164:167], v[52:55]
  s_cselect_b32 s87, s90, s89
  s_cselect_b32 s88, 0, s88
  v_mfma_f32_16x16x32_bf16 v[136:139], v[192:195], v[168:171], v[52:55]
  v_add_u32 v2, s87, v2
  v_add_u32 v3, s87, v3
  v_mfma_f32_16x16x32_bf16 v[140:143], v[192:195], v[172:175], v[52:55]
  v_add_u32 v4, s87, v4
  v_add_u32 v5, s87, v5
  v_mfma_f32_16x16x32_bf16 v[144:147], v[196:199], v[160:163], v[56:59]
  v_add_u32 v6, s87, v6
  v_mfma_f32_16x16x32_bf16 v[148:151], v[196:199], v[164:167], v[56:59]
  v_add_u32 v7, s87, v7
  v_mfma_f32_16x16x32_bf16 v[152:155], v[196:199], v[168:171], v[56:59]
  v_add_u32 v8, s87, v8
  v_mfma_f32_16x16x32_bf16 v[156:159], v[196:199], v[172:175], v[56:59]
  v_add_u32 v9, s87, v9
  s_waitcnt lgkmcnt(0)
L_ML_F:
  s_barrier
  v_mfma_f32_16x16x32_bf16 v[64:67], v[216:219], v[200:203], v[64:67]
  ds_read_b64_tr_b16 v[176:177], v4 offset:0
  v_mfma_f32_16x16x32_bf16 v[68:71], v[216:219], v[204:207], v[68:71]
  ds_read_b64_tr_b16 v[178:179], v4 offset:1536
  v_mfma_f32_16x16x32_bf16 v[72:75], v[216:219], v[208:211], v[72:75]
  ds_read_b128 v[160:163], v2 offset:0
  v_mfma_f32_16x16x32_bf16 v[76:79], v[216:219], v[212:215], v[76:79]
  ds_read_b128 v[164:167], v2 offset:2048
  v_mfma_f32_16x16x32_bf16 v[80:83], v[220:223], v[200:203], v[80:83]
  ds_read_b128 v[168:171], v2 offset:4096
  v_mfma_f32_16x16x32_bf16 v[84:87], v[220:223], v[204:207], v[84:87]
  ds_read_b128 v[172:175], v2 offset:6144
  v_mfma_f32_16x16x32_bf16 v[88:91], v[220:223], v[208:211], v[88:91]
  ds_read_b64_tr_b16 v[180:181], v5 offset:0
  v_mfma_f32_16x16x32_bf16 v[92:95], v[220:223], v[212:215], v[92:95]
  ds_read_b64_tr_b16 v[182:183], v5 offset:1536
  v_mfma_f32_16x16x32_bf16 v[96:99], v[224:227], v[200:203], v[96:99]
  ds_read_b64_tr_b16 v[184:185], v6 offset:0
  v_mfma_f32_16x16x32_bf16 v[100:103], v[224:227], v[204:207], v[100:103]
  ds_read_b64_tr_b16 v[186:187], v6 offset:1536
  v_mfma_f32_16x16x32_bf16 v[104:107], v[224:227], v[208:211], v[104:107]
  ds_read_b64_tr_b16 v[188:189], v7 offset:0
  v_mfma_f32_16x16x32_bf16 v[108:111], v[224:227], v[212:215], v[108:111]
  ds_read_b64_tr_b16 v[190:191], v7 offset:1536
  v_mfma_f32_16x16x32_bf16 v[112:115], v[228:231], v[200:203], v[112:115]
  ds_read_b64_tr_b16 v[192:193], v8 offset:0
  v_mfma_f32_16x16x32_bf16 v[116:119], v[228:231], v[204:207], v[116:119]
  ds_read_b64_tr_b16 v[194:195], v8 offset:1536
  v_mfma_f32_16x16x32_bf16 v[120:123], v[228:231], v[208:211], v[120:123]
  ds_read_b64_tr_b16 v[196:197], v9 offset:0
  v_mfma_f32_16x16x32_bf16 v[124:127], v[228:231], v[212:215], v[124:127]
  ds_read_b64_tr_b16 v[198:199], v9 offset:1536
  v_mfma_f32_16x16x32_bf16 v[128:131], v[232:235], v[200:203], v[128:131]
  v_mfma_f32_16x16x32_bf16 v[132:135], v[232:235], v[204:207], v[132:135]
  v_mfma_f32_16x16x32_bf16 v[136:139], v[232:235], v[208:211], v[136:139]
  v_mfma_f32_16x16x32_bf16 v[140:143], v[232:235], v[212:215], v[140:143]
  v_mfma_f32_16x16x32_bf16 v[144:147], v[236:239], v[200:203], v[144:147]
  v_mfma_f32_16x16x32_bf16 v[148:151], v[236:239], v[204:207], v[148:151]
  v_mfma_f32_16x16x32_bf16 v[152:155], v[236:239], v[208:211], v[152:155]
  v_mfma_f32_16x16x32_bf16 v[156:159], v[236:239], v[212:215], v[156:159]
  s_cmp_eq_u32 s86, 1
  s_cbranch_scc0 L_ML_h1_F
  buffer_load_dword v249, v248, s[20:23], 0 offen
L_ML_h1_F:
  s_cmp_eq_u32 s86, 4
  s_cbranch_scc0 L_ML_h2_F
  s_waitcnt vmcnt(0)
  v_readfirstlane_b32 s78, v249
  s_nop 0
  s_cmp_eq_u32 s78, 0
  s_cbranch_scc0 L_ML_h2b_F
  s_mov_b32 s20, s68
  s_mov_b32 s21, s69
  s_mov_b32 s22, 256
  s_mov_b32 s23, 0x20000
  v_mov_b32 v11, 0
  s_mov_b32 s80, 0
L_nonce_HF:
  buffer_load_dword v10, v11, s[20:23], 0 offen sc1
  s_add_u32 s80, s80, 1
  s_waitcnt vmcnt(0)
  v_readfirstlane_b32 s78, v10
  s_cmp_ge_u32 s80, 2000000
  s_cbranch_scc1 L_nonce_done_HF
  s_cmp_eq_u32 s78, 0
  s_cbranch_scc0 L_nonce_done_HF
  s_sleep 1
  s_branch L_nonce_HF
L_nonce_done_HF:
L_ML_h2b_F:
  s_lshl_b32 s80, s35, 9
  s_lshl_b32 s81, s3, 2
  s_add_u32 s80, s80, s81
  s_add_u32 s80, s80, 17039360
  v_mov_b32 v10, s78
  s_cmp_ge_u32 s3, 94
  s_cselect_b32 s81, 0x10000000, 0
  v_mov_b32 v11, s81
  s_mov_b64 exec, 1
  buffer_store_dword v10, v11, s[16:19], s80 offen sc0 sc1
  s_mov_b64 exec, -1
L_ML_h2_F:
  s_waitcnt lgkmcnt(0)
  v_mfma_f32_16x16x32_bf16 v[64:67], v[176:179], v[160:163], v[64:67]
  ds_read_b64_tr_b16 v[216:217], v4 offset:12288
  v_mfma_f32_16x16x32_bf16 v[68:71], v[176:179], v[164:167], v[68:71]
  ds_read_b64_tr_b16 v[218:219], v4 offset:13824
  v_mfma_f32_16x16x32_bf16 v[72:75], v[176:179], v[168:171], v[72:75]
  ds_read_b128 v[200:203], v3 offset:0
  v_mfma_f32_16x16x32_bf16 v[76:79], v[176:179], v[172:175], v[76:79]
  ds_read_b128 v[204:207], v3 offset:2048
  v_mfma_f32_16x16x32_bf16 v[80:83], v[180:183], v[160:163], v[80:83]
  ds_read_b128 v[208:211], v3 offset:4096
  v_mfma_f32_16x16x32_bf16 v[84:87], v[180:183], v[164:167], v[84:87]
  ds_read_b128 v[212:215], v3 offset:6144
  v_mfma_f32_16x16x32_bf16 v[88:91], v[180:183], v[168:171], v[88:91]
  ds_read_b64_tr_b16 v[220:221], v5 offset:12288
  v_mfma_f32_16x16x32_bf16 v[92:95], v[180:183], v[172:175], v[92:95]
  ds_read_b64_tr_b16 v[222:223], v5 offset:13824
  v_mfma_f32_16x16x32_bf16 v[96:99], v[184:187], v[160:163], v[96:99]
  ds_read_b64_tr_b16 v[224:225], v6 offset:12288
  v_mfma_f32_16x16x32_bf16 v[100:103], v[184:187], v[164:167], v[100:103]
  ds_read_b64_tr_b16 v[226:227], v6 offset:13824
  v_mfma_f32_16x16x32_bf16 v[104:107], v[184:187], v[168:171], v[104:107]
  ds_read_b64_tr_b16 v[228:229], v7 offset:12288
  v_mfma_f32_16x16x32_bf16 v[108:111], v[184:187], v[172:175], v[108:111]
  ds_read_b64_tr_b16 v[230:231], v7 offset:13824
  v_mfma_f32_16x16x32_bf16 v[112:115], v[188:191], v[160:163], v[112:115]
  ds_read_b64_tr_b16 v[232:233], v8 offset:12288
  v_mfma_f32_16x16x32_bf16 v[116:119], v[188:191], v[164:167], v[116:119]
  ds_read_b64_tr_b16 v[234:235], v8 offset:13824
  v_mfma_f32_16x16x32_bf16 v[120:123], v[188:191], v[168:171], v[120:123]
  ds_read_b64_tr_b16 v[236:237], v9 offset:12288
  v_mfma_f32_16x16x32_bf16 v[124:127], v[188:191], v[172:175], v[124:127]
  ds_read_b64_tr_b16 v[238:239], v9 offset:13824
  v_mfma_f32_16x16x32_bf16 v[128:131], v[192:195], v[160:163], v[128:131]
  s_add_u32 s88, s88, 1
  s_cmp_eq_u32 s88, 3
  v_mfma_f32_16x16x32_bf16 v[132:135], v[192:195], v[164:167], v[132:135]
  s_cselect_b32 s87, s90, s89
  s_cselect_b32 s88, 0, s88
  v_mfma_f32_16x16x32_bf16 v[136:139], v[192:195], v[168:171], v[136:139]
  v_add_u32 v2, s87, v2
  v_add_u32 v3, s87, v3
  v_mfma_f32_16x16x32_bf16 v[140:143], v[192:195], v[172:175], v[140:143]
  v_add_u32 v4, s87, v4
  v_add_u32 v5, s87, v5
  v_mfma_f32_16x16x32_bf16 v[144:147], v[196:199], v[160:163], v[144:147]
  v_add_u32 v6, s87, v6
  v_add_u32 v7, s87, v7
  v_mfma_f32_16x16x32_bf16 v[148:151], v[196:199], v[164:167], v[148:151]
  v_add_u32 v8, s87, v8
  v_add_u32 v9, s87, v9
  v_mfma_f32_16x16x32_bf16 v[152:155], v[196:199], v[168:171], v[152:155]
  s_add_u32 s86, s86, 1
  v_mfma_f32_16x16x32_bf16 v[156:159], v[196:199], v[172:175], v[156:159]
  s_cmp_lt_u32 s86, 10
  s_waitcnt lgkmcnt(0)
  s_cbranch_scc1 L_ML_F
  v_mov_b32 v10, 152600
  v_mov_b32 v11, 1
  s_mov_b64 exec, 1
  ds_add_u32 v10, v11
  s_mov_b64 exec, -1
  s_mul_i32 s87, s72, 10
  s_add_u32 s87, s87, 54
  s_lshl_b32 s89, s77, 9
  s_lshl_b32 s90, s87, 2
  s_add_u32 s89, s89, s90
  s_add_u32 s35, s89, 17039360
  v_lshlrev_b32 v8, 2, v0
  buffer_load_dword v1, v8, s[16:19], s35 offen sc1
  v_mfma_f32_16x16x32_bf16 v[64:67], v[216:219], v[200:203], v[64:67]
  v_mfma_f32_16x16x32_bf16 v[68:71], v[216:219], v[204:207], v[68:71]
  v_mfma_f32_16x16x32_bf16 v[72:75], v[216:219], v[208:211], v[72:75]
  v_mfma_f32_16x16x32_bf16 v[76:79], v[216:219], v[212:215], v[76:79]
  v_mfma_f32_16x16x32_bf16 v[80:83], v[220:223], v[200:203], v[80:83]
  v_mfma_f32_16x16x32_bf16 v[84:87], v[220:223], v[204:207], v[84:87]
  v_mfma_f32_16x16x32_bf16 v[88:91], v[220:223], v[208:211], v[88:91]
  v_mfma_f32_16x16x32_bf16 v[92:95], v[220:223], v[212:215], v[92:95]
  v_mfma_f32_16x16x32_bf16 v[96:99], v[224:227], v[200:203], v[96:99]
  v_mfma_f32_16x16x32_bf16 v[100:103], v[224:227], v[204:207], v[100:103]
  v_mfma_f32_16x16x32_bf16 v[104:107], v[224:227], v[208:211], v[104:107]
  v_mfma_f32_16x16x32_bf16 v[108:111], v[224:227], v[212:215], v[108:111]
  v_mfma_f32_16x16x32_bf16 v[112:115], v[228:231], v[200:203], v[112:115]
  v_mfma_f32_16x16x32_bf16 v[116:119], v[228:231], v[204:207], v[116:119]
  v_mfma_f32_16x16x32_bf16 v[120:123], v[228:231], v[208:211], v[120:123]
  v_mfma_f32_16x16x32_bf16 v[124:127], v[228:231], v[212:215], v[124:127]
  v_mfma_f32_16x16x32_bf16 v[128:131], v[232:235], v[200:203], v[128:131]
  v_mfma_f32_16x16x32_bf16 v[132:135], v[232:235], v[204:207], v[132:135]
  v_mfma_f32_16x16x32_bf16 v[136:139], v[232:235], v[208:211], v[136:139]
  v_mfma_f32_16x16x32_bf16 v[140:143], v[232:235], v[212:215], v[140:143]
  v_mfma_f32_16x16x32_bf16 v[144:147], v[236:239], v[200:203], v[144:147]
  v_mfma_f32_16x16x32_bf16 v[148:151], v[236:239], v[204:207], v[148:151]
  v_mfma_f32_16x16x32_bf16 v[152:155], v[236:239], v[208:211], v[152:155]
  v_mfma_f32_16x16x32_bf16 v[156:159], v[236:239], v[212:215], v[156:159]
  s_setprio 3
  s_lshr_b32 s80, s72, 1
  s_lshl_b32 s81, s73, 1
  s_add_u32 s80, s80, s81
  s_mul_i32 s80, s80, 94
  s_mul_i32 s81, s75, 6
  s_add_u32 s80, s80, s81
  s_and_b32 s81, s72, 1
  s_mul_i32 s81, s81, 3
  s_add_u32 s80, s80, s81
  s_lshl_b32 s32, s80, 12
  v_lshlrev_b32 v10, 4, v0
  v_max_f32 v24, 0, v64
  v_max_f32 v25, 0, v65
  v_max_f32 v26, 0, v66
  v_max_f32 v27, 0, v67
  v_max_f32 v28, 0, v80
  v_max_f32 v29, 0, v81
  v_max_f32 v30, 0, v82
  v_max_f32 v31, 0, v83
  v_pk_mul_f32 v[64:65], v[64:65], v[24:25]
  v_pk_mul_f32 v[66:67], v[66:67], v[26:27]
  v_pk_mul_f32 v[80:81], v[80:81], v[28:29]
  v_pk_mul_f32 v[82:83], v[82:83], v[30:31]
  v_cvt_pk_bf16_f32 v196, v64, v65
  v_cvt_pk_bf16_f32 v197, v66, v67
  v_cvt_pk_bf16_f32 v198, v80, v81
  v_cvt_pk_bf16_f32 v199, v82, v83
  v_max_f32 v16, 0, v68
  v_max_f32 v17, 0, v69
  v_max_f32 v18, 0, v70
  v_max_f32 v19, 0, v71
  v_max_f32 v20, 0, v84
  v_max_f32 v21, 0, v85
  v_max_f32 v22, 0, v86
  v_max_f32 v23, 0, v87
  v_pk_mul_f32 v[68:69], v[68:69], v[16:17]
  v_pk_mul_f32 v[70:71], v[70:71], v[18:19]
  v_pk_mul_f32 v[84:85], v[84:85], v[20:21]
  v_pk_mul_f32 v[86:87], v[86:87], v[22:23]
  v_cvt_pk_bf16_f32 v200, v68, v69
  v_cvt_pk_bf16_f32 v201, v70, v71
  v_cvt_pk_bf16_f32 v202, v84, v85
  v_cvt_pk_bf16_f32 v203, v86, v87
  v_max_f32 v24, 0, v72
  v_max_f32 v25, 0, v73
  v_max_f32 v26, 0, v74
  v_max_f32 v27, 0, v75
  v_max_f32 v28, 0, v88
  v_max_f32 v29, 0, v89
  v_max_f32 v30, 0, v90
  v_max_f32 v31, 0, v91
  v_pk_mul_f32 v[72:73], v[72:73], v[24:25]
  v_pk_mul_f32 v[74:75], v[74:75], v[26:27]
  v_pk_mul_f32 v[88:89], v[88:89], v[28:29]
  v_pk_mul_f32 v[90:91], v[90:91], v[30:31]
  v_cvt_pk_bf16_f32 v204, v72, v73
  v_cvt_pk_bf16_f32 v205, v74, v75
  v_cvt_pk_bf16_f32 v206, v88, v89
  v_cvt_pk_bf16_f32 v207, v90, v91
  v_max_f32 v16, 0, v76
  v_max_f32 v17, 0, v77
  v_max_f32 v18, 0, v78
  v_max_f32 v19, 0, v79
  v_max_f32 v20, 0, v92
  v_max_f32 v21, 0, v93
  v_max_f32 v22, 0, v94
  v_max_f32 v23, 0, v95
  v_pk_mul_f32 v[76:77], v[76:77], v[16:17]
  v_pk_mul_f32 v[78:79], v[78:79], v[18:19]
  v_pk_mul_f32 v[92:93], v[92:93], v[20:21]
  v_pk_mul_f32 v[94:95], v[94:95], v[22:23]
  v_cvt_pk_bf16_f32 v208, v76, v77
  v_cvt_pk_bf16_f32 v209, v78, v79
  v_cvt_pk_bf16_f32 v210, v92, v93
  v_cvt_pk_bf16_f32 v211, v94, v95
  v_max_f32 v24, 0, v96
  v_max_f32 v25, 0, v97
  v_max_f32 v26, 0, v98
  v_max_f32 v27, 0, v99
  v_max_f32 v28, 0, v112
  v_max_f32 v29, 0, v113
  v_max_f32 v30, 0, v114
  v_max_f32 v31, 0, v115
  v_pk_mul_f32 v[96:97], v[96:97], v[24:25]
  v_pk_mul_f32 v[98:99], v[98:99], v[26:27]
  v_pk_mul_f32 v[112:113], v[112:113], v[28:29]
  v_pk_mul_f32 v[114:115], v[114:115], v[30:31]
  v_cvt_pk_bf16_f32 v212, v96, v97
  v_cvt_pk_bf16_f32 v213, v98, v99
  v_cvt_pk_bf16_f32 v214, v112, v113
  v_cvt_pk_bf16_f32 v215, v114, v115
  v_max_f32 v16, 0, v100
  v_max_f32 v17, 0, v101
  v_max_f32 v18, 0, v102
  v_max_f32 v19, 0, v103
  v_max_f32 v20, 0, v116
  v_max_f32 v21, 0, v117
  v_max_f32 v22, 0, v118
  v_max_f32 v23, 0, v119
  v_pk_mul_f32 v[100:101], v[100:101], v[16:17]
  v_pk_mul_f32 v[102:103], v[102:103], v[18:19]
  v_pk_mul_f32 v[116:117], v[116:117], v[20:21]
  v_pk_mul_f32 v[118:119], v[118:119], v[22:23]
  v_cvt_pk_bf16_f32 v216, v100, v101
  v_cvt_pk_bf16_f32 v217, v102, v103
  v_cvt_pk_bf16_f32 v218, v116, v117
  v_cvt_pk_bf16_f32 v219, v118, v119
  v_max_f32 v24, 0, v104
  v_max_f32 v25, 0, v105
  v_max_f32 v26, 0, v106
  v_max_f32 v27, 0, v107
  v_max_f32 v28, 0, v120
  v_max_f32 v29, 0, v121
  v_max_f32 v30, 0, v122
  v_max_f32 v31, 0, v123
  v_pk_mul_f32 v[104:105], v[104:105], v[24:25]
  v_pk_mul_f32 v[106:107], v[106:107], v[26:27]
  v_pk_mul_f32 v[120:121], v[120:121], v[28:29]
  v_pk_mul_f32 v[122:123], v[122:123], v[30:31]
  v_cvt_pk_bf16_f32 v220, v104, v105
  v_cvt_pk_bf16_f32 v221, v106, v107
  v_cvt_pk_bf16_f32 v222, v120, v121
  v_cvt_pk_bf16_f32 v223, v122, v123
  v_max_f32 v16, 0, v108
  v_max_f32 v17, 0, v109
  v_max_f32 v18, 0, v110
  v_max_f32 v19, 0, v111
  v_max_f32 v20, 0, v124
  v_max_f32 v21, 0, v125
  v_max_f32 v22, 0, v126
  v_max_f32 v23, 0, v127
  v_pk_mul_f32 v[108:109], v[108:109], v[16:17]
  v_pk_mul_f32 v[110:111], v[110:111], v[18:19]
  v_pk_mul_f32 v[124:125], v[124:125], v[20:21]
  v_pk_mul_f32 v[126:127], v[126:127], v[22:23]
  v_cvt_pk_bf16_f32 v224, v108, v109
  v_cvt_pk_bf16_f32 v225, v110, v111
  v_cvt_pk_bf16_f32 v226, v124, v125
  v_cvt_pk_bf16_f32 v227, v126, v127
  v_max_f32 v24, 0, v128
  v_max_f32 v25, 0, v129
  v_max_f32 v26, 0, v130
  v_max_f32 v27, 0, v131
  v_max_f32 v28, 0, v144
  v_max_f32 v29, 0, v145
  v_max_f32 v30, 0, v146
  v_max_f32 v31, 0, v147
  v_pk_mul_f32 v[128:129], v[128:129], v[24:25]
  v_pk_mul_f32 v[130:131], v[130:131], v[26:27]
  v_pk_mul_f32 v[144:145], v[144:145], v[28:29]
  v_pk_mul_f32 v[146:147], v[146:147], v[30:31]
  v_cvt_pk_bf16_f32 v228, v128, v129
  v_cvt_pk_bf16_f32 v229, v130, v131
  v_cvt_pk_bf16_f32 v230, v144, v145
  v_cvt_pk_bf16_f32 v231, v146, v147
  v_max_f32 v16, 0, v132
  v_max_f32 v17, 0, v133
  v_max_f32 v18, 0, v134
  v_max_f32 v19, 0, v135
  v_max_f32 v20, 0, v148
  v_max_f32 v21, 0, v149
  v_max_f32 v22, 0, v150
  v_max_f32 v23, 0, v151
  v_pk_mul_f32 v[132:133], v[132:133], v[16:17]
  v_pk_mul_f32 v[134:135], v[134:135], v[18:19]
  v_pk_mul_f32 v[148:149], v[148:149], v[20:21]
  v_pk_mul_f32 v[150:151], v[150:151], v[22:23]
  v_cvt_pk_bf16_f32 v232, v132, v133
  v_cvt_pk_bf16_f32 v233, v134, v135
  v_cvt_pk_bf16_f32 v234, v148, v149
  v_cvt_pk_bf16_f32 v235, v150, v151
  v_max_f32 v24, 0, v136
  v_max_f32 v25, 0, v137
  v_max_f32 v26, 0, v138
  v_max_f32 v27, 0, v139
  v_max_f32 v28, 0, v152
  v_max_f32 v29, 0, v153
  v_max_f32 v30, 0, v154
  v_max_f32 v31, 0, v155
  v_pk_mul_f32 v[136:137], v[136:137], v[24:25]
  v_pk_mul_f32 v[138:139], v[138:139], v[26:27]
  v_pk_mul_f32 v[152:153], v[152:153], v[28:29]
  v_pk_mul_f32 v[154:155], v[154:155], v[30:31]
  v_cvt_pk_bf16_f32 v236, v136, v137
  v_cvt_pk_bf16_f32 v237, v138, v139
  v_cvt_pk_bf16_f32 v238, v152, v153
  v_cvt_pk_bf16_f32 v239, v154, v155
  v_max_f32 v16, 0, v140
  v_max_f32 v17, 0, v141
  v_max_f32 v18, 0, v142
  v_max_f32 v19, 0, v143
  v_max_f32 v20, 0, v156
  v_max_f32 v21, 0, v157
  v_max_f32 v22, 0, v158
  v_max_f32 v23, 0, v159
  v_pk_mul_f32 v[140:141], v[140:141], v[16:17]
  v_pk_mul_f32 v[142:143], v[142:143], v[18:19]
  v_pk_mul_f32 v[156:157], v[156:157], v[20:21]
  v_pk_mul_f32 v[158:159], v[158:159], v[22:23]
  v_cvt_pk_bf16_f32 v240, v140, v141
  v_cvt_pk_bf16_f32 v241, v142, v143
  v_cvt_pk_bf16_f32 v242, v156, v157
  v_cvt_pk_bf16_f32 v243, v158, v159
  s_waitcnt vmcnt(0)
  s_mul_i32 s87, s72, 10
  s_add_u32 s87, s87, 54
  v_cmp_ne_u32 vcc, s78, v1
  v_lshlrev_b32 v1, 4, v0
  v_lshlrev_b32 v8, 2, v0
  s_and_b32 s80, vcc_lo, 0x3ff
  s_cbranch_scc0 L_SSM_wokF
  s_mov_b32 s80, 0
  s_mov_b32 s82, 1023
  s_mov_b32 s83, 0
L_poll_SWF:
  buffer_load_dword v10, v8, s[16:19], s35 offen sc1
  s_add_u32 s80, s80, 1
  s_waitcnt vmcnt(0)
  v_cmp_ne_u32 vcc, s78, v10
  s_cmp_ge_u32 s80, 2000000
  s_cbranch_scc1 L_poll_done_SWF
  s_and_b64 vcc, vcc, s[82:83]
  s_cbranch_scc0 L_poll_done_SWF
  s_sleep 1
  s_branch L_poll_SWF
L_poll_done_SWF:
L_SSM_wokF:
  s_mul_i32 s84, s77, 94
  s_add_u32 s84, s84, s87
  s_mul_i32 s84, s84, 5120
  s_add_u32 s84, s84, 12582912
  s_mul_i32 s85, s76, 94
  s_add_u32 s85, s85, s87
  s_lshl_b32 s85, s85, 12
  s_mul_i32 s88, s72, 15360
  s_add_u32 s88, s88, 81920
  v_add_u32 v3, s88, v1
  s_setprio 2
  buffer_load_dwordx4 v[96:99], v1, s[16:19], s84 offen offset:0 sc1
  buffer_load_dwordx4 v[100:103], v1, s[16:19], s84 offen offset:1024 sc1
  buffer_load_dwordx4 v[104:107], v1, s[16:19], s84 offen offset:2048 sc1
  buffer_load_dwordx4 v[108:111], v1, s[16:19], s84 offen offset:3072 sc1
  s_add_u32 s84, s84, 4096
  buffer_load_dwordx4 v[112:115], v1, s[16:19], s84 offen sc1
  s_add_u32 s84, s84, 1024
  buffer_load_dwordx4 v[116:119], v1, s[16:19], s84 offen offset:0 sc1
  buffer_load_dwordx4 v[120:123], v1, s[16:19], s84 offen offset:1024 sc1
  buffer_load_dwordx4 v[124:127], v1, s[16:19], s84 offen offset:2048 sc1
  buffer_load_dwordx4 v[128:131], v1, s[16:19], s84 offen offset:3072 sc1
  s_add_u32 s84, s84, 4096
  buffer_load_dwordx4 v[132:135], v1, s[16:19], s84 offen sc1
  s_add_u32 s84, s84, 1024
  buffer_load_dwordx4 v[136:139], v1, s[16:19], s84 offen offset:0 sc1
  buffer_load_dwordx4 v[140:143], v1, s[16:19], s84 offen offset:1024 sc1
  buffer_load_dwordx4 v[144:147], v1, s[16:19], s84 offen offset:2048 sc1
  buffer_load_dwordx4 v[148:151], v1, s[16:19], s84 offen offset:3072 sc1
  s_add_u32 s84, s84, 4096
  buffer_load_dwordx4 v[152:155], v1, s[16:19], s84 offen sc1
  s_add_u32 s84, s84, 1024
  buffer_load_dwordx4 v[156:159], v1, s[16:19], s84 offen offset:0 sc1
  buffer_load_dwordx4 v[160:163], v1, s[16:19], s84 offen offset:1024 sc1
  buffer_load_dwordx4 v[164:167], v1, s[16:19], s84 offen offset:2048 sc1
  buffer_load_dwordx4 v[168:171], v1, s[16:19], s84 offen offset:3072 sc1
  s_add_u32 s84, s84, 4096
  buffer_load_dwordx4 v[172:175], v1, s[16:19], s84 offen sc1
  s_add_u32 s84, s84, 1024
  buffer_load_dwordx4 v[176:179], v1, s[16:19], s84 offen offset:0 sc1
  buffer_load_dwordx4 v[180:183], v1, s[16:19], s84 offen offset:1024 sc1
  buffer_load_dwordx4 v[184:187], v1, s[16:19], s84 offen offset:2048 sc1
  buffer_load_dwordx4 v[188:191], v1, s[16:19], s84 offen offset:3072 sc1
  s_add_u32 s84, s84, 4096
  buffer_load_dwordx4 v[192:195], v1, s[16:19], s84 offen sc1
  s_add_u32 s84, s84, 1024
  v_lshlrev_b32 v10, 4, v0
  buffer_store_dwordx4 v[196:199], v10, s[16:19], s32 offen offset:0 sc1
  buffer_store_dwordx4 v[200:203], v10, s[16:19], s32 offen offset:1024 sc1
  buffer_store_dwordx4 v[204:207], v10, s[16:19], s32 offen offset:2048 sc1
  buffer_store_dwordx4 v[208:211], v10, s[16:19], s32 offen offset:3072 sc1
  s_add_u32 s32, s32, 4096
  buffer_store_dwordx4 v[212:215], v10, s[16:19], s32 offen offset:0 sc1
  buffer_store_dwordx4 v[216:219], v10, s[16:19], s32 offen offset:1024 sc1
  buffer_store_dwordx4 v[220:223], v10, s[16:19], s32 offen offset:2048 sc1
  buffer_store_dwordx4 v[224:227], v10, s[16:19], s32 offen offset:3072 sc1
  s_add_u32 s32, s32, 4096
  buffer_store_dwordx4 v[228:231], v10, s[16:19], s32 offen offset:0 sc1
  buffer_store_dwordx4 v[232:235], v10, s[16:19], s32 offen offset:1024 sc1
  buffer_store_dwordx4 v[236:239], v10, s[16:19], s32 offen offset:2048 sc1
  buffer_store_dwordx4 v[240:243], v10, s[16:19], s32 offen offset:3072 sc1
  v_mov_b32 v12, 152592
  v_mov_b32 v13, 1
  s_mov_b64 exec, 1
  ds_add_u32 v12, v13
  s_mov_b64 exec, -1
  s_waitcnt vmcnt(0)
  s_lshr_b32 s80, s72, 1
  s_lshl_b32 s81, s73, 1
  s_add_u32 s80, s80, s81
  s_lshl_b32 s80, s80, 8
  s_lshl_b32 s81, s74, 1
  s_and_b32 s82, s72, 1
  s_add_u32 s81, s81, s82
  s_lshl_b32 s82, s81, 2
  s_cmp_ge_u32 s81, 18
  s_cselect_b32 s81, 56, 0
  s_add_u32 s80, s80, s82
  s_add_u32 s80, s80, s81
  s_add_u32 s80, s80, 17104896
  v_mov_b32 v10, s78
  v_mov_b32 v11, 0
  s_mov_b64 exec, 1
  buffer_store_dword v10, v11, s[16:19], s80 offen sc0 sc1
  s_mov_b64 exec, -1
  s_setprio 0
  s_add_u32 m0, s88, 0
  s_nop 0
  buffer_load_dwordx4 v1, s[16:19], s84 offen sc1 lds
  s_add_u32 s84, s84, 1024
  s_add_u32 m0, s88, 1024
  s_nop 0
  buffer_load_dwordx4 v1, s[16:19], s84 offen sc1 lds
  s_add_u32 s84, s84, 1024
  s_add_u32 m0, s88, 2048
  s_nop 0
  buffer_load_dwordx4 v1, s[16:19], s84 offen sc1 lds
  s_add_u32 s84, s84, 1024
  s_add_u32 m0, s88, 3072
  s_nop 0
  buffer_load_dwordx4 v1, s[16:19], s84 offen sc1 lds
  s_add_u32 s84, s84, 1024
  s_add_u32 m0, s88, 4096
  s_nop 0
  buffer_load_dwordx4 v1, s[16:19], s84 offen sc1 lds
  s_add_u32 s84, s84, 1024
  s_add_u32 m0, s88, 5120
  s_nop 0
  buffer_load_dwordx4 v1, s[16:19], s84 offen sc1 lds
  s_add_u32 s84, s84, 1024
  s_add_u32 m0, s88, 6144
  s_nop 0
  buffer_load_dwordx4 v1, s[16:19], s84 offen sc1 lds
  s_add_u32 s84, s84, 1024
  s_add_u32 m0, s88, 7168
  s_nop 0
  buffer_load_dwordx4 v1, s[16:19], s84 offen sc1 lds
  s_add_u32 s84, s84, 1024
  s_add_u32 m0, s88, 8192
  s_nop 0
  buffer_load_dwordx4 v1, s[16:19], s84 offen sc1 lds
  s_add_u32 s84, s84, 1024
  s_add_u32 m0, s88, 9216
  s_nop 0
  buffer_load_dwordx4 v1, s[16:19], s84 offen sc1 lds
  s_add_u32 s84, s84, 1024
  s_add_u32 m0, s88, 10240
  s_nop 0
  buffer_load_dwordx4 v1, s[16:19], s84 offen sc1 lds
  s_add_u32 s84, s84, 1024
  s_add_u32 m0, s88, 11264
  s_nop 0
  buffer_load_dwordx4 v1, s[16:19], s84 offen sc1 lds
  s_add_u32 s84, s84, 1024
  s_add_u32 m0, s88, 12288
  s_nop 0
  buffer_load_dwordx4 v1, s[16:19], s84 offen sc1 lds
  s_add_u32 s84, s84, 1024
  s_add_u32 m0, s88, 13312
  s_nop 0
  buffer_load_dwordx4 v1, s[16:19], s84 offen sc1 lds
  s_add_u32 s84, s84, 1024
  s_add_u32 m0, s88, 14336
  s_nop 0
  buffer_load_dwordx4 v1, s[16:19], s84 offen sc1 lds
  s_add_u32 s84, s84, 1024
  s_branch L_SSM_P2b
L_CONS_U:
  s_lshr_b32 s80, s72, 1
  s_lshl_b32 s80, s80, 13
  v_and_b32 v10, 15, v0
  v_lshlrev_b32 v10, 7, v10
  v_lshrrev_b32 v11, 4, v0
  v_and_b32 v12, 7, v0
  v_xor_b32 v11, v11, v12
  v_lshlrev_b32 v11, 4, v11
  v_add_u32 v10, v10, v11
  v_add_u32 v2, s80, v10
  v_xor_b32 v3, 64, v2
  s_and_b32 s81, s72, 1
  s_mul_i32 s81, s81, 12288
  s_add_u32 s81, s81, 16384
  v_add_u32 v4, s81, v10
  v_xor_b32 v5, 64, v4
  s_waitcnt vmcnt(0)
  s_cmp_ge_u32 s3, 54
  s_cbranch_scc1 L_PF_storeU
  v_lshrrev_b32 v10, 4, v0
  v_lshlrev_b32 v10, 2, v10
  v_bfe_u32 v11, v0, 2, 2
  v_add_u32 v10, v10, v11
  v_mul_u32_u24 v10, 160, v10
  v_and_b32 v11, 3, v0
  v_lshlrev_b32 v11, 3, v11
  v_add_u32 v10, v10, v11
  s_mul_i32 s81, s72, 5120
  s_add_u32 s81, s81, 122880
  v_add_u32 v10, s81, v10
  ds_read_b64_tr_b16 v[16:17], v10 offset:0
  ds_read_b64_tr_b16 v[18:19], v10 offset:2560
  ds_read_b64_tr_b16 v[20:21], v10 offset:32
  ds_read_b64_tr_b16 v[22:23], v10 offset:2592
  ds_read_b64_tr_b16 v[24:25], v10 offset:64
  ds_read_b64_tr_b16 v[26:27], v10 offset:2624
  ds_read_b64_tr_b16 v[28:29], v10 offset:96
  ds_read_b64_tr_b16 v[30:31], v10 offset:2656
  ds_read_b64_tr_b16 v[32:33], v10 offset:128
  ds_read_b64_tr_b16 v[34:35], v10 offset:2688
  s_waitcnt lgkmcnt(0)
L_PF_storeU:
  s_mul_i32 s80, s35, 94
  s_add_u32 s80, s80, s3
  s_mul_i32 s80, s80, 5120
  s_add_u32 s80, s80, 12582912
  v_lshlrev_b32 v10, 4, v0
  v_mov_b32 v11, 0x10000000
  s_cmp_ge_u32 s3, 94
  s_cselect_b32 s81, 1, 0
  v_mov_b32 v12, s81
  v_cmp_eq_u32 vcc, 1, v12
  s_nop 1
  v_cndmask_b32 v10, v10, v11, vcc
  buffer_store_dwordx4 v[16:19], v10, s[16:19], s80 offen offset:0 sc1
  buffer_store_dwordx4 v[20:23], v10, s[16:19], s80 offen offset:1024 sc1
  buffer_store_dwordx4 v[24:27], v10, s[16:19], s80 offen offset:2048 sc1
  buffer_store_dwordx4 v[28:31], v10, s[16:19], s80 offen offset:3072 sc1
  s_add_u32 s80, s80, 4096
  buffer_store_dwordx4 v[32:35], v10, s[16:19], s80 offen sc1
  s_mov_b32 s20, s68
  s_mov_b32 s21, s69
  s_mov_b32 s22, 256
  s_mov_b32 s23, 0x20000
  v_mov_b32 v248, 0
  s_mov_b32 s86, 1
  s_mov_b32 s88, 0
  s_mov_b32 s89, 40960
  s_mov_b32 s90, 4294885376
  s_waitcnt lgkmcnt(0)
  s_barrier
  ds_read_b128 v[176:179], v4 offset:0
  ds_read_b128 v[160:163], v2 offset:0
  ds_read_b128 v[164:167], v2 offset:2048
  ds_read_b128 v[168:171], v2 offset:4096
  ds_read_b128 v[172:175], v2 offset:6144
  ds_read_b128 v[180:183], v4 offset:2048
  ds_read_b128 v[184:187], v4 offset:4096
  ds_read_b128 v[188:191], v4 offset:6144
  ds_read_b128 v[192:195], v4 offset:8192
  ds_read_b128 v[196:199], v4 offset:10240
  s_waitcnt lgkmcnt(0)
  v_mfma_f32_16x16x32_bf16 v[64:67], v[160:163], v[176:179], 0
  ds_read_b128 v[216:219], v5 offset:0
  v_mfma_f32_16x16x32_bf16 v[88:91], v[164:167], v[176:179], 0
  ds_read_b128 v[200:203], v3 offset:0
  v_mfma_f32_16x16x32_bf16 v[112:115], v[168:171], v[176:179], 0
  ds_read_b128 v[204:207], v3 offset:2048
  v_mfma_f32_16x16x32_bf16 v[136:139], v[172:175], v[176:179], 0
  ds_read_b128 v[208:211], v3 offset:4096
  v_mfma_f32_16x16x32_bf16 v[68:71], v[160:163], v[180:183], 0
  ds_read_b128 v[212:215], v3 offset:6144
  v_mfma_f32_16x16x32_bf16 v[92:95], v[164:167], v[180:183], 0
  ds_read_b128 v[220:223], v5 offset:2048
  v_mfma_f32_16x16x32_bf16 v[116:119], v[168:171], v[180:183], 0
  ds_read_b128 v[224:227], v5 offset:4096
  v_mfma_f32_16x16x32_bf16 v[140:143], v[172:175], v[180:183], 0
  ds_read_b128 v[228:231], v5 offset:6144
  v_mfma_f32_16x16x32_bf16 v[72:75], v[160:163], v[184:187], 0
  ds_read_b128 v[232:235], v5 offset:8192
  v_mfma_f32_16x16x32_bf16 v[96:99], v[164:167], v[184:187], 0
  ds_read_b128 v[236:239], v5 offset:10240
  v_mfma_f32_16x16x32_bf16 v[120:123], v[168:171], v[184:187], 0
  s_add_u32 s88, s88, 1
  v_mfma_f32_16x16x32_bf16 v[144:147], v[172:175], v[184:187], 0
  s_cmp_eq_u32 s88, 3
  v_mfma_f32_16x16x32_bf16 v[76:79], v[160:163], v[188:191], 0
  s_cselect_b32 s87, s90, s89
  v_mfma_f32_16x16x32_bf16 v[100:103], v[164:167], v[188:191], 0
  s_cselect_b32 s88, 0, s88
  v_mfma_f32_16x16x32_bf16 v[124:127], v[168:171], v[188:191], 0
  v_add_u32 v2, s87, v2
  v_mfma_f32_16x16x32_bf16 v[148:151], v[172:175], v[188:191], 0
  v_add_u32 v3, s87, v3
  v_mfma_f32_16x16x32_bf16 v[80:83], v[160:163], v[192:195], 0
  v_add_u32 v4, s87, v4
  v_mfma_f32_16x16x32_bf16 v[104:107], v[164:167], v[192:195], 0
  v_add_u32 v5, s87, v5
  v_mfma_f32_16x16x32_bf16 v[128:131], v[168:171], v[192:195], 0
  v_mfma_f32_16x16x32_bf16 v[152:155], v[172:175], v[192:195], 0
  v_mfma_f32_16x16x32_bf16 v[84:87], v[160:163], v[196:199], 0
  v_mfma_f32_16x16x32_bf16 v[108:111], v[164:167], v[196:199], 0
  v_mfma_f32_16x16x32_bf16 v[132:135], v[168:171], v[196:199], 0
  v_mfma_f32_16x16x32_bf16 v[156:159], v[172:175], v[196:199], 0
  s_waitcnt lgkmcnt(0)
L_ML_U:
  s_barrier
  v_mfma_f32_16x16x32_bf16 v[64:67], v[200:203], v[216:219], v[64:67]
  ds_read_b128 v[176:179], v4 offset:0
  v_mfma_f32_16x16x32_bf16 v[88:91], v[204:207], v[216:219], v[88:91]
  ds_read_b128 v[160:163], v2 offset:0
  v_mfma_f32_16x16x32_bf16 v[112:115], v[208:211], v[216:219], v[112:115]
  ds_read_b128 v[164:167], v2 offset:2048
  v_mfma_f32_16x16x32_bf16 v[136:139], v[212:215], v[216:219], v[136:139]
  ds_read_b128 v[168:171], v2 offset:4096
  v_mfma_f32_16x16x32_bf16 v[68:71], v[200:203], v[220:223], v[68:71]
  ds_read_b128 v[172:175], v2 offset:6144
  v_mfma_f32_16x16x32_bf16 v[92:95], v[204:207], v[220:223], v[92:95]
  ds_read_b128 v[180:183], v4 offset:2048
  v_mfma_f32_16x16x32_bf16 v[116:119], v[208:211], v[220:223], v[116:119]
  ds_read_b128 v[184:187], v4 offset:4096
  v_mfma_f32_16x16x32_bf16 v[140:143], v[212:215], v[220:223], v[140:143]
  ds_read_b128 v[188:191], v4 offset:6144
  v_mfma_f32_16x16x32_bf16 v[72:75], v[200:203], v[224:227], v[72:75]
  ds_read_b128 v[192:195], v4 offset:8192
  v_mfma_f32_16x16x32_bf16 v[96:99], v[204:207], v[224:227], v[96:99]
  ds_read_b128 v[196:199], v4 offset:10240
  v_mfma_f32_16x16x32_bf16 v[120:123], v[208:211], v[224:227], v[120:123]
  v_mfma_f32_16x16x32_bf16 v[144:147], v[212:215], v[224:227], v[144:147]
  v_mfma_f32_16x16x32_bf16 v[76:79], v[200:203], v[228:231], v[76:79]
  v_mfma_f32_16x16x32_bf16 v[100:103], v[204:207], v[228:231], v[100:103]
  v_mfma_f32_16x16x32_bf16 v[124:127], v[208:211], v[228:231], v[124:127]
  v_mfma_f32_16x16x32_bf16 v[148:151], v[212:215], v[228:231], v[148:151]
  v_mfma_f32_16x16x32_bf16 v[80:83], v[200:203], v[232:235], v[80:83]
  v_mfma_f32_16x16x32_bf16 v[104:107], v[204:207], v[232:235], v[104:107]
  v_mfma_f32_16x16x32_bf16 v[128:131], v[208:211], v[232:235], v[128:131]
  v_mfma_f32_16x16x32_bf16 v[152:155], v[212:215], v[232:235], v[152:155]
  v_mfma_f32_16x16x32_bf16 v[84:87], v[200:203], v[236:239], v[84:87]
  v_mfma_f32_16x16x32_bf16 v[108:111], v[204:207], v[236:239], v[108:111]
  v_mfma_f32_16x16x32_bf16 v[132:135], v[208:211], v[236:239], v[132:135]
  v_mfma_f32_16x16x32_bf16 v[156:159], v[212:215], v[236:239], v[156:159]
  s_cmp_eq_u32 s86, 1
  s_cbranch_scc0 L_ML_h1_U
  buffer_load_dword v249, v248, s[20:23], 0 offen
L_ML_h1_U:
  s_cmp_eq_u32 s86, 4
  s_cbranch_scc0 L_ML_h2_U
  s_waitcnt vmcnt(0)
  v_readfirstlane_b32 s78, v249
  s_nop 0
  s_cmp_eq_u32 s78, 0
  s_cbranch_scc0 L_ML_h2b_U
  s_mov_b32 s20, s68
  s_mov_b32 s21, s69
  s_mov_b32 s22, 256
  s_mov_b32 s23, 0x20000
  v_mov_b32 v11, 0
  s_mov_b32 s80, 0
L_nonce_HU:
  buffer_load_dword v10, v11, s[20:23], 0 offen sc1
  s_add_u32 s80, s80, 1
  s_waitcnt vmcnt(0)
  v_readfirstlane_b32 s78, v10
  s_cmp_ge_u32 s80, 2000000
  s_cbranch_scc1 L_nonce_done_HU
  s_cmp_eq_u32 s78, 0
  s_cbranch_scc0 L_nonce_done_HU
  s_sleep 1
  s_branch L_nonce_HU
L_nonce_done_HU:
L_ML_h2b_U:
  s_lshl_b32 s80, s35, 9
  s_lshl_b32 s81, s3, 2
  s_add_u32 s80, s80, s81
  s_add_u32 s80, s80, 17039360
  v_mov_b32 v10, s78
  s_cmp_ge_u32 s3, 94
  s_cselect_b32 s81, 0x10000000, 0
  v_mov_b32 v11, s81
  s_mov_b64 exec, 1
  buffer_store_dword v10, v11, s[16:19], s80 offen sc0 sc1
  s_mov_b64 exec, -1
L_ML_h2_U:
  s_waitcnt lgkmcnt(0)
  v_mfma_f32_16x16x32_bf16 v[64:67], v[160:163], v[176:179], v[64:67]
  ds_read_b128 v[216:219], v5 offset:0
  v_mfma_f32_16x16x32_bf16 v[88:91], v[164:167], v[176:179], v[88:91]
  ds_read_b128 v[200:203], v3 offset:0
  v_mfma_f32_16x16x32_bf16 v[112:115], v[168:171], v[176:179], v[112:115]
  ds_read_b128 v[204:207], v3 offset:2048
  v_mfma_f32_16x16x32_bf16 v[136:139], v[172:175], v[176:179], v[136:139]
  ds_read_b128 v[208:211], v3 offset:4096
  v_mfma_f32_16x16x32_bf16 v[68:71], v[160:163], v[180:183], v[68:71]
  ds_read_b128 v[212:215], v3 offset:6144
  v_mfma_f32_16x16x32_bf16 v[92:95], v[164:167], v[180:183], v[92:95]
  ds_read_b128 v[220:223], v5 offset:2048
  v_mfma_f32_16x16x32_bf16 v[116:119], v[168:171], v[180:183], v[116:119]
  ds_read_b128 v[224:227], v5 offset:4096
  v_mfma_f32_16x16x32_bf16 v[140:143], v[172:175], v[180:183], v[140:143]
  ds_read_b128 v[228:231], v5 offset:6144
  v_mfma_f32_16x16x32_bf16 v[72:75], v[160:163], v[184:187], v[72:75]
  ds_read_b128 v[232:235], v5 offset:8192
  v_mfma_f32_16x16x32_bf16 v[96:99], v[164:167], v[184:187], v[96:99]
  ds_read_b128 v[236:239], v5 offset:10240
  v_mfma_f32_16x16x32_bf16 v[120:123], v[168:171], v[184:187], v[120:123]
  s_add_u32 s88, s88, 1
  v_mfma_f32_16x16x32_bf16 v[144:147], v[172:175], v[184:187], v[144:147]
  s_cmp_eq_u32 s88, 3
  v_mfma_f32_16x16x32_bf16 v[76:79], v[160:163], v[188:191], v[76:79]
  s_cselect_b32 s87, s90, s89
  v_mfma_f32_16x16x32_bf16 v[100:103], v[164:167], v[188:191], v[100:103]
  s_cselect_b32 s88, 0, s88
  v_mfma_f32_16x16x32_bf16 v[124:127], v[168:171], v[188:191], v[124:127]
  v_add_u32 v2, s87, v2
  v_mfma_f32_16x16x32_bf16 v[148:151], v[172:175], v[188:191], v[148:151]
  v_add_u32 v3, s87, v3
  v_mfma_f32_16x16x32_bf16 v[80:83], v[160:163], v[192:195], v[80:83]
  v_add_u32 v4, s87, v4
  v_mfma_f32_16x16x32_bf16 v[104:107], v[164:167], v[192:195], v[104:107]
  v_add_u32 v5, s87, v5
  v_mfma_f32_16x16x32_bf16 v[128:131], v[168:171], v[192:195], v[128:131]
  s_add_u32 s86, s86, 1
  v_mfma_f32_16x16x32_bf16 v[152:155], v[172:175], v[192:195], v[152:155]
  s_cmp_lt_u32 s86, 10
  v_mfma_f32_16x16x32_bf16 v[84:87], v[160:163], v[196:199], v[84:87]
  v_mfma_f32_16x16x32_bf16 v[108:111], v[164:167], v[196:199], v[108:111]
  v_mfma_f32_16x16x32_bf16 v[132:135], v[168:171], v[196:199], v[132:135]
  v_mfma_f32_16x16x32_bf16 v[156:159], v[172:175], v[196:199], v[156:159]
  s_waitcnt lgkmcnt(0)
  s_cbranch_scc1 L_ML_U
  v_mov_b32 v10, 152600
  v_mov_b32 v11, 1
  s_mov_b64 exec, 1
  ds_add_u32 v10, v11
  s_mov_b64 exec, -1
  s_mul_i32 s87, s72, 10
  s_add_u32 s87, s87, 54
  s_lshl_b32 s89, s77, 9
  s_lshl_b32 s90, s87, 2
  s_add_u32 s89, s89, s90
  s_add_u32 s35, s89, 17039360
  v_lshlrev_b32 v8, 2, v0
  buffer_load_dword v1, v8, s[16:19], s35 offen sc1
  v_mfma_f32_16x16x32_bf16 v[64:67], v[200:203], v[216:219], v[64:67]
  v_mfma_f32_16x16x32_bf16 v[88:91], v[204:207], v[216:219], v[88:91]
  v_mfma_f32_16x16x32_bf16 v[112:115], v[208:211], v[216:219], v[112:115]
  v_mfma_f32_16x16x32_bf16 v[136:139], v[212:215], v[216:219], v[136:139]
  v_mfma_f32_16x16x32_bf16 v[68:71], v[200:203], v[220:223], v[68:71]
  v_mfma_f32_16x16x32_bf16 v[92:95], v[204:207], v[220:223], v[92:95]
  v_mfma_f32_16x16x32_bf16 v[116:119], v[208:211], v[220:223], v[116:119]
  v_mfma_f32_16x16x32_bf16 v[140:143], v[212:215], v[220:223], v[140:143]
  v_mfma_f32_16x16x32_bf16 v[72:75], v[200:203], v[224:227], v[72:75]
  v_mfma_f32_16x16x32_bf16 v[96:99], v[204:207], v[224:227], v[96:99]
  v_mfma_f32_16x16x32_bf16 v[120:123], v[208:211], v[224:227], v[120:123]
  v_mfma_f32_16x16x32_bf16 v[144:147], v[212:215], v[224:227], v[144:147]
  v_mfma_f32_16x16x32_bf16 v[76:79], v[200:203], v[228:231], v[76:79]
  v_mfma_f32_16x16x32_bf16 v[100:103], v[204:207], v[228:231], v[100:103]
  v_mfma_f32_16x16x32_bf16 v[124:127], v[208:211], v[228:231], v[124:127]
  v_mfma_f32_16x16x32_bf16 v[148:151], v[212:215], v[228:231], v[148:151]
  v_mfma_f32_16x16x32_bf16 v[80:83], v[200:203], v[232:235], v[80:83]
  v_mfma_f32_16x16x32_bf16 v[104:107], v[204:207], v[232:235], v[104:107]
  v_mfma_f32_16x16x32_bf16 v[128:131], v[208:211], v[232:235], v[128:131]
  v_mfma_f32_16x16x32_bf16 v[152:155], v[212:215], v[232:235], v[152:155]
  v_mfma_f32_16x16x32_bf16 v[84:87], v[200:203], v[236:239], v[84:87]
  v_mfma_f32_16x16x32_bf16 v[108:111], v[204:207], v[236:239], v[108:111]
  v_mfma_f32_16x16x32_bf16 v[132:135], v[208:211], v[236:239], v[132:135]
  v_mfma_f32_16x16x32_bf16 v[156:159], v[212:215], v[236:239], v[156:159]
  s_setprio 3
  s_and_b32 s81, s72, 1
  s_mul_i32 s81, s81, 384
  s_add_u32 s81, s81, 143360
  v_and_b32 v10, 15, v0
  v_lshlrev_b32 v10, 3, v10
  v_add_u32 v10, s81, v10
  v_lshrrev_b32 v11, 4, v0
  v_mul_u32_u24 v11, 768, v11
  v_add_u32 v11, v11, v10
  ds_read_b64 v[160:161], v10 offset:0
  ds_read_b64 v[162:163], v10 offset:768
  ds_read_b64 v[164:165], v10 offset:2304
  ds_read_b64 v[168:169], v10 offset:4608
  ds_read_b64 v[170:171], v10 offset:5376
  ds_read_b64 v[172:173], v10 offset:6144
  ds_read_b64 v[174:175], v10 offset:6912
  ds_read_b64 v[176:177], v10 offset:7680
  ds_read_b64 v[166:167], v11 offset:1536
  ds_read_b64 v[178:179], v10 offset:128
  ds_read_b64 v[180:181], v10 offset:896
  ds_read_b64 v[182:183], v10 offset:2432
  ds_read_b64 v[186:187], v10 offset:4736
  ds_read_b64 v[188:189], v10 offset:5504
  ds_read_b64 v[190:191], v10 offset:6272
  ds_read_b64 v[192:193], v10 offset:7040
  ds_read_b64 v[194:195], v10 offset:7808
  ds_read_b64 v[184:185], v11 offset:1664
  ds_read_b64 v[196:197], v10 offset:256
  ds_read_b64 v[198:199], v10 offset:1024
  ds_read_b64 v[200:201], v10 offset:2560
  ds_read_b64 v[204:205], v10 offset:4864
  ds_read_b64 v[206:207], v10 offset:5632
  ds_read_b64 v[208:209], v10 offset:6400
  ds_read_b64 v[210:211], v10 offset:7168
  ds_read_b64 v[212:213], v10 offset:7936
  ds_read_b64 v[202:203], v11 offset:1792
  s_waitcnt lgkmcnt(0)
  v_mov_b32 v2, v161
  v_mov_b32 v252, v179
  v_mov_b32 v254, v197
  v_pk_fma_f32 v[20:21], v[64:65], v[160:161], v[66:67] op_sel:[0,0,0] op_sel_hi:[1,0,1]
  v_pk_fma_f32 v[22:23], v[68:69], v[160:161], v[70:71] op_sel:[0,0,0] op_sel_hi:[1,0,1]
  v_pk_fma_f32 v[28:29], v[72:73], v[178:179], v[74:75] op_sel:[0,0,0] op_sel_hi:[1,0,1]
  v_pk_fma_f32 v[30:31], v[76:77], v[178:179], v[78:79] op_sel:[0,0,0] op_sel_hi:[1,0,1]
  v_pk_fma_f32 v[36:37], v[80:81], v[196:197], v[82:83] op_sel:[0,0,0] op_sel_hi:[1,0,1]
  v_pk_fma_f32 v[38:39], v[84:85], v[196:197], v[86:87] op_sel:[0,0,0] op_sel_hi:[1,0,1]
  v_pk_fma_f32 v[20:21], v[68:69], v[2:3], v[20:21] op_sel:[0,0,0] op_sel_hi:[1,0,1] neg_lo:[0,1,0] neg_hi:[0,1,0]
  v_pk_fma_f32 v[22:23], v[64:65], v[2:3], v[22:23] op_sel:[0,0,0] op_sel_hi:[1,0,1]
  v_pk_fma_f32 v[28:29], v[76:77], v[252:253], v[28:29] op_sel:[0,0,0] op_sel_hi:[1,0,1] neg_lo:[0,1,0] neg_hi:[0,1,0]
  v_pk_fma_f32 v[30:31], v[72:73], v[252:253], v[30:31] op_sel:[0,0,0] op_sel_hi:[1,0,1]
  v_pk_fma_f32 v[36:37], v[84:85], v[254:255], v[36:37] op_sel:[0,0,0] op_sel_hi:[1,0,1] neg_lo:[0,1,0] neg_hi:[0,1,0]
  v_pk_fma_f32 v[38:39], v[80:81], v[254:255], v[38:39] op_sel:[0,0,0] op_sel_hi:[1,0,1]
  v_pk_fma_f32 v[16:17], v[20:21], v[160:161], v[88:89] op_sel:[0,0,0] op_sel_hi:[1,0,1]
  v_pk_fma_f32 v[18:19], v[22:23], v[160:161], v[92:93] op_sel:[0,0,0] op_sel_hi:[1,0,1]
  v_pk_fma_f32 v[24:25], v[28:29], v[178:179], v[96:97] op_sel:[0,0,0] op_sel_hi:[1,0,1]
  v_pk_fma_f32 v[26:27], v[30:31], v[178:179], v[100:101] op_sel:[0,0,0] op_sel_hi:[1,0,1]
  v_pk_fma_f32 v[32:33], v[36:37], v[196:197], v[104:105] op_sel:[0,0,0] op_sel_hi:[1,0,1]
  v_pk_fma_f32 v[34:35], v[38:39], v[196:197], v[108:109] op_sel:[0,0,0] op_sel_hi:[1,0,1]
  v_pk_fma_f32 v[16:17], v[22:23], v[2:3], v[16:17] op_sel:[0,0,0] op_sel_hi:[1,0,1] neg_lo:[0,1,0] neg_hi:[0,1,0]
  v_pk_fma_f32 v[18:19], v[20:21], v[2:3], v[18:19] op_sel:[0,0,0] op_sel_hi:[1,0,1]
  v_pk_fma_f32 v[24:25], v[30:31], v[252:253], v[24:25] op_sel:[0,0,0] op_sel_hi:[1,0,1] neg_lo:[0,1,0] neg_hi:[0,1,0]
  v_pk_fma_f32 v[26:27], v[28:29], v[252:253], v[26:27] op_sel:[0,0,0] op_sel_hi:[1,0,1]
  v_pk_fma_f32 v[32:33], v[38:39], v[254:255], v[32:33] op_sel:[0,0,0] op_sel_hi:[1,0,1] neg_lo:[0,1,0] neg_hi:[0,1,0]
  v_pk_fma_f32 v[34:35], v[36:37], v[254:255], v[34:35] op_sel:[0,0,0] op_sel_hi:[1,0,1]
  v_pk_fma_f32 v[20:21], v[16:17], v[160:161], v[90:91] op_sel:[0,0,0] op_sel_hi:[1,0,1]
  v_pk_fma_f32 v[22:23], v[18:19], v[160:161], v[94:95] op_sel:[0,0,0] op_sel_hi:[1,0,1]
  v_pk_fma_f32 v[28:29], v[24:25], v[178:179], v[98:99] op_sel:[0,0,0] op_sel_hi:[1,0,1]
  v_pk_fma_f32 v[30:31], v[26:27], v[178:179], v[102:103] op_sel:[0,0,0] op_sel_hi:[1,0,1]
  v_pk_fma_f32 v[36:37], v[32:33], v[196:197], v[106:107] op_sel:[0,0,0] op_sel_hi:[1,0,1]
  v_pk_fma_f32 v[38:39], v[34:35], v[196:197], v[110:111] op_sel:[0,0,0] op_sel_hi:[1,0,1]
  v_pk_fma_f32 v[20:21], v[18:19], v[2:3], v[20:21] op_sel:[0,0,0] op_sel_hi:[1,0,1] neg_lo:[0,1,0] neg_hi:[0,1,0]
  v_pk_fma_f32 v[22:23], v[16:17], v[2:3], v[22:23] op_sel:[0,0,0] op_sel_hi:[1,0,1]
  v_pk_fma_f32 v[28:29], v[26:27], v[252:253], v[28:29] op_sel:[0,0,0] op_sel_hi:[1,0,1] neg_lo:[0,1,0] neg_hi:[0,1,0]
  v_pk_fma_f32 v[30:31], v[24:25], v[252:253], v[30:31] op_sel:[0,0,0] op_sel_hi:[1,0,1]
  v_pk_fma_f32 v[36:37], v[34:35], v[254:255], v[36:37] op_sel:[0,0,0] op_sel_hi:[1,0,1] neg_lo:[0,1,0] neg_hi:[0,1,0]
  v_pk_fma_f32 v[38:39], v[32:33], v[254:255], v[38:39] op_sel:[0,0,0] op_sel_hi:[1,0,1]
  v_pk_fma_f32 v[16:17], v[20:21], v[160:161], v[112:113] op_sel:[0,0,0] op_sel_hi:[1,0,1]
  v_pk_fma_f32 v[18:19], v[22:23], v[160:161], v[116:117] op_sel:[0,0,0] op_sel_hi:[1,0,1]
  v_pk_fma_f32 v[24:25], v[28:29], v[178:179], v[120:121] op_sel:[0,0,0] op_sel_hi:[1,0,1]
  v_pk_fma_f32 v[26:27], v[30:31], v[178:179], v[124:125] op_sel:[0,0,0] op_sel_hi:[1,0,1]
  v_pk_fma_f32 v[32:33], v[36:37], v[196:197], v[128:129] op_sel:[0,0,0] op_sel_hi:[1,0,1]
  v_pk_fma_f32 v[34:35], v[38:39], v[196:197], v[132:133] op_sel:[0,0,0] op_sel_hi:[1,0,1]
  v_pk_fma_f32 v[16:17], v[22:23], v[2:3], v[16:17] op_sel:[0,0,0] op_sel_hi:[1,0,1] neg_lo:[0,1,0] neg_hi:[0,1,0]
  v_pk_fma_f32 v[18:19], v[20:21], v[2:3], v[18:19] op_sel:[0,0,0] op_sel_hi:[1,0,1]
  v_pk_fma_f32 v[24:25], v[30:31], v[252:253], v[24:25] op_sel:[0,0,0] op_sel_hi:[1,0,1] neg_lo:[0,1,0] neg_hi:[0,1,0]
  v_pk_fma_f32 v[26:27], v[28:29], v[252:253], v[26:27] op_sel:[0,0,0] op_sel_hi:[1,0,1]
  v_pk_fma_f32 v[32:33], v[38:39], v[254:255], v[32:33] op_sel:[0,0,0] op_sel_hi:[1,0,1] neg_lo:[0,1,0] neg_hi:[0,1,0]
  v_pk_fma_f32 v[34:35], v[36:37], v[254:255], v[34:35] op_sel:[0,0,0] op_sel_hi:[1,0,1]
  v_pk_fma_f32 v[20:21], v[16:17], v[160:161], v[114:115] op_sel:[0,0,0] op_sel_hi:[1,0,1]
  v_pk_fma_f32 v[22:23], v[18:19], v[160:161], v[118:119] op_sel:[0,0,0] op_sel_hi:[1,0,1]
  v_pk_fma_f32 v[28:29], v[24:25], v[178:179], v[122:123] op_sel:[0,0,0] op_sel_hi:[1,0,1]
  v_pk_fma_f32 v[30:31], v[26:27], v[178:179], v[126:127] op_sel:[0,0,0] op_sel_hi:[1,0,1]
  v_pk_fma_f32 v[36:37], v[32:33], v[196:197], v[130:131] op_sel:[0,0,0] op_sel_hi:[1,0,1]
  v_pk_fma_f32 v[38:39], v[34:35], v[196:197], v[134:135] op_sel:[0,0,0] op_sel_hi:[1,0,1]
  v_pk_fma_f32 v[20:21], v[18:19], v[2:3], v[20:21] op_sel:[0,0,0] op_sel_hi:[1,0,1] neg_lo:[0,1,0] neg_hi:[0,1,0]
  v_pk_fma_f32 v[22:23], v[16:17], v[2:3], v[22:23] op_sel:[0,0,0] op_sel_hi:[1,0,1]
  v_pk_fma_f32 v[28:29], v[26:27], v[252:253], v[28:29] op_sel:[0,0,0] op_sel_hi:[1,0,1] neg_lo:[0,1,0] neg_hi:[0,1,0]
  v_pk_fma_f32 v[30:31], v[24:25], v[252:253], v[30:31] op_sel:[0,0,0] op_sel_hi:[1,0,1]
  v_pk_fma_f32 v[36:37], v[34:35], v[254:255], v[36:37] op_sel:[0,0,0] op_sel_hi:[1,0,1] neg_lo:[0,1,0] neg_hi:[0,1,0]
  v_pk_fma_f32 v[38:39], v[32:33], v[254:255], v[38:39] op_sel:[0,0,0] op_sel_hi:[1,0,1]
  v_pk_fma_f32 v[16:17], v[20:21], v[160:161], v[136:137] op_sel:[0,0,0] op_sel_hi:[1,0,1]
  v_pk_fma_f32 v[18:19], v[22:23], v[160:161], v[140:141] op_sel:[0,0,0] op_sel_hi:[1,0,1]
  v_pk_fma_f32 v[24:25], v[28:29], v[178:179], v[144:145] op_sel:[0,0,0] op_sel_hi:[1,0,1]
  v_pk_fma_f32 v[26:27], v[30:31], v[178:179], v[148:149] op_sel:[0,0,0] op_sel_hi:[1,0,1]
  v_pk_fma_f32 v[32:33], v[36:37], v[196:197], v[152:153] op_sel:[0,0,0] op_sel_hi:[1,0,1]
  v_pk_fma_f32 v[34:35], v[38:39], v[196:197], v[156:157] op_sel:[0,0,0] op_sel_hi:[1,0,1]
  v_pk_fma_f32 v[16:17], v[22:23], v[2:3], v[16:17] op_sel:[0,0,0] op_sel_hi:[1,0,1] neg_lo:[0,1,0] neg_hi:[0,1,0]
  v_pk_fma_f32 v[18:19], v[20:21], v[2:3], v[18:19] op_sel:[0,0,0] op_sel_hi:[1,0,1]
  v_pk_fma_f32 v[24:25], v[30:31], v[252:253], v[24:25] op_sel:[0,0,0] op_sel_hi:[1,0,1] neg_lo:[0,1,0] neg_hi:[0,1,0]
  v_pk_fma_f32 v[26:27], v[28:29], v[252:253], v[26:27] op_sel:[0,0,0] op_sel_hi:[1,0,1]
  v_pk_fma_f32 v[32:33], v[38:39], v[254:255], v[32:33] op_sel:[0,0,0] op_sel_hi:[1,0,1] neg_lo:[0,1,0] neg_hi:[0,1,0]
  v_pk_fma_f32 v[34:35], v[36:37], v[254:255], v[34:35] op_sel:[0,0,0] op_sel_hi:[1,0,1]
  v_pk_fma_f32 v[20:21], v[16:17], v[160:161], v[138:139] op_sel:[0,0,0] op_sel_hi:[1,0,1]
  v_pk_fma_f32 v[22:23], v[18:19], v[160:161], v[142:143] op_sel:[0,0,0] op_sel_hi:[1,0,1]
  v_pk_fma_f32 v[28:29], v[24:25], v[178:179], v[146:147] op_sel:[0,0,0] op_sel_hi:[1,0,1]
  v_pk_fma_f32 v[30:31], v[26:27], v[178:179], v[150:151] op_sel:[0,0,0] op_sel_hi:[1,0,1]
  v_pk_fma_f32 v[36:37], v[32:33], v[196:197], v[154:155] op_sel:[0,0,0] op_sel_hi:[1,0,1]
  v_pk_fma_f32 v[38:39], v[34:35], v[196:197], v[158:159] op_sel:[0,0,0] op_sel_hi:[1,0,1]
  v_pk_fma_f32 v[20:21], v[18:19], v[2:3], v[20:21] op_sel:[0,0,0] op_sel_hi:[1,0,1] neg_lo:[0,1,0] neg_hi:[0,1,0]
  v_pk_fma_f32 v[22:23], v[16:17], v[2:3], v[22:23] op_sel:[0,0,0] op_sel_hi:[1,0,1]
  v_pk_fma_f32 v[28:29], v[26:27], v[252:253], v[28:29] op_sel:[0,0,0] op_sel_hi:[1,0,1] neg_lo:[0,1,0] neg_hi:[0,1,0]
  v_pk_fma_f32 v[30:31], v[24:25], v[252:253], v[30:31] op_sel:[0,0,0] op_sel_hi:[1,0,1]
  v_pk_fma_f32 v[36:37], v[34:35], v[254:255], v[36:37] op_sel:[0,0,0] op_sel_hi:[1,0,1] neg_lo:[0,1,0] neg_hi:[0,1,0]
  v_pk_fma_f32 v[38:39], v[32:33], v[254:255], v[38:39] op_sel:[0,0,0] op_sel_hi:[1,0,1]
  v_fma_f32 v16, v162, v20, v21
  v_fma_f32 v17, v162, v22, v23
  v_fma_f32 v16, -v163, v22, v16
  v_fma_f32 v17, v163, v20, v17
  v_fma_f32 v24, v180, v28, v29
  v_fma_f32 v25, v180, v30, v31
  v_fma_f32 v24, -v181, v30, v24
  v_fma_f32 v25, v181, v28, v25
  v_fma_f32 v32, v198, v36, v37
  v_fma_f32 v33, v198, v38, v39
  v_fma_f32 v32, -v199, v38, v32
  v_fma_f32 v33, v199, v36, v33
  v_mov_b32 v214, v16
  v_mov_b32 v216, v16
  s_nop 1
  v_permlane16_swap_b32 v214, v216
  v_mov_b32 v218, v214
  v_mov_b32 v220, v216
  s_nop 0
  v_permlane32_swap_b32 v214, v218
  v_permlane32_swap_b32 v216, v220
  v_mov_b32 v215, v17
  v_mov_b32 v217, v17
  s_nop 1
  v_permlane16_swap_b32 v215, v217
  v_mov_b32 v219, v215
  v_mov_b32 v221, v217
  s_nop 0
  v_permlane32_swap_b32 v215, v219
  v_permlane32_swap_b32 v217, v221
  v_mov_b32 v222, v24
  v_mov_b32 v224, v24
  s_nop 1
  v_permlane16_swap_b32 v222, v224
  v_mov_b32 v226, v222
  v_mov_b32 v228, v224
  s_nop 0
  v_permlane32_swap_b32 v222, v226
  v_permlane32_swap_b32 v224, v228
  v_mov_b32 v223, v25
  v_mov_b32 v225, v25
  s_nop 1
  v_permlane16_swap_b32 v223, v225
  v_mov_b32 v227, v223
  v_mov_b32 v229, v225
  s_nop 0
  v_permlane32_swap_b32 v223, v227
  v_permlane32_swap_b32 v225, v229
  v_mov_b32 v230, v32
  v_mov_b32 v232, v32
  s_nop 1
  v_permlane16_swap_b32 v230, v232
  v_mov_b32 v234, v230
  v_mov_b32 v236, v232
  s_nop 0
  v_permlane32_swap_b32 v230, v234
  v_permlane32_swap_b32 v232, v236
  v_mov_b32 v231, v33
  v_mov_b32 v233, v33
  s_nop 1
  v_permlane16_swap_b32 v231, v233
  v_mov_b32 v235, v231
  v_mov_b32 v237, v233
  s_nop 0
  v_permlane32_swap_b32 v231, v235
  v_permlane32_swap_b32 v233, v237
  v_fma_f32 v216, v164, v214, v216
  v_fma_f32 v217, v164, v215, v217
  v_fma_f32 v216, -v165, v215, v216
  v_fma_f32 v217, v165, v214, v217
  v_fma_f32 v224, v182, v222, v224
  v_fma_f32 v225, v182, v223, v225
  v_fma_f32 v224, -v183, v223, v224
  v_fma_f32 v225, v183, v222, v225
  v_fma_f32 v232, v200, v230, v232
  v_fma_f32 v233, v200, v231, v233
  v_fma_f32 v232, -v201, v231, v232
  v_fma_f32 v233, v201, v230, v233
  v_fma_f32 v218, v164, v216, v218
  v_fma_f32 v219, v164, v217, v219
  v_fma_f32 v218, -v165, v217, v218
  v_fma_f32 v219, v165, v216, v219
  v_fma_f32 v226, v182, v224, v226
  v_fma_f32 v227, v182, v225, v227
  v_fma_f32 v226, -v183, v225, v226
  v_fma_f32 v227, v183, v224, v227
  v_fma_f32 v234, v200, v232, v234
  v_fma_f32 v235, v200, v233, v235
  v_fma_f32 v234, -v201, v233, v234
  v_fma_f32 v235, v201, v232, v235
  v_fma_f32 v220, v164, v218, v220
  v_fma_f32 v221, v164, v219, v221
  v_fma_f32 v220, -v165, v219, v220
  v_fma_f32 v221, v165, v218, v221
  v_fma_f32 v228, v182, v226, v228
  v_fma_f32 v229, v182, v227, v229
  v_fma_f32 v228, -v183, v227, v228
  v_fma_f32 v229, v183, v226, v229
  v_fma_f32 v236, v200, v234, v236
  v_fma_f32 v237, v200, v235, v237
  v_fma_f32 v236, -v201, v235, v236
  v_fma_f32 v237, v201, v234, v237
  s_mov_b32 s80, 0xffff0000
  s_mov_b32 s81, 0
  s_mov_b32 s82, 0
  s_mov_b32 s83, 0x0000ffff
  s_mov_b32 s90, 0
  s_mov_b32 s91, 0xffff0000
  v_cndmask_b32 v16, 0, v214, s[80:81]
  v_cndmask_b32 v16, v16, v216, s[82:83]
  v_cndmask_b32 v16, v16, v218, s[90:91]
  v_cndmask_b32 v17, 0, v215, s[80:81]
  v_cndmask_b32 v17, v17, v217, s[82:83]
  v_cndmask_b32 v17, v17, v219, s[90:91]
  v_cndmask_b32 v24, 0, v222, s[80:81]
  v_cndmask_b32 v24, v24, v224, s[82:83]
  v_cndmask_b32 v24, v24, v226, s[90:91]
  v_cndmask_b32 v25, 0, v223, s[80:81]
  v_cndmask_b32 v25, v25, v225, s[82:83]
  v_cndmask_b32 v25, v25, v227, s[90:91]
  v_cndmask_b32 v32, 0, v230, s[80:81]
  v_cndmask_b32 v32, v32, v232, s[82:83]
  v_cndmask_b32 v32, v32, v234, s[90:91]
  v_cndmask_b32 v33, 0, v231, s[80:81]
  v_cndmask_b32 v33, v33, v233, s[82:83]
  v_cndmask_b32 v33, v33, v235, s[90:91]
  s_and_b32 s84, s72, 1
  s_mul_i32 s85, s84, 384
  s_add_u32 s85, s85, 151808
  v_and_b32 v10, 15, v0
  v_lshlrev_b32 v10, 3, v10
  v_add_u32 v10, s85, v10
  s_lshl_b32 s85, s84, 2
  s_add_u32 s85, s85, 152576
  v_mov_b32 v11, s85
  s_cmp_ge_u32 s72, 2
  s_cbranch_scc1 L_U_wt1
  ds_write_b64 v10, v[220:221] offset:0
  ds_write_b64 v10, v[228:229] offset:128
  ds_write_b64 v10, v[236:237] offset:256
  v_mov_b32 v12, 1
  s_waitcnt lgkmcnt(0)
  ds_write_b32 v11, v12
  s_branch L_U_lb
L_U_wt1:
  s_mov_b32 s85, 0
L_U_pairwait:
  ds_read_b32 v12, v11
  s_add_u32 s85, s85, 1
  s_waitcnt lgkmcnt(0)
  v_readfirstlane_b32 s86, v12
  s_cmp_ge_u32 s85, 2000000
  s_cbranch_scc1 L_U_pairok
  s_cmp_eq_u32 s86, 0
  s_cbranch_scc1 L_U_pairwait
L_U_pairok:
  ds_read_b64 v[214:215], v10 offset:0
  ds_read_b64 v[222:223], v10 offset:128
  ds_read_b64 v[230:231], v10 offset:256
  s_waitcnt lgkmcnt(0)
  v_fma_f32 v216, v168, v214, v220
  v_fma_f32 v217, v168, v215, v221
  v_fma_f32 v216, -v169, v215, v216
  v_fma_f32 v217, v169, v214, v217
  v_fma_f32 v224, v186, v222, v228
  v_fma_f32 v225, v186, v223, v229
  v_fma_f32 v224, -v187, v223, v224
  v_fma_f32 v225, v187, v222, v225
  v_fma_f32 v232, v204, v230, v236
  v_fma_f32 v233, v204, v231, v237
  v_fma_f32 v232, -v205, v231, v232
  v_fma_f32 v233, v205, v230, v233
  s_mov_b32 s80, 0xffff0000
  s_mov_b32 s81, 0
  s_mov_b32 s82, 0
  s_mov_b32 s83, 0x0000ffff
  v_cndmask_b32 v240, v216, v224, s[80:81]
  v_cndmask_b32 v241, v217, v225, s[80:81]
  v_cndmask_b32 v240, v240, v232, s[82:83]
  v_cndmask_b32 v241, v241, v233, s[82:83]
  v_mov_b32 v242, s78
  v_mov_b32 v243, s78
  s_mul_i32 s85, s75, 16
  s_add_u32 s85, s85, s73
  s_mul_i32 s85, s85, 96
  s_mul_i32 s86, s84, 48
  s_add_u32 s85, s85, s86
  s_lshl_b32 s85, s85, 4
  s_add_u32 s85, s85, 16842752
  v_lshlrev_b32 v12, 4, v0
  s_mov_b32 exec_lo, -1
  s_mov_b32 exec_hi, 0x0000ffff
  buffer_store_dwordx4 v[240:243], v12, s[16:19], s85 offen sc0 sc1
  s_mov_b64 exec, -1
L_U_lb:
  v_mov_b32 v12, 152592
  v_mov_b32 v13, 1
  s_mov_b64 exec, 1
  ds_add_u32 v12, v13
  s_mov_b64 exec, -1
  s_mul_i32 s85, s75, 1536
  s_mul_i32 s86, s84, 48
  s_add_u32 s85, s85, s86
  s_lshl_b32 s85, s85, 4
  s_add_u32 s85, s85, 16842752
  v_lshrrev_b32 v12, 4, v0
  v_lshlrev_b32 v12, 2, v12
  v_sub_u32 v12, s73, v12
  v_mov_b32 v9, 0x10000000
  v_and_b32 v13, 15, v0
  v_subrev_u32 v14, 1, v12
  v_cmp_le_i32 s[88:89], 0, v14
  v_mul_u32_u24 v15, 96, v14
  v_add_u32 v15, v15, v13
  v_lshlrev_b32 v15, 4, v15
  v_cndmask_b32 v4, v9, v15, s[88:89]
  v_subrev_u32 v14, 2, v12
  v_cmp_le_i32 s[90:91], 0, v14
  v_mul_u32_u24 v15, 96, v14
  v_add_u32 v15, v15, v13
  v_lshlrev_b32 v15, 4, v15
  v_cndmask_b32 v5, v9, v15, s[90:91]
  v_subrev_u32 v14, 3, v12
  v_cmp_le_i32 s[92:93], 0, v14
  v_mul_u32_u24 v15, 96, v14
  v_add_u32 v15, v15, v13
  v_lshlrev_b32 v15, 4, v15
  v_cndmask_b32 v6, v9, v15, s[92:93]
  v_subrev_u32 v14, 4, v12
  v_cmp_le_i32 s[94:95], 0, v14
  v_mul_u32_u24 v15, 96, v14
  v_add_u32 v15, v15, v13
  v_lshlrev_b32 v15, 4, v15
  v_cndmask_b32 v7, v9, v15, s[94:95]
  v_mov_b32 v8, v177
  v_mov_b32 v10, v195
  v_mov_b32 v238, v213
  v_pk_mul_f32 v[40:41], v[64:65], v[176:177] op_sel:[0,0] op_sel_hi:[1,0]
  v_pk_mul_f32 v[42:43], v[64:65], v[8:9] op_sel:[0,0] op_sel_hi:[1,0]
  v_pk_fma_f32 v[64:65], v[68:69], v[8:9], v[40:41] op_sel:[0,0,0] op_sel_hi:[1,0,1] neg_lo:[0,1,0] neg_hi:[0,1,0]
  v_pk_fma_f32 v[68:69], v[68:69], v[176:177], v[42:43] op_sel:[0,0,0] op_sel_hi:[1,0,1]
  v_pk_mul_f32 v[44:45], v[72:73], v[194:195] op_sel:[0,0] op_sel_hi:[1,0]
  v_pk_mul_f32 v[46:47], v[72:73], v[10:11] op_sel:[0,0] op_sel_hi:[1,0]
  v_pk_fma_f32 v[72:73], v[76:77], v[10:11], v[44:45] op_sel:[0,0,0] op_sel_hi:[1,0,1] neg_lo:[0,1,0] neg_hi:[0,1,0]
  v_pk_fma_f32 v[76:77], v[76:77], v[194:195], v[46:47] op_sel:[0,0,0] op_sel_hi:[1,0,1]
  v_pk_mul_f32 v[48:49], v[80:81], v[212:213] op_sel:[0,0] op_sel_hi:[1,0]
  v_pk_mul_f32 v[50:51], v[80:81], v[238:239] op_sel:[0,0] op_sel_hi:[1,0]
  v_pk_fma_f32 v[80:81], v[84:85], v[238:239], v[48:49] op_sel:[0,0,0] op_sel_hi:[1,0,1] neg_lo:[0,1,0] neg_hi:[0,1,0]
  v_pk_fma_f32 v[84:85], v[84:85], v[212:213], v[50:51] op_sel:[0,0,0] op_sel_hi:[1,0,1]
  v_pk_mul_f32 v[52:53], v[66:67], v[176:177] op_sel:[0,0] op_sel_hi:[1,0]
  v_pk_mul_f32 v[54:55], v[66:67], v[8:9] op_sel:[0,0] op_sel_hi:[1,0]
  v_pk_fma_f32 v[66:67], v[70:71], v[8:9], v[52:53] op_sel:[0,0,0] op_sel_hi:[1,0,1] neg_lo:[0,1,0] neg_hi:[0,1,0]
  v_pk_fma_f32 v[70:71], v[70:71], v[176:177], v[54:55] op_sel:[0,0,0] op_sel_hi:[1,0,1]
  v_pk_mul_f32 v[56:57], v[74:75], v[194:195] op_sel:[0,0] op_sel_hi:[1,0]
  v_pk_mul_f32 v[58:59], v[74:75], v[10:11] op_sel:[0,0] op_sel_hi:[1,0]
  v_pk_fma_f32 v[74:75], v[78:79], v[10:11], v[56:57] op_sel:[0,0,0] op_sel_hi:[1,0,1] neg_lo:[0,1,0] neg_hi:[0,1,0]
  v_pk_fma_f32 v[78:79], v[78:79], v[194:195], v[58:59] op_sel:[0,0,0] op_sel_hi:[1,0,1]
  v_pk_mul_f32 v[60:61], v[82:83], v[212:213] op_sel:[0,0] op_sel_hi:[1,0]
  v_pk_mul_f32 v[62:63], v[82:83], v[238:239] op_sel:[0,0] op_sel_hi:[1,0]
  v_pk_fma_f32 v[82:83], v[86:87], v[238:239], v[60:61] op_sel:[0,0,0] op_sel_hi:[1,0,1] neg_lo:[0,1,0] neg_hi:[0,1,0]
  v_pk_fma_f32 v[86:87], v[86:87], v[212:213], v[62:63] op_sel:[0,0,0] op_sel_hi:[1,0,1]
  v_pk_mul_f32 v[40:41], v[88:89], v[176:177] op_sel:[0,0] op_sel_hi:[1,0]
  v_pk_mul_f32 v[42:43], v[88:89], v[8:9] op_sel:[0,0] op_sel_hi:[1,0]
  v_pk_fma_f32 v[88:89], v[92:93], v[8:9], v[40:41] op_sel:[0,0,0] op_sel_hi:[1,0,1] neg_lo:[0,1,0] neg_hi:[0,1,0]
  v_pk_fma_f32 v[92:93], v[92:93], v[176:177], v[42:43] op_sel:[0,0,0] op_sel_hi:[1,0,1]
  v_pk_mul_f32 v[44:45], v[96:97], v[194:195] op_sel:[0,0] op_sel_hi:[1,0]
  v_pk_mul_f32 v[46:47], v[96:97], v[10:11] op_sel:[0,0] op_sel_hi:[1,0]
  v_pk_fma_f32 v[96:97], v[100:101], v[10:11], v[44:45] op_sel:[0,0,0] op_sel_hi:[1,0,1] neg_lo:[0,1,0] neg_hi:[0,1,0]
  v_pk_fma_f32 v[100:101], v[100:101], v[194:195], v[46:47] op_sel:[0,0,0] op_sel_hi:[1,0,1]
  v_pk_mul_f32 v[48:49], v[104:105], v[212:213] op_sel:[0,0] op_sel_hi:[1,0]
  v_pk_mul_f32 v[50:51], v[104:105], v[238:239] op_sel:[0,0] op_sel_hi:[1,0]
  v_pk_fma_f32 v[104:105], v[108:109], v[238:239], v[48:49] op_sel:[0,0,0] op_sel_hi:[1,0,1] neg_lo:[0,1,0] neg_hi:[0,1,0]
  v_pk_fma_f32 v[108:109], v[108:109], v[212:213], v[50:51] op_sel:[0,0,0] op_sel_hi:[1,0,1]
  v_pk_mul_f32 v[52:53], v[90:91], v[176:177] op_sel:[0,0] op_sel_hi:[1,0]
  v_pk_mul_f32 v[54:55], v[90:91], v[8:9] op_sel:[0,0] op_sel_hi:[1,0]
  v_pk_fma_f32 v[90:91], v[94:95], v[8:9], v[52:53] op_sel:[0,0,0] op_sel_hi:[1,0,1] neg_lo:[0,1,0] neg_hi:[0,1,0]
  v_pk_fma_f32 v[94:95], v[94:95], v[176:177], v[54:55] op_sel:[0,0,0] op_sel_hi:[1,0,1]
  v_pk_mul_f32 v[56:57], v[98:99], v[194:195] op_sel:[0,0] op_sel_hi:[1,0]
  v_pk_mul_f32 v[58:59], v[98:99], v[10:11] op_sel:[0,0] op_sel_hi:[1,0]
  v_pk_fma_f32 v[98:99], v[102:103], v[10:11], v[56:57] op_sel:[0,0,0] op_sel_hi:[1,0,1] neg_lo:[0,1,0] neg_hi:[0,1,0]
  v_pk_fma_f32 v[102:103], v[102:103], v[194:195], v[58:59] op_sel:[0,0,0] op_sel_hi:[1,0,1]
  v_pk_mul_f32 v[60:61], v[106:107], v[212:213] op_sel:[0,0] op_sel_hi:[1,0]
  v_pk_mul_f32 v[62:63], v[106:107], v[238:239] op_sel:[0,0] op_sel_hi:[1,0]
  v_pk_fma_f32 v[106:107], v[110:111], v[238:239], v[60:61] op_sel:[0,0,0] op_sel_hi:[1,0,1] neg_lo:[0,1,0] neg_hi:[0,1,0]
  v_pk_fma_f32 v[110:111], v[110:111], v[212:213], v[62:63] op_sel:[0,0,0] op_sel_hi:[1,0,1]
  v_pk_mul_f32 v[40:41], v[112:113], v[176:177] op_sel:[0,0] op_sel_hi:[1,0]
  v_pk_mul_f32 v[42:43], v[112:113], v[8:9] op_sel:[0,0] op_sel_hi:[1,0]
  v_pk_fma_f32 v[112:113], v[116:117], v[8:9], v[40:41] op_sel:[0,0,0] op_sel_hi:[1,0,1] neg_lo:[0,1,0] neg_hi:[0,1,0]
  v_pk_fma_f32 v[116:117], v[116:117], v[176:177], v[42:43] op_sel:[0,0,0] op_sel_hi:[1,0,1]
  v_pk_mul_f32 v[44:45], v[120:121], v[194:195] op_sel:[0,0] op_sel_hi:[1,0]
  v_pk_mul_f32 v[46:47], v[120:121], v[10:11] op_sel:[0,0] op_sel_hi:[1,0]
  v_pk_fma_f32 v[120:121], v[124:125], v[10:11], v[44:45] op_sel:[0,0,0] op_sel_hi:[1,0,1] neg_lo:[0,1,0] neg_hi:[0,1,0]
  v_pk_fma_f32 v[124:125], v[124:125], v[194:195], v[46:47] op_sel:[0,0,0] op_sel_hi:[1,0,1]
  v_pk_mul_f32 v[48:49], v[128:129], v[212:213] op_sel:[0,0] op_sel_hi:[1,0]
  v_pk_mul_f32 v[50:51], v[128:129], v[238:239] op_sel:[0,0] op_sel_hi:[1,0]
  v_pk_fma_f32 v[128:129], v[132:133], v[238:239], v[48:49] op_sel:[0,0,0] op_sel_hi:[1,0,1] neg_lo:[0,1,0] neg_hi:[0,1,0]
  v_pk_fma_f32 v[132:133], v[132:133], v[212:213], v[50:51] op_sel:[0,0,0] op_sel_hi:[1,0,1]
  v_pk_mul_f32 v[52:53], v[114:115], v[176:177] op_sel:[0,0] op_sel_hi:[1,0]
  v_pk_mul_f32 v[54:55], v[114:115], v[8:9] op_sel:[0,0] op_sel_hi:[1,0]
  v_pk_fma_f32 v[114:115], v[118:119], v[8:9], v[52:53] op_sel:[0,0,0] op_sel_hi:[1,0,1] neg_lo:[0,1,0] neg_hi:[0,1,0]
  v_pk_fma_f32 v[118:119], v[118:119], v[176:177], v[54:55] op_sel:[0,0,0] op_sel_hi:[1,0,1]
  v_pk_mul_f32 v[56:57], v[122:123], v[194:195] op_sel:[0,0] op_sel_hi:[1,0]
  v_pk_mul_f32 v[58:59], v[122:123], v[10:11] op_sel:[0,0] op_sel_hi:[1,0]
  v_pk_fma_f32 v[122:123], v[126:127], v[10:11], v[56:57] op_sel:[0,0,0] op_sel_hi:[1,0,1] neg_lo:[0,1,0] neg_hi:[0,1,0]
  v_pk_fma_f32 v[126:127], v[126:127], v[194:195], v[58:59] op_sel:[0,0,0] op_sel_hi:[1,0,1]
  v_pk_mul_f32 v[60:61], v[130:131], v[212:213] op_sel:[0,0] op_sel_hi:[1,0]
  v_pk_mul_f32 v[62:63], v[130:131], v[238:239] op_sel:[0,0] op_sel_hi:[1,0]
  v_pk_fma_f32 v[130:131], v[134:135], v[238:239], v[60:61] op_sel:[0,0,0] op_sel_hi:[1,0,1] neg_lo:[0,1,0] neg_hi:[0,1,0]
  v_pk_fma_f32 v[134:135], v[134:135], v[212:213], v[62:63] op_sel:[0,0,0] op_sel_hi:[1,0,1]
  v_pk_mul_f32 v[40:41], v[136:137], v[176:177] op_sel:[0,0] op_sel_hi:[1,0]
  v_pk_mul_f32 v[42:43], v[136:137], v[8:9] op_sel:[0,0] op_sel_hi:[1,0]
  v_pk_fma_f32 v[136:137], v[140:141], v[8:9], v[40:41] op_sel:[0,0,0] op_sel_hi:[1,0,1] neg_lo:[0,1,0] neg_hi:[0,1,0]
  v_pk_fma_f32 v[140:141], v[140:141], v[176:177], v[42:43] op_sel:[0,0,0] op_sel_hi:[1,0,1]
  v_pk_mul_f32 v[44:45], v[144:145], v[194:195] op_sel:[0,0] op_sel_hi:[1,0]
  v_pk_mul_f32 v[46:47], v[144:145], v[10:11] op_sel:[0,0] op_sel_hi:[1,0]
  v_pk_fma_f32 v[144:145], v[148:149], v[10:11], v[44:45] op_sel:[0,0,0] op_sel_hi:[1,0,1] neg_lo:[0,1,0] neg_hi:[0,1,0]
  v_pk_fma_f32 v[148:149], v[148:149], v[194:195], v[46:47] op_sel:[0,0,0] op_sel_hi:[1,0,1]
  v_pk_mul_f32 v[48:49], v[152:153], v[212:213] op_sel:[0,0] op_sel_hi:[1,0]
  v_pk_mul_f32 v[50:51], v[152:153], v[238:239] op_sel:[0,0] op_sel_hi:[1,0]
  v_pk_fma_f32 v[152:153], v[156:157], v[238:239], v[48:49] op_sel:[0,0,0] op_sel_hi:[1,0,1] neg_lo:[0,1,0] neg_hi:[0,1,0]
  v_pk_fma_f32 v[156:157], v[156:157], v[212:213], v[50:51] op_sel:[0,0,0] op_sel_hi:[1,0,1]
  v_pk_mul_f32 v[52:53], v[138:139], v[176:177] op_sel:[0,0] op_sel_hi:[1,0]
  v_pk_mul_f32 v[54:55], v[138:139], v[8:9] op_sel:[0,0] op_sel_hi:[1,0]
  v_pk_fma_f32 v[138:139], v[142:143], v[8:9], v[52:53] op_sel:[0,0,0] op_sel_hi:[1,0,1] neg_lo:[0,1,0] neg_hi:[0,1,0]
  v_pk_fma_f32 v[142:143], v[142:143], v[176:177], v[54:55] op_sel:[0,0,0] op_sel_hi:[1,0,1]
  v_pk_mul_f32 v[56:57], v[146:147], v[194:195] op_sel:[0,0] op_sel_hi:[1,0]
  v_pk_mul_f32 v[58:59], v[146:147], v[10:11] op_sel:[0,0] op_sel_hi:[1,0]
  v_pk_fma_f32 v[146:147], v[150:151], v[10:11], v[56:57] op_sel:[0,0,0] op_sel_hi:[1,0,1] neg_lo:[0,1,0] neg_hi:[0,1,0]
  v_pk_fma_f32 v[150:151], v[150:151], v[194:195], v[58:59] op_sel:[0,0,0] op_sel_hi:[1,0,1]
  v_pk_mul_f32 v[60:61], v[154:155], v[212:213] op_sel:[0,0] op_sel_hi:[1,0]
  v_pk_mul_f32 v[62:63], v[154:155], v[238:239] op_sel:[0,0] op_sel_hi:[1,0]
  v_pk_fma_f32 v[154:155], v[158:159], v[238:239], v[60:61] op_sel:[0,0,0] op_sel_hi:[1,0,1] neg_lo:[0,1,0] neg_hi:[0,1,0]
  v_pk_fma_f32 v[158:159], v[158:159], v[212:213], v[62:63] op_sel:[0,0,0] op_sel_hi:[1,0,1]
  s_mov_b32 s38, s78
  s_mov_b32 s39, s78
  s_mov_b32 s40, s78
  s_mov_b32 s41, s78
  s_mov_b32 s42, s78
  s_mov_b32 s43, s78
  s_mov_b32 s44, s78
  s_mov_b32 s45, s78
  s_mov_b32 s46, s78
  s_mov_b32 s47, s78
  s_mov_b32 s48, s78
  s_mov_b32 s49, s78
  s_mov_b32 s50, s78
  s_mov_b32 s51, s78
  s_mov_b32 s54, s78
  s_add_u32 s87, s85, 760
  s_mov_b32 s86, 0
L_U_cp:
  s_cmp_gt_u32 s73, 0
  s_cbranch_scc0 L_U_cpl
  s_load_dword s38, s[70:71], s87 offset:0 glc
  s_cmp_gt_u32 s73, 1
  s_cbranch_scc0 L_U_cpl
  s_load_dword s39, s[70:71], s87 offset:1536 glc
  s_cmp_gt_u32 s73, 2
  s_cbranch_scc0 L_U_cpl
  s_load_dword s40, s[70:71], s87 offset:3072 glc
  s_cmp_gt_u32 s73, 3
  s_cbranch_scc0 L_U_cpl
  s_load_dword s41, s[70:71], s87 offset:4608 glc
  s_cmp_gt_u32 s73, 4
  s_cbranch_scc0 L_U_cpl
  s_load_dword s42, s[70:71], s87 offset:6144 glc
  s_cmp_gt_u32 s73, 5
  s_cbranch_scc0 L_U_cpl
  s_load_dword s43, s[70:71], s87 offset:7680 glc
  s_cmp_gt_u32 s73, 6
  s_cbranch_scc0 L_U_cpl
  s_load_dword s44, s[70:71], s87 offset:9216 glc
  s_cmp_gt_u32 s73, 7
  s_cbranch_scc0 L_U_cpl
  s_load_dword s45, s[70:71], s87 offset:10752 glc
  s_cmp_gt_u32 s73, 8
  s_cbranch_scc0 L_U_cpl
  s_load_dword s46, s[70:71], s87 offset:12288 glc
  s_cmp_gt_u32 s73, 9
  s_cbranch_scc0 L_U_cpl
  s_load_dword s47, s[70:71], s87 offset:13824 glc
  s_cmp_gt_u32 s73, 10
  s_cbranch_scc0 L_U_cpl
  s_load_dword s48, s[70:71], s87 offset:15360 glc
  s_cmp_gt_u32 s73, 11
  s_cbranch_scc0 L_U_cpl
  s_load_dword s49, s[70:71], s87 offset:16896 glc
  s_cmp_gt_u32 s73, 12
  s_cbranch_scc0 L_U_cpl
  s_load_dword s50, s[70:71], s87 offset:18432 glc
  s_cmp_gt_u32 s73, 13
  s_cbranch_scc0 L_U_cpl
  s_load_dword s51, s[70:71], s87 offset:19968 glc
  s_cmp_gt_u32 s73, 14
  s_cbranch_scc0 L_U_cpl
  s_load_dword s54, s[70:71], s87 offset:21504 glc
L_U_cpl:
  s_add_u32 s86, s86, 1
  s_waitcnt lgkmcnt(0)
  s_mov_b32 s81, 0
  s_xor_b32 s82, s38, s78
  s_or_b32 s81, s81, s82
  s_xor_b32 s82, s39, s78
  s_or_b32 s81, s81, s82
  s_xor_b32 s82, s40, s78
  s_or_b32 s81, s81, s82
  s_xor_b32 s82, s41, s78
  s_or_b32 s81, s81, s82
  s_xor_b32 s82, s42, s78
  s_or_b32 s81, s81, s82
  s_xor_b32 s82, s43, s78
  s_or_b32 s81, s81, s82
  s_xor_b32 s82, s44, s78
  s_or_b32 s81, s81, s82
  s_xor_b32 s82, s45, s78
  s_or_b32 s81, s81, s82
  s_xor_b32 s82, s46, s78
  s_or_b32 s81, s81, s82
  s_xor_b32 s82, s47, s78
  s_or_b32 s81, s81, s82
  s_xor_b32 s82, s48, s78
  s_or_b32 s81, s81, s82
  s_xor_b32 s82, s49, s78
  s_or_b32 s81, s81, s82
  s_xor_b32 s82, s50, s78
  s_or_b32 s81, s81, s82
  s_xor_b32 s82, s51, s78
  s_or_b32 s81, s81, s82
  s_xor_b32 s82, s54, s78
  s_or_b32 s81, s81, s82
  s_cmp_ge_u32 s86, 2000000
  s_cbranch_scc1 L_U_cpok
  s_cmp_eq_u32 s81, 0
  s_cbranch_scc1 L_U_cpok
  s_sleep 1
  s_branch L_U_cp
L_U_cpok:
  s_mov_b32 s86, 0
L_U_lbloop:
  buffer_load_dwordx4 v[40:43], v4, s[16:19], s85 offen offset:0 sc1
  buffer_load_dwordx4 v[44:47], v4, s[16:19], s85 offen offset:256 sc1
  buffer_load_dwordx4 v[48:51], v4, s[16:19], s85 offen offset:512 sc1
  buffer_load_dwordx4 v[52:55], v5, s[16:19], s85 offen offset:0 sc1
  buffer_load_dwordx4 v[56:59], v5, s[16:19], s85 offen offset:256 sc1
  buffer_load_dwordx4 v[60:63], v5, s[16:19], s85 offen offset:512 sc1
  buffer_load_dwordx4 v[240:243], v6, s[16:19], s85 offen offset:0 sc1
  buffer_load_dwordx4 v[244:247], v6, s[16:19], s85 offen offset:256 sc1
  buffer_load_dwordx4 v[248:251], v6, s[16:19], s85 offen offset:512 sc1
  buffer_load_dwordx4 v[216:219], v7, s[16:19], s85 offen offset:0 sc1
  buffer_load_dwordx4 v[224:227], v7, s[16:19], s85 offen offset:256 sc1
  buffer_load_dwordx4 v[232:235], v7, s[16:19], s85 offen offset:512 sc1
  s_add_u32 s86, s86, 1
  s_mov_b64 s[96:97], 0
  s_waitcnt vmcnt(0)
  v_cmp_ne_u32 vcc, s78, v42
  s_nop 0
  s_and_b64 vcc, vcc, s[88:89]
  s_or_b64 s[96:97], s[96:97], vcc
  v_cmp_ne_u32 vcc, s78, v46
  s_nop 0
  s_and_b64 vcc, vcc, s[88:89]
  s_or_b64 s[96:97], s[96:97], vcc
  v_cmp_ne_u32 vcc, s78, v50
  s_nop 0
  s_and_b64 vcc, vcc, s[88:89]
  s_or_b64 s[96:97], s[96:97], vcc
  v_cmp_ne_u32 vcc, s78, v54
  s_nop 0
  s_and_b64 vcc, vcc, s[90:91]
  s_or_b64 s[96:97], s[96:97], vcc
  v_cmp_ne_u32 vcc, s78, v58
  s_nop 0
  s_and_b64 vcc, vcc, s[90:91]
  s_or_b64 s[96:97], s[96:97], vcc
  v_cmp_ne_u32 vcc, s78, v62
  s_nop 0
  s_and_b64 vcc, vcc, s[90:91]
  s_or_b64 s[96:97], s[96:97], vcc
  v_cmp_ne_u32 vcc, s78, v242
  s_nop 0
  s_and_b64 vcc, vcc, s[92:93]
  s_or_b64 s[96:97], s[96:97], vcc
  v_cmp_ne_u32 vcc, s78, v246
  s_nop 0
  s_and_b64 vcc, vcc, s[92:93]
  s_or_b64 s[96:97], s[96:97], vcc
  v_cmp_ne_u32 vcc, s78, v250
  s_nop 0
  s_and_b64 vcc, vcc, s[92:93]
  s_or_b64 s[96:97], s[96:97], vcc
  v_cmp_ne_u32 vcc, s78, v218
  s_nop 0
  s_and_b64 vcc, vcc, s[94:95]
  s_or_b64 s[96:97], s[96:97], vcc
  v_cmp_ne_u32 vcc, s78, v226
  s_nop 0
  s_and_b64 vcc, vcc, s[94:95]
  s_or_b64 s[96:97], s[96:97], vcc
  v_cmp_ne_u32 vcc, s78, v234
  s_nop 0
  s_and_b64 vcc, vcc, s[94:95]
  s_or_b64 s[96:97], s[96:97], vcc
  s_cmp_ge_u32 s86, 2000000
  s_cbranch_scc1 L_U_lbok
  s_cmp_eq_u64 s[96:97], 0
  s_cbranch_scc0 L_U_lbloop
L_U_lbok:
  v_fma_f32 v240, v170, v216, v240
  v_fma_f32 v241, v170, v217, v241
  v_fma_f32 v240, -v171, v217, v240
  v_fma_f32 v241, v171, v216, v241
  v_fma_f32 v244, v188, v224, v244
  v_fma_f32 v245, v188, v225, v245
  v_fma_f32 v244, -v189, v225, v244
  v_fma_f32 v245, v189, v224, v245
  v_fma_f32 v248, v206, v232, v248
  v_fma_f32 v249, v206, v233, v249
  v_fma_f32 v248, -v207, v233, v248
  v_fma_f32 v249, v207, v232, v249
  v_fma_f32 v52, v170, v240, v52
  v_fma_f32 v53, v170, v241, v53
  v_fma_f32 v52, -v171, v241, v52
  v_fma_f32 v53, v171, v240, v53
  v_fma_f32 v56, v188, v244, v56
  v_fma_f32 v57, v188, v245, v57
  v_fma_f32 v56, -v189, v245, v56
  v_fma_f32 v57, v189, v244, v57
  v_fma_f32 v60, v206, v248, v60
  v_fma_f32 v61, v206, v249, v61
  v_fma_f32 v60, -v207, v249, v60
  v_fma_f32 v61, v207, v248, v61
  v_fma_f32 v40, v170, v52, v40
  v_fma_f32 v41, v170, v53, v41
  v_fma_f32 v40, -v171, v53, v40
  v_fma_f32 v41, v171, v52, v41
  v_fma_f32 v44, v188, v56, v44
  v_fma_f32 v45, v188, v57, v45
  v_fma_f32 v44, -v189, v57, v44
  v_fma_f32 v45, v189, v56, v45
  v_fma_f32 v48, v206, v60, v48
  v_fma_f32 v49, v206, v61, v49
  v_fma_f32 v48, -v207, v61, v48
  v_fma_f32 v49, v207, v60, v49
  v_mov_b32 v52, v40
  v_mov_b32 v53, v41
  s_nop 0
  v_permlane16_swap_b32 v40, v52
  v_permlane16_swap_b32 v41, v53
  v_fma_f32 v240, v172, v52, v40
  v_fma_f32 v241, v172, v53, v41
  v_fma_f32 v240, -v173, v53, v240
  v_fma_f32 v241, v173, v52, v241
  v_mov_b32 v216, v240
  v_mov_b32 v217, v241
  s_nop 0
  v_permlane32_swap_b32 v240, v216
  v_permlane32_swap_b32 v241, v217
  v_fma_f32 v40, v174, v216, v240
  v_fma_f32 v41, v174, v217, v241
  v_fma_f32 v40, -v175, v217, v40
  v_fma_f32 v41, v175, v216, v41
  v_mov_b32 v56, v44
  v_mov_b32 v57, v45
  s_nop 0
  v_permlane16_swap_b32 v44, v56
  v_permlane16_swap_b32 v45, v57
  v_fma_f32 v244, v190, v56, v44
  v_fma_f32 v245, v190, v57, v45
  v_fma_f32 v244, -v191, v57, v244
  v_fma_f32 v245, v191, v56, v245
  v_mov_b32 v224, v244
  v_mov_b32 v225, v245
  s_nop 0
  v_permlane32_swap_b32 v244, v224
  v_permlane32_swap_b32 v245, v225
  v_fma_f32 v44, v192, v224, v244
  v_fma_f32 v45, v192, v225, v245
  v_fma_f32 v44, -v193, v225, v44
  v_fma_f32 v45, v193, v224, v45
  v_mov_b32 v60, v48
  v_mov_b32 v61, v49
  s_nop 0
  v_permlane16_swap_b32 v48, v60
  v_permlane16_swap_b32 v49, v61
  v_fma_f32 v248, v208, v60, v48
  v_fma_f32 v249, v208, v61, v49
  v_fma_f32 v248, -v209, v61, v248
  v_fma_f32 v249, v209, v60, v249
  v_mov_b32 v232, v248
  v_mov_b32 v233, v249
  s_nop 0
  v_permlane32_swap_b32 v248, v232
  v_permlane32_swap_b32 v249, v233
  v_fma_f32 v48, v210, v232, v248
  v_fma_f32 v49, v210, v233, v249
  v_fma_f32 v48, -v211, v233, v48
  v_fma_f32 v49, v211, v232, v49
  s_cmp_ge_u32 s72, 2
  s_cbranch_scc0 L_U_hw0
  v_fma_f32 v52, v168, v40, v214
  v_fma_f32 v53, v168, v41, v215
  v_fma_f32 v52, -v169, v41, v52
  v_fma_f32 v53, v169, v40, v53
  v_fma_f32 v56, v186, v44, v222
  v_fma_f32 v57, v186, v45, v223
  v_fma_f32 v56, -v187, v45, v56
  v_fma_f32 v57, v187, v44, v57
  v_fma_f32 v60, v204, v48, v230
  v_fma_f32 v61, v204, v49, v231
  v_fma_f32 v60, -v205, v49, v60
  v_fma_f32 v61, v205, v48, v61
  s_branch L_U_hw1
L_U_hw0:
  v_mov_b32 v52, v40
  v_mov_b32 v53, v41
  v_mov_b32 v56, v44
  v_mov_b32 v57, v45
  v_mov_b32 v60, v48
  v_mov_b32 v61, v49
L_U_hw1:
  s_nop 1
  v_fma_f32 v240, v166, v52, v16
  v_fma_f32 v241, v166, v53, v17
  v_fma_f32 v240, -v167, v53, v240
  v_fma_f32 v241, v167, v52, v241
  v_fma_f32 v244, v184, v56, v24
  v_fma_f32 v245, v184, v57, v25
  v_fma_f32 v244, -v185, v57, v244
  v_fma_f32 v245, v185, v56, v245
  v_fma_f32 v248, v202, v60, v32
  v_fma_f32 v249, v202, v61, v33
  v_fma_f32 v248, -v203, v61, v248
  v_fma_f32 v249, v203, v60, v249
  v_mov_b32 v216, v240
  v_mov_b32 v218, v241
  v_fma_f32 v217, v162, v240, v20
  v_fma_f32 v219, v162, v241, v22
  v_fma_f32 v217, -v163, v241, v217
  v_fma_f32 v219, v163, v240, v219
  v_mov_b32 v224, v244
  v_mov_b32 v226, v245
  v_fma_f32 v225, v180, v244, v28
  v_fma_f32 v227, v180, v245, v30
  v_fma_f32 v225, -v181, v245, v225
  v_fma_f32 v227, v181, v244, v227
  v_mov_b32 v232, v248
  v_mov_b32 v234, v249
  v_fma_f32 v233, v198, v248, v36
  v_fma_f32 v235, v198, v249, v38
  v_fma_f32 v233, -v199, v249, v233
  v_fma_f32 v235, v199, v248, v235
  v_pk_mul_f32 v[52:53], v[216:217], v[176:177] op_sel:[0,0] op_sel_hi:[1,0]
  v_pk_mul_f32 v[54:55], v[216:217], v[8:9] op_sel:[0,0] op_sel_hi:[1,0]
  v_pk_mul_f32 v[56:57], v[224:225], v[194:195] op_sel:[0,0] op_sel_hi:[1,0]
  v_pk_mul_f32 v[58:59], v[224:225], v[10:11] op_sel:[0,0] op_sel_hi:[1,0]
  v_pk_mul_f32 v[60:61], v[232:233], v[212:213] op_sel:[0,0] op_sel_hi:[1,0]
  v_pk_mul_f32 v[62:63], v[232:233], v[238:239] op_sel:[0,0] op_sel_hi:[1,0]
  v_pk_fma_f32 v[216:217], v[218:219], v[8:9], v[52:53] op_sel:[0,0,0] op_sel_hi:[1,0,1] neg_lo:[0,1,0] neg_hi:[0,1,0]
  v_pk_fma_f32 v[218:219], v[218:219], v[176:177], v[54:55] op_sel:[0,0,0] op_sel_hi:[1,0,1]
  v_pk_fma_f32 v[224:225], v[226:227], v[10:11], v[56:57] op_sel:[0,0,0] op_sel_hi:[1,0,1] neg_lo:[0,1,0] neg_hi:[0,1,0]
  v_pk_fma_f32 v[226:227], v[226:227], v[194:195], v[58:59] op_sel:[0,0,0] op_sel_hi:[1,0,1]
  v_pk_fma_f32 v[232:233], v[234:235], v[238:239], v[60:61] op_sel:[0,0,0] op_sel_hi:[1,0,1] neg_lo:[0,1,0] neg_hi:[0,1,0]
  v_pk_fma_f32 v[234:235], v[234:235], v[212:213], v[62:63] op_sel:[0,0,0] op_sel_hi:[1,0,1]
  v_pk_fma_f32 v[64:65], v[216:217], v[160:161], v[64:65] op_sel:[0,0,0] op_sel_hi:[1,0,1]
  v_pk_fma_f32 v[68:69], v[218:219], v[160:161], v[68:69] op_sel:[0,0,0] op_sel_hi:[1,0,1]
  v_pk_fma_f32 v[72:73], v[224:225], v[178:179], v[72:73] op_sel:[0,0,0] op_sel_hi:[1,0,1]
  v_pk_fma_f32 v[76:77], v[226:227], v[178:179], v[76:77] op_sel:[0,0,0] op_sel_hi:[1,0,1]
  v_pk_fma_f32 v[80:81], v[232:233], v[196:197], v[80:81] op_sel:[0,0,0] op_sel_hi:[1,0,1]
  v_pk_fma_f32 v[84:85], v[234:235], v[196:197], v[84:85] op_sel:[0,0,0] op_sel_hi:[1,0,1]
  v_pk_fma_f32 v[64:65], v[218:219], v[2:3], v[64:65] op_sel:[0,0,0] op_sel_hi:[1,0,1] neg_lo:[0,1,0] neg_hi:[0,1,0]
  v_pk_fma_f32 v[68:69], v[216:217], v[2:3], v[68:69] op_sel:[0,0,0] op_sel_hi:[1,0,1]
  v_pk_fma_f32 v[72:73], v[226:227], v[252:253], v[72:73] op_sel:[0,0,0] op_sel_hi:[1,0,1] neg_lo:[0,1,0] neg_hi:[0,1,0]
  v_pk_fma_f32 v[76:77], v[224:225], v[252:253], v[76:77] op_sel:[0,0,0] op_sel_hi:[1,0,1]
  v_pk_fma_f32 v[80:81], v[234:235], v[254:255], v[80:81] op_sel:[0,0,0] op_sel_hi:[1,0,1] neg_lo:[0,1,0] neg_hi:[0,1,0]
  v_pk_fma_f32 v[84:85], v[232:233], v[254:255], v[84:85] op_sel:[0,0,0] op_sel_hi:[1,0,1]
  v_pk_fma_f32 v[66:67], v[64:65], v[160:161], v[66:67] op_sel:[0,0,0] op_sel_hi:[1,0,1]
  v_pk_fma_f32 v[70:71], v[68:69], v[160:161], v[70:71] op_sel:[0,0,0] op_sel_hi:[1,0,1]
  v_pk_fma_f32 v[74:75], v[72:73], v[178:179], v[74:75] op_sel:[0,0,0] op_sel_hi:[1,0,1]
  v_pk_fma_f32 v[78:79], v[76:77], v[178:179], v[78:79] op_sel:[0,0,0] op_sel_hi:[1,0,1]
  v_pk_fma_f32 v[82:83], v[80:81], v[196:197], v[82:83] op_sel:[0,0,0] op_sel_hi:[1,0,1]
  v_pk_fma_f32 v[86:87], v[84:85], v[196:197], v[86:87] op_sel:[0,0,0] op_sel_hi:[1,0,1]
  v_pk_fma_f32 v[66:67], v[68:69], v[2:3], v[66:67] op_sel:[0,0,0] op_sel_hi:[1,0,1] neg_lo:[0,1,0] neg_hi:[0,1,0]
  v_pk_fma_f32 v[70:71], v[64:65], v[2:3], v[70:71] op_sel:[0,0,0] op_sel_hi:[1,0,1]
  v_pk_fma_f32 v[74:75], v[76:77], v[252:253], v[74:75] op_sel:[0,0,0] op_sel_hi:[1,0,1] neg_lo:[0,1,0] neg_hi:[0,1,0]
  v_pk_fma_f32 v[78:79], v[72:73], v[252:253], v[78:79] op_sel:[0,0,0] op_sel_hi:[1,0,1]
  v_pk_fma_f32 v[82:83], v[84:85], v[254:255], v[82:83] op_sel:[0,0,0] op_sel_hi:[1,0,1] neg_lo:[0,1,0] neg_hi:[0,1,0]
  v_pk_fma_f32 v[86:87], v[80:81], v[254:255], v[86:87] op_sel:[0,0,0] op_sel_hi:[1,0,1]
  v_pk_fma_f32 v[88:89], v[66:67], v[160:161], v[88:89] op_sel:[0,0,0] op_sel_hi:[1,0,1]
  v_pk_fma_f32 v[92:93], v[70:71], v[160:161], v[92:93] op_sel:[0,0,0] op_sel_hi:[1,0,1]
  v_pk_fma_f32 v[96:97], v[74:75], v[178:179], v[96:97] op_sel:[0,0,0] op_sel_hi:[1,0,1]
  v_pk_fma_f32 v[100:101], v[78:79], v[178:179], v[100:101] op_sel:[0,0,0] op_sel_hi:[1,0,1]
  v_pk_fma_f32 v[104:105], v[82:83], v[196:197], v[104:105] op_sel:[0,0,0] op_sel_hi:[1,0,1]
  v_pk_fma_f32 v[108:109], v[86:87], v[196:197], v[108:109] op_sel:[0,0,0] op_sel_hi:[1,0,1]
  v_pk_fma_f32 v[88:89], v[70:71], v[2:3], v[88:89] op_sel:[0,0,0] op_sel_hi:[1,0,1] neg_lo:[0,1,0] neg_hi:[0,1,0]
  v_pk_fma_f32 v[92:93], v[66:67], v[2:3], v[92:93] op_sel:[0,0,0] op_sel_hi:[1,0,1]
  v_pk_fma_f32 v[96:97], v[78:79], v[252:253], v[96:97] op_sel:[0,0,0] op_sel_hi:[1,0,1] neg_lo:[0,1,0] neg_hi:[0,1,0]
  v_pk_fma_f32 v[100:101], v[74:75], v[252:253], v[100:101] op_sel:[0,0,0] op_sel_hi:[1,0,1]
  v_pk_fma_f32 v[104:105], v[86:87], v[254:255], v[104:105] op_sel:[0,0,0] op_sel_hi:[1,0,1] neg_lo:[0,1,0] neg_hi:[0,1,0]
  v_pk_fma_f32 v[108:109], v[82:83], v[254:255], v[108:109] op_sel:[0,0,0] op_sel_hi:[1,0,1]
  v_pk_fma_f32 v[90:91], v[88:89], v[160:161], v[90:91] op_sel:[0,0,0] op_sel_hi:[1,0,1]
  v_pk_fma_f32 v[94:95], v[92:93], v[160:161], v[94:95] op_sel:[0,0,0] op_sel_hi:[1,0,1]
  v_pk_fma_f32 v[98:99], v[96:97], v[178:179], v[98:99] op_sel:[0,0,0] op_sel_hi:[1,0,1]
  v_pk_fma_f32 v[102:103], v[100:101], v[178:179], v[102:103] op_sel:[0,0,0] op_sel_hi:[1,0,1]
  v_pk_fma_f32 v[106:107], v[104:105], v[196:197], v[106:107] op_sel:[0,0,0] op_sel_hi:[1,0,1]
  v_pk_fma_f32 v[110:111], v[108:109], v[196:197], v[110:111] op_sel:[0,0,0] op_sel_hi:[1,0,1]
  v_pk_fma_f32 v[90:91], v[92:93], v[2:3], v[90:91] op_sel:[0,0,0] op_sel_hi:[1,0,1] neg_lo:[0,1,0] neg_hi:[0,1,0]
  v_pk_fma_f32 v[94:95], v[88:89], v[2:3], v[94:95] op_sel:[0,0,0] op_sel_hi:[1,0,1]
  v_pk_fma_f32 v[98:99], v[100:101], v[252:253], v[98:99] op_sel:[0,0,0] op_sel_hi:[1,0,1] neg_lo:[0,1,0] neg_hi:[0,1,0]
  v_pk_fma_f32 v[102:103], v[96:97], v[252:253], v[102:103] op_sel:[0,0,0] op_sel_hi:[1,0,1]
  v_pk_fma_f32 v[106:107], v[108:109], v[254:255], v[106:107] op_sel:[0,0,0] op_sel_hi:[1,0,1] neg_lo:[0,1,0] neg_hi:[0,1,0]
  v_pk_fma_f32 v[110:111], v[104:105], v[254:255], v[110:111] op_sel:[0,0,0] op_sel_hi:[1,0,1]
  v_pk_fma_f32 v[112:113], v[90:91], v[160:161], v[112:113] op_sel:[0,0,0] op_sel_hi:[1,0,1]
  v_pk_fma_f32 v[116:117], v[94:95], v[160:161], v[116:117] op_sel:[0,0,0] op_sel_hi:[1,0,1]
  v_pk_fma_f32 v[120:121], v[98:99], v[178:179], v[120:121] op_sel:[0,0,0] op_sel_hi:[1,0,1]
  v_pk_fma_f32 v[124:125], v[102:103], v[178:179], v[124:125] op_sel:[0,0,0] op_sel_hi:[1,0,1]
  v_pk_fma_f32 v[128:129], v[106:107], v[196:197], v[128:129] op_sel:[0,0,0] op_sel_hi:[1,0,1]
  v_pk_fma_f32 v[132:133], v[110:111], v[196:197], v[132:133] op_sel:[0,0,0] op_sel_hi:[1,0,1]
  v_pk_fma_f32 v[112:113], v[94:95], v[2:3], v[112:113] op_sel:[0,0,0] op_sel_hi:[1,0,1] neg_lo:[0,1,0] neg_hi:[0,1,0]
  v_pk_fma_f32 v[116:117], v[90:91], v[2:3], v[116:117] op_sel:[0,0,0] op_sel_hi:[1,0,1]
  v_pk_fma_f32 v[120:121], v[102:103], v[252:253], v[120:121] op_sel:[0,0,0] op_sel_hi:[1,0,1] neg_lo:[0,1,0] neg_hi:[0,1,0]
  v_pk_fma_f32 v[124:125], v[98:99], v[252:253], v[124:125] op_sel:[0,0,0] op_sel_hi:[1,0,1]
  v_pk_fma_f32 v[128:129], v[110:111], v[254:255], v[128:129] op_sel:[0,0,0] op_sel_hi:[1,0,1] neg_lo:[0,1,0] neg_hi:[0,1,0]
  v_pk_fma_f32 v[132:133], v[106:107], v[254:255], v[132:133] op_sel:[0,0,0] op_sel_hi:[1,0,1]
  v_pk_fma_f32 v[114:115], v[112:113], v[160:161], v[114:115] op_sel:[0,0,0] op_sel_hi:[1,0,1]
  v_pk_fma_f32 v[118:119], v[116:117], v[160:161], v[118:119] op_sel:[0,0,0] op_sel_hi:[1,0,1]
  v_pk_fma_f32 v[122:123], v[120:121], v[178:179], v[122:123] op_sel:[0,0,0] op_sel_hi:[1,0,1]
  v_pk_fma_f32 v[126:127], v[124:125], v[178:179], v[126:127] op_sel:[0,0,0] op_sel_hi:[1,0,1]
  v_pk_fma_f32 v[130:131], v[128:129], v[196:197], v[130:131] op_sel:[0,0,0] op_sel_hi:[1,0,1]
  v_pk_fma_f32 v[134:135], v[132:133], v[196:197], v[134:135] op_sel:[0,0,0] op_sel_hi:[1,0,1]
  v_pk_fma_f32 v[114:115], v[116:117], v[2:3], v[114:115] op_sel:[0,0,0] op_sel_hi:[1,0,1] neg_lo:[0,1,0] neg_hi:[0,1,0]
  v_pk_fma_f32 v[118:119], v[112:113], v[2:3], v[118:119] op_sel:[0,0,0] op_sel_hi:[1,0,1]
  v_pk_fma_f32 v[122:123], v[124:125], v[252:253], v[122:123] op_sel:[0,0,0] op_sel_hi:[1,0,1] neg_lo:[0,1,0] neg_hi:[0,1,0]
  v_pk_fma_f32 v[126:127], v[120:121], v[252:253], v[126:127] op_sel:[0,0,0] op_sel_hi:[1,0,1]
  v_pk_fma_f32 v[130:131], v[132:133], v[254:255], v[130:131] op_sel:[0,0,0] op_sel_hi:[1,0,1] neg_lo:[0,1,0] neg_hi:[0,1,0]
  v_pk_fma_f32 v[134:135], v[128:129], v[254:255], v[134:135] op_sel:[0,0,0] op_sel_hi:[1,0,1]
  v_pk_fma_f32 v[136:137], v[114:115], v[160:161], v[136:137] op_sel:[0,0,0] op_sel_hi:[1,0,1]
  v_pk_fma_f32 v[140:141], v[118:119], v[160:161], v[140:141] op_sel:[0,0,0] op_sel_hi:[1,0,1]
  v_pk_fma_f32 v[144:145], v[122:123], v[178:179], v[144:145] op_sel:[0,0,0] op_sel_hi:[1,0,1]
  v_pk_fma_f32 v[148:149], v[126:127], v[178:179], v[148:149] op_sel:[0,0,0] op_sel_hi:[1,0,1]
  v_pk_fma_f32 v[152:153], v[130:131], v[196:197], v[152:153] op_sel:[0,0,0] op_sel_hi:[1,0,1]
  v_pk_fma_f32 v[156:157], v[134:135], v[196:197], v[156:157] op_sel:[0,0,0] op_sel_hi:[1,0,1]
  v_pk_fma_f32 v[136:137], v[118:119], v[2:3], v[136:137] op_sel:[0,0,0] op_sel_hi:[1,0,1] neg_lo:[0,1,0] neg_hi:[0,1,0]
  v_pk_fma_f32 v[140:141], v[114:115], v[2:3], v[140:141] op_sel:[0,0,0] op_sel_hi:[1,0,1]
  v_pk_fma_f32 v[144:145], v[126:127], v[252:253], v[144:145] op_sel:[0,0,0] op_sel_hi:[1,0,1] neg_lo:[0,1,0] neg_hi:[0,1,0]
  v_pk_fma_f32 v[148:149], v[122:123], v[252:253], v[148:149] op_sel:[0,0,0] op_sel_hi:[1,0,1]
  v_pk_fma_f32 v[152:153], v[134:135], v[254:255], v[152:153] op_sel:[0,0,0] op_sel_hi:[1,0,1] neg_lo:[0,1,0] neg_hi:[0,1,0]
  v_pk_fma_f32 v[156:157], v[130:131], v[254:255], v[156:157] op_sel:[0,0,0] op_sel_hi:[1,0,1]
  v_pk_fma_f32 v[138:139], v[136:137], v[160:161], v[138:139] op_sel:[0,0,0] op_sel_hi:[1,0,1]
  v_pk_fma_f32 v[142:143], v[140:141], v[160:161], v[142:143] op_sel:[0,0,0] op_sel_hi:[1,0,1]
  v_pk_fma_f32 v[146:147], v[144:145], v[178:179], v[146:147] op_sel:[0,0,0] op_sel_hi:[1,0,1]
  v_pk_fma_f32 v[150:151], v[148:149], v[178:179], v[150:151] op_sel:[0,0,0] op_sel_hi:[1,0,1]
  v_pk_fma_f32 v[154:155], v[152:153], v[196:197], v[154:155] op_sel:[0,0,0] op_sel_hi:[1,0,1]
  v_pk_fma_f32 v[158:159], v[156:157], v[196:197], v[158:159] op_sel:[0,0,0] op_sel_hi:[1,0,1]
  v_pk_fma_f32 v[138:139], v[140:141], v[2:3], v[138:139] op_sel:[0,0,0] op_sel_hi:[1,0,1] neg_lo:[0,1,0] neg_hi:[0,1,0]
  v_pk_fma_f32 v[142:143], v[136:137], v[2:3], v[142:143] op_sel:[0,0,0] op_sel_hi:[1,0,1]
  v_pk_fma_f32 v[146:147], v[148:149], v[252:253], v[146:147] op_sel:[0,0,0] op_sel_hi:[1,0,1] neg_lo:[0,1,0] neg_hi:[0,1,0]
  v_pk_fma_f32 v[150:151], v[144:145], v[252:253], v[150:151] op_sel:[0,0,0] op_sel_hi:[1,0,1]
  v_pk_fma_f32 v[154:155], v[156:157], v[254:255], v[154:155] op_sel:[0,0,0] op_sel_hi:[1,0,1] neg_lo:[0,1,0] neg_hi:[0,1,0]
  v_pk_fma_f32 v[158:159], v[152:153], v[254:255], v[158:159] op_sel:[0,0,0] op_sel_hi:[1,0,1]
  v_and_b32 v10, 15, v0
  v_lshrrev_b32 v11, 4, v0
  v_lshlrev_b32 v11, 3, v11
  v_sub_u32 v10, v10, v11
  v_mov_b32 v14, 0x3f80
  v_add_u32 v12, 0, v10
  v_and_b32 v13, 1, v12
  v_lshlrev_b32 v13, 4, v13
  v_lshlrev_b32 v13, v13, v14
  v_lshrrev_b32 v12, 1, v12
  v_cmp_eq_u32 s[86:87], 0, v12
  v_cmp_eq_u32 s[88:89], 1, v12
  v_cmp_eq_u32 s[90:91], 2, v12
  v_cmp_eq_u32 s[92:93], 3, v12
  v_cndmask_b32 v40, 0, v13, s[86:87]
  v_cndmask_b32 v41, 0, v13, s[88:89]
  v_cndmask_b32 v42, 0, v13, s[90:91]
  v_cndmask_b32 v43, 0, v13, s[92:93]
  v_add_u32 v12, 16, v10
  v_and_b32 v13, 1, v12
  v_lshlrev_b32 v13, 4, v13
  v_lshlrev_b32 v13, v13, v14
  v_lshrrev_b32 v12, 1, v12
  v_cmp_eq_u32 s[86:87], 0, v12
  v_cmp_eq_u32 s[88:89], 1, v12
  v_cmp_eq_u32 s[90:91], 2, v12
  v_cmp_eq_u32 s[92:93], 3, v12
  v_cndmask_b32 v44, 0, v13, s[86:87]
  v_cndmask_b32 v45, 0, v13, s[88:89]
  v_cndmask_b32 v46, 0, v13, s[90:91]
  v_cndmask_b32 v47, 0, v13, s[92:93]
  s_lshr_b32 s80, s72, 1
  s_lshl_b32 s81, s73, 1
  s_add_u32 s80, s80, s81
  s_mul_i32 s80, s80, 94
  s_mul_i32 s81, s75, 6
  s_mul_i32 s82, s84, 3
  s_add_u32 s81, s81, s82
  s_add_u32 s80, s80, s81
  s_add_u32 s80, s80, 54
  s_lshl_b32 s80, s80, 12
  v_lshlrev_b32 v10, 4, v0
  v_cvt_pk_bf16_f32 v48, v64, v66
  v_cvt_pk_bf16_f32 v52, v65, v67
  v_cvt_pk_bf16_f32 v56, -v68, -v70
  v_cvt_pk_bf16_f32 v60, -v69, -v71
  v_cvt_pk_bf16_f32 v49, v88, v90
  v_cvt_pk_bf16_f32 v53, v89, v91
  v_cvt_pk_bf16_f32 v57, -v92, -v94
  v_cvt_pk_bf16_f32 v61, -v93, -v95
  v_cvt_pk_bf16_f32 v50, v112, v114
  v_cvt_pk_bf16_f32 v54, v113, v115
  v_cvt_pk_bf16_f32 v58, -v116, -v118
  v_cvt_pk_bf16_f32 v62, -v117, -v119
  v_cvt_pk_bf16_f32 v51, v136, v138
  v_cvt_pk_bf16_f32 v55, v137, v139
  v_cvt_pk_bf16_f32 v59, -v140, -v142
  v_cvt_pk_bf16_f32 v63, -v141, -v143
  v_mfma_f32_16x16x32_bf16 v[224:227], v[48:51], v[40:43], 0
  v_mfma_f32_16x16x32_bf16 v[232:235], v[48:51], v[44:47], 0
  v_mfma_f32_16x16x32_bf16 v[228:231], v[52:55], v[40:43], 0
  v_mfma_f32_16x16x32_bf16 v[236:239], v[52:55], v[44:47], 0
  v_mfma_f32_16x16x32_bf16 v[240:243], v[56:59], v[40:43], 0
  v_mfma_f32_16x16x32_bf16 v[248:251], v[56:59], v[44:47], 0
  v_mfma_f32_16x16x32_bf16 v[244:247], v[60:63], v[40:43], 0
  v_mfma_f32_16x16x32_bf16 v[252:255], v[60:63], v[44:47], 0
  s_add_u32 s82, s81, 0
  s_cmp_ge_u32 s82, 40
  s_cbranch_scc1 L_U_skip0
  v_cvt_pk_bf16_f32 v64, v224, v225
  v_cvt_pk_bf16_f32 v65, v226, v227
  v_cvt_pk_bf16_f32 v66, v240, v241
  v_cvt_pk_bf16_f32 v67, v242, v243
  buffer_store_dwordx4 v[64:67], v10, s[16:19], s80 offen offset:0 sc1
  v_cvt_pk_bf16_f32 v88, v228, v229
  v_cvt_pk_bf16_f32 v89, v230, v231
  v_cvt_pk_bf16_f32 v90, v244, v245
  v_cvt_pk_bf16_f32 v91, v246, v247
  buffer_store_dwordx4 v[88:91], v10, s[16:19], s80 offen offset:1024 sc1
  v_cvt_pk_bf16_f32 v112, v232, v233
  v_cvt_pk_bf16_f32 v113, v234, v235
  v_cvt_pk_bf16_f32 v114, v248, v249
  v_cvt_pk_bf16_f32 v115, v250, v251
  buffer_store_dwordx4 v[112:115], v10, s[16:19], s80 offen offset:2048 sc1
  v_cvt_pk_bf16_f32 v136, v236, v237
  v_cvt_pk_bf16_f32 v137, v238, v239
  v_cvt_pk_bf16_f32 v138, v252, v253
  v_cvt_pk_bf16_f32 v139, v254, v255
  buffer_store_dwordx4 v[136:139], v10, s[16:19], s80 offen offset:3072 sc1
L_U_skip0:
  s_nop 7
  s_add_u32 s80, s80, 4096
  v_cvt_pk_bf16_f32 v48, v72, v74
  v_cvt_pk_bf16_f32 v52, v73, v75
  v_cvt_pk_bf16_f32 v56, -v76, -v78
  v_cvt_pk_bf16_f32 v60, -v77, -v79
  v_cvt_pk_bf16_f32 v49, v96, v98
  v_cvt_pk_bf16_f32 v53, v97, v99
  v_cvt_pk_bf16_f32 v57, -v100, -v102
  v_cvt_pk_bf16_f32 v61, -v101, -v103
  v_cvt_pk_bf16_f32 v50, v120, v122
  v_cvt_pk_bf16_f32 v54, v121, v123
  v_cvt_pk_bf16_f32 v58, -v124, -v126
  v_cvt_pk_bf16_f32 v62, -v125, -v127
  v_cvt_pk_bf16_f32 v51, v144, v146
  v_cvt_pk_bf16_f32 v55, v145, v147
  v_cvt_pk_bf16_f32 v59, -v148, -v150
  v_cvt_pk_bf16_f32 v63, -v149, -v151
  v_mfma_f32_16x16x32_bf16 v[224:227], v[48:51], v[40:43], 0
  v_mfma_f32_16x16x32_bf16 v[232:235], v[48:51], v[44:47], 0
  v_mfma_f32_16x16x32_bf16 v[228:231], v[52:55], v[40:43], 0
  v_mfma_f32_16x16x32_bf16 v[236:239], v[52:55], v[44:47], 0
  v_mfma_f32_16x16x32_bf16 v[240:243], v[56:59], v[40:43], 0
  v_mfma_f32_16x16x32_bf16 v[248:251], v[56:59], v[44:47], 0
  v_mfma_f32_16x16x32_bf16 v[244:247], v[60:63], v[40:43], 0
  v_mfma_f32_16x16x32_bf16 v[252:255], v[60:63], v[44:47], 0
  s_add_u32 s82, s81, 1
  s_cmp_ge_u32 s82, 40
  s_cbranch_scc1 L_U_skip1
  v_cvt_pk_bf16_f32 v72, v224, v225
  v_cvt_pk_bf16_f32 v73, v226, v227
  v_cvt_pk_bf16_f32 v74, v240, v241
  v_cvt_pk_bf16_f32 v75, v242, v243
  buffer_store_dwordx4 v[72:75], v10, s[16:19], s80 offen offset:0 sc1
  v_cvt_pk_bf16_f32 v96, v228, v229
  v_cvt_pk_bf16_f32 v97, v230, v231
  v_cvt_pk_bf16_f32 v98, v244, v245
  v_cvt_pk_bf16_f32 v99, v246, v247
  buffer_store_dwordx4 v[96:99], v10, s[16:19], s80 offen offset:1024 sc1
  v_cvt_pk_bf16_f32 v120, v232, v233
  v_cvt_pk_bf16_f32 v121, v234, v235
  v_cvt_pk_bf16_f32 v122, v248, v249
  v_cvt_pk_bf16_f32 v123, v250, v251
  buffer_store_dwordx4 v[120:123], v10, s[16:19], s80 offen offset:2048 sc1
  v_cvt_pk_bf16_f32 v144, v236, v237
  v_cvt_pk_bf16_f32 v145, v238, v239
  v_cvt_pk_bf16_f32 v146, v252, v253
  v_cvt_pk_bf16_f32 v147, v254, v255
  buffer_store_dwordx4 v[144:147], v10, s[16:19], s80 offen offset:3072 sc1
L_U_skip1:
  s_nop 7
  s_add_u32 s80, s80, 4096
  v_cvt_pk_bf16_f32 v48, v80, v82
  v_cvt_pk_bf16_f32 v52, v81, v83
  v_cvt_pk_bf16_f32 v56, -v84, -v86
  v_cvt_pk_bf16_f32 v60, -v85, -v87
  v_cvt_pk_bf16_f32 v49, v104, v106
  v_cvt_pk_bf16_f32 v53, v105, v107
  v_cvt_pk_bf16_f32 v57, -v108, -v110
  v_cvt_pk_bf16_f32 v61, -v109, -v111
  v_cvt_pk_bf16_f32 v50, v128, v130
  v_cvt_pk_bf16_f32 v54, v129, v131
  v_cvt_pk_bf16_f32 v58, -v132, -v134
  v_cvt_pk_bf16_f32 v62, -v133, -v135
  v_cvt_pk_bf16_f32 v51, v152, v154
  v_cvt_pk_bf16_f32 v55, v153, v155
  v_cvt_pk_bf16_f32 v59, -v156, -v158
  v_cvt_pk_bf16_f32 v63, -v157, -v159
  v_mfma_f32_16x16x32_bf16 v[224:227], v[48:51], v[40:43], 0
  v_mfma_f32_16x16x32_bf16 v[232:235], v[48:51], v[44:47], 0
  v_mfma_f32_16x16x32_bf16 v[228:231], v[52:55], v[40:43], 0
  v_mfma_f32_16x16x32_bf16 v[236:239], v[52:55], v[44:47], 0
  v_mfma_f32_16x16x32_bf16 v[240:243], v[56:59], v[40:43], 0
  v_mfma_f32_16x16x32_bf16 v[248:251], v[56:59], v[44:47], 0
  v_mfma_f32_16x16x32_bf16 v[244:247], v[60:63], v[40:43], 0
  v_mfma_f32_16x16x32_bf16 v[252:255], v[60:63], v[44:47], 0
  s_add_u32 s82, s81, 2
  s_cmp_ge_u32 s82, 40
  s_cbranch_scc1 L_U_skip2
  v_cvt_pk_bf16_f32 v80, v224, v225
  v_cvt_pk_bf16_f32 v81, v226, v227
  v_cvt_pk_bf16_f32 v82, v240, v241
  v_cvt_pk_bf16_f32 v83, v242, v243
  buffer_store_dwordx4 v[80:83], v10, s[16:19], s80 offen offset:0 sc1
  v_cvt_pk_bf16_f32 v104, v228, v229
  v_cvt_pk_bf16_f32 v105, v230, v231
  v_cvt_pk_bf16_f32 v106, v244, v245
  v_cvt_pk_bf16_f32 v107, v246, v247
  buffer_store_dwordx4 v[104:107], v10, s[16:19], s80 offen offset:1024 sc1
  v_cvt_pk_bf16_f32 v128, v232, v233
  v_cvt_pk_bf16_f32 v129, v234, v235
  v_cvt_pk_bf16_f32 v130, v248, v249
  v_cvt_pk_bf16_f32 v131, v250, v251
  buffer_store_dwordx4 v[128:131], v10, s[16:19], s80 offen offset:2048 sc1
  v_cvt_pk_bf16_f32 v152, v236, v237
  v_cvt_pk_bf16_f32 v153, v238, v239
  v_cvt_pk_bf16_f32 v154, v252, v253
  v_cvt_pk_bf16_f32 v155, v254, v255
  buffer_store_dwordx4 v[152:155], v10, s[16:19], s80 offen offset:3072 sc1
L_U_skip2:
  s_nop 7
  s_add_u32 s80, s80, 4096
  v_mov_b32 v12, 152608
  v_mov_b32 v13, 1
  s_mov_b64 exec, 1
  ds_add_u32 v12, v13
  s_mov_b64 exec, -1
  s_waitcnt vmcnt(0)
  s_lshr_b32 s80, s72, 1
  s_lshl_b32 s81, s73, 1
  s_add_u32 s80, s80, s81
  s_lshl_b32 s80, s80, 8
  s_lshl_b32 s81, s74, 1
  s_and_b32 s82, s72, 1
  s_add_u32 s81, s81, s82
  s_lshl_b32 s82, s81, 2
  s_cmp_ge_u32 s81, 18
  s_cselect_b32 s81, 56, 0
  s_add_u32 s80, s80, s82
  s_add_u32 s80, s80, s81
  s_add_u32 s80, s80, 17104896
  v_mov_b32 v10, s78
  v_mov_b32 v11, 0
  s_mov_b64 exec, 1
  buffer_store_dword v10, v11, s[16:19], s80 offen sc0 sc1
  s_mov_b64 exec, -1
  s_setprio 0
  s_branch L_SSM_P2
L_LOADER:
  s_sub_u32 s84, s72, 4
  v_lshrrev_b32 v10, 3, v0
  v_and_b32 v11, 7, v0
  v_xor_b32 v11, v11, v10
  v_lshlrev_b32 v11, 4, v11
  s_lshl_b32 s32, s84, 12
  s_mul_i32 s33, s84, 6144
  s_add_u32 s33, s33, 16384
  s_lshl_b32 s85, s73, 7
  s_mul_i32 s80, s75, 96
  s_lshl_b32 s81, s84, 5
  s_add_u32 s80, s80, s81
  v_and_b32 v12, 31, v0
  v_add_u32 v12, s80, v12
  v_min_u32 v12, 639, v12
  v_lshlrev_b32 v12, 1, v12
  s_mov_b32 s20, s38
  s_mov_b32 s21, s39
  s_mov_b32 s22, 1280
  s_mov_b32 s23, 0x20000
  buffer_load_ushort v20, v12, s[20:23], 0 offen
  s_mov_b32 s24, s40
  s_mov_b32 s25, s41
  s_mov_b32 s26, 1280
  s_mov_b32 s27, 0x20000
  buffer_load_ushort v21, v12, s[24:27], 0 offen
  s_mov_b32 s20, s50
  s_mov_b32 s21, s51
  s_mov_b32 s22, 1280
  s_mov_b32 s23, 0x20000
  buffer_load_ushort v22, v12, s[20:23], 0 offen
  s_cmp_eq_u32 s79, 1
  s_cbranch_scc1 L_LD_U
  v_mul_u32_u24 v2, 1280, v10
  v_add_u32 v2, v2, v11
  s_lshl_b32 s80, s84, 5
  s_add_u32 s80, s80, s85
  s_add_u32 s81, s80, 0
  s_mul_i32 s86, s81, 1280
  s_add_u32 s81, s80, 16
  s_mul_i32 s87, s81, 1280
  s_add_u32 s81, s80, 8
  s_mul_i32 s88, s81, 1280
  s_add_u32 s81, s80, 24
  s_mul_i32 s89, s81, 1280
  s_add_u32 m0, s32, 0
  s_nop 0
  buffer_load_dwordx4 v2, s[4:7], s86 offen  lds
  s_add_u32 s86, s86, 128
  s_add_u32 m0, s32, 1024
  s_nop 0
  buffer_load_dwordx4 v2, s[4:7], s87 offen  lds
  s_add_u32 s87, s87, 128
  s_add_u32 m0, s32, 2048
  s_nop 0
  buffer_load_dwordx4 v2, s[4:7], s88 offen  lds
  s_add_u32 s88, s88, 128
  s_add_u32 m0, s32, 3072
  s_nop 0
  buffer_load_dwordx4 v2, s[4:7], s89 offen  lds
  s_add_u32 s89, s89, 128
  s_mov_b32 s8, s56
  s_mov_b32 s9, s57
  s_mov_b32 s10, 2211840
  s_mov_b32 s11, 0x20000
  s_mov_b32 s12, s56
  s_mov_b32 s13, s57
  s_mov_b32 s14, 2211840
  s_mov_b32 s15, 0x20000
  s_mul_i32 s80, s84, 55296
  s_mul_i32 s81, s75, 384
  s_add_u32 s80, s80, s81
  s_mov_b32 s90, s80
  s_mov_b32 s91, s80
  s_mov_b32 s92, s80
  s_mov_b32 s93, s80
  s_mov_b32 s94, s80
  s_mov_b32 s95, s80
  s_mov_b32 s34, 221184
  v_add_u32 v12, 0, v0
  v_mul_u32_u24 v13, 2731, v12
  v_lshrrev_b32 v13, 16, v13
  v_mul_u32_u24 v14, 24, v13
  v_sub_u32 v14, v12, v14
  v_bfe_u32 v15, v13, 1, 1
  v_lshlrev_b32 v15, 1, v15
  v_bfe_u32 v16, v13, 3, 1
  v_lshlrev_b32 v16, 2, v16
  v_or_b32 v15, v15, v16
  v_xor_b32 v14, v14, v15
  v_lshlrev_b32 v14, 4, v14
  v_mul_u32_u24 v13, 3456, v13
  v_add_u32 v4, v13, v14
  v_add_u32 v12, 64, v0
  v_mul_u32_u24 v13, 2731, v12
  v_lshrrev_b32 v13, 16, v13
  v_mul_u32_u24 v14, 24, v13
  v_sub_u32 v14, v12, v14
  v_bfe_u32 v15, v13, 1, 1
  v_lshlrev_b32 v15, 1, v15
  v_bfe_u32 v16, v13, 3, 1
  v_lshlrev_b32 v16, 2, v16
  v_or_b32 v15, v15, v16
  v_xor_b32 v14, v14, v15
  v_lshlrev_b32 v14, 4, v14
  v_mul_u32_u24 v13, 3456, v13
  v_add_u32 v5, v13, v14
  v_add_u32 v12, 128, v0
  v_mul_u32_u24 v13, 2731, v12
  v_lshrrev_b32 v13, 16, v13
  v_mul_u32_u24 v14, 24, v13
  v_sub_u32 v14, v12, v14
  v_bfe_u32 v15, v13, 1, 1
  v_lshlrev_b32 v15, 1, v15
  v_bfe_u32 v16, v13, 3, 1
  v_lshlrev_b32 v16, 2, v16
  v_or_b32 v15, v15, v16
  v_xor_b32 v14, v14, v15
  v_lshlrev_b32 v14, 4, v14
  v_mul_u32_u24 v13, 3456, v13
  v_add_u32 v6, v13, v14
  v_add_u32 v12, 192, v0
  v_mul_u32_u24 v13, 2731, v12
  v_lshrrev_b32 v13, 16, v13
  v_mul_u32_u24 v14, 24, v13
  v_sub_u32 v14, v12, v14
  v_bfe_u32 v15, v13, 1, 1
  v_lshlrev_b32 v15, 1, v15
  v_bfe_u32 v16, v13, 3, 1
  v_lshlrev_b32 v16, 2, v16
  v_or_b32 v15, v15, v16
  v_xor_b32 v14, v14, v15
  v_lshlrev_b32 v14, 4, v14
  v_mul_u32_u24 v13, 3456, v13
  v_add_u32 v7, v13, v14
  v_add_u32 v12, 256, v0
  v_mul_u32_u24 v13, 2731, v12
  v_lshrrev_b32 v13, 16, v13
  v_mul_u32_u24 v14, 24, v13
  v_sub_u32 v14, v12, v14
  v_bfe_u32 v15, v13, 1, 1
  v_lshlrev_b32 v15, 1, v15
  v_bfe_u32 v16, v13, 3, 1
  v_lshlrev_b32 v16, 2, v16
  v_or_b32 v15, v15, v16
  v_xor_b32 v14, v14, v15
  v_lshlrev_b32 v14, 4, v14
  v_mul_u32_u24 v13, 3456, v13
  v_add_u32 v8, v13, v14
  v_add_u32 v12, 320, v0
  v_mul_u32_u24 v13, 2731, v12
  v_lshrrev_b32 v13, 16, v13
  v_mul_u32_u24 v14, 24, v13
  v_sub_u32 v14, v12, v14
  v_bfe_u32 v15, v13, 1, 1
  v_lshlrev_b32 v15, 1, v15
  v_bfe_u32 v16, v13, 3, 1
  v_lshlrev_b32 v16, 2, v16
  v_or_b32 v15, v15, v16
  v_xor_b32 v14, v14, v15
  v_lshlrev_b32 v14, 4, v14
  v_mul_u32_u24 v13, 3456, v13
  v_add_u32 v9, v13, v14
  s_branch L_LD_GO
L_LD_U:
  v_lshrrev_b32 v12, 5, v0
  v_lshlrev_b32 v12, 4, v12
  v_bfe_u32 v13, v0, 3, 1
  v_lshlrev_b32 v13, 3, v13
  v_add_u32 v12, v12, v13
  v_bfe_u32 v13, v0, 4, 1
  v_add_u32 v12, v12, v13
  v_mul_u32_u24 v2, 1280, v12
  v_add_u32 v2, v2, v11
  s_lshr_b32 s80, s84, 1
  s_lshl_b32 s80, s80, 6
  s_and_b32 s81, s84, 1
  s_lshl_b32 s82, s81, 2
  s_add_u32 s80, s80, s82
  s_add_u32 s80, s80, s85
  s_add_u32 s82, s80, 0
  s_mul_i32 s86, s82, 1280
  s_add_u32 s82, s80, 32
  s_mul_i32 s87, s82, 1280
  s_add_u32 s82, s80, 2
  s_mul_i32 s88, s82, 1280
  s_add_u32 s82, s80, 34
  s_mul_i32 s89, s82, 1280
  s_add_u32 m0, s32, 0
  s_nop 0
  buffer_load_dwordx4 v2, s[4:7], s86 offen  lds
  s_add_u32 s86, s86, 128
  s_add_u32 m0, s32, 1024
  s_nop 0
  buffer_load_dwordx4 v2, s[4:7], s87 offen  lds
  s_add_u32 s87, s87, 128
  s_add_u32 m0, s32, 2048
  s_nop 0
  buffer_load_dwordx4 v2, s[4:7], s88 offen  lds
  s_add_u32 s88, s88, 128
  s_add_u32 m0, s32, 3072
  s_nop 0
  buffer_load_dwordx4 v2, s[4:7], s89 offen  lds
  s_add_u32 s89, s89, 128
  v_mul_u32_u24 v12, 1280, v10
  v_add_u32 v12, v12, v11
  v_mov_b32 v4, v12
  v_mov_b32 v5, v12
  v_mov_b32 v6, v12
  v_mov_b32 v7, v12
  v_mov_b32 v8, v12
  v_mov_b32 v9, v12
  s_mul_i32 s80, s75, 96
  s_lshr_b32 s82, s84, 1
  s_mul_i32 s82, s82, 48
  s_add_u32 s80, s80, s82
  s_mul_i32 s83, s81, 3
  s_add_u32 s82, s83, 0
  s_lshr_b32 s82, s82, 1
  s_lshl_b32 s82, s82, 4
  s_add_u32 s82, s82, s80
  s_add_u32 s82, s82, 0
  s_min_u32 s82, s82, 632
  s_mul_i32 s90, s82, 1280
  s_add_u32 s82, s83, 0
  s_lshr_b32 s82, s82, 1
  s_lshl_b32 s82, s82, 4
  s_add_u32 s82, s82, s80
  s_add_u32 s82, s82, 8
  s_min_u32 s82, s82, 632
  s_mul_i32 s91, s82, 1280
  s_add_u32 s82, s83, 1
  s_lshr_b32 s82, s82, 1
  s_lshl_b32 s82, s82, 4
  s_add_u32 s82, s82, s80
  s_add_u32 s82, s82, 0
  s_min_u32 s82, s82, 632
  s_mul_i32 s92, s82, 1280
  s_add_u32 s82, s83, 1
  s_lshr_b32 s82, s82, 1
  s_lshl_b32 s82, s82, 4
  s_add_u32 s82, s82, s80
  s_add_u32 s82, s82, 8
  s_min_u32 s82, s82, 632
  s_mul_i32 s93, s82, 1280
  s_add_u32 s82, s83, 2
  s_lshr_b32 s82, s82, 1
  s_lshl_b32 s82, s82, 4
  s_add_u32 s82, s82, s80
  s_add_u32 s82, s82, 0
  s_min_u32 s82, s82, 632
  s_mul_i32 s94, s82, 1280
  s_add_u32 s82, s83, 2
  s_lshr_b32 s82, s82, 1
  s_lshl_b32 s82, s82, 4
  s_add_u32 s82, s82, s80
  s_add_u32 s82, s82, 8
  s_min_u32 s82, s82, 632
  s_mul_i32 s95, s82, 1280
  s_mov_b32 s34, 128
  s_cmp_eq_u32 s81, 0
  s_cselect_b32 s8, s42, s44
  s_cselect_b32 s9, s43, s45
  s_cselect_b32 s12, s44, s42
  s_cselect_b32 s13, s45, s43
  s_mov_b32 s10, 819200
  s_mov_b32 s11, 0x20000
  s_mov_b32 s14, 819200
  s_mov_b32 s15, 0x20000
L_LD_GO:
  s_add_u32 m0, s33, 0
  s_nop 0
  buffer_load_dwordx4 v4, s[8:11], s90 offen  lds
  s_add_u32 s90, s90, s34
  s_add_u32 m0, s33, 1024
  s_nop 0
  buffer_load_dwordx4 v5, s[8:11], s91 offen  lds
  s_add_u32 s91, s91, s34
  s_add_u32 m0, s33, 2048
  s_nop 0
  buffer_load_dwordx4 v6, s[12:15], s92 offen  lds
  s_add_u32 s92, s92, s34
  s_add_u32 m0, s33, 3072
  s_nop 0
  buffer_load_dwordx4 v7, s[12:15], s93 offen  lds
  s_add_u32 s93, s93, s34
  s_add_u32 m0, s33, 4096
  s_nop 0
  buffer_load_dwordx4 v8, s[8:11], s94 offen  lds
  s_add_u32 s94, s94, s34
  s_add_u32 m0, s33, 5120
  s_nop 0
  buffer_load_dwordx4 v9, s[8:11], s95 offen  lds
  s_add_u32 s95, s95, s34
  s_lshr_b32 s80, s2, 3
  s_and_b32 s81, s80, 7
  s_lshr_b32 s80, s80, 3
  v_mov_b32 v17, 0x10000000
  s_mov_b32 s83, 384
  s_mov_b32 s85, 128
  s_mov_b32 s28, s4
  s_mov_b32 s29, s5
  s_mov_b32 s30, 2621440
  s_mov_b32 s31, 0x20000
  s_cmp_eq_u32 s84, 0
  s_cbranch_scc0 L_GS_1L
  s_lshl_b32 s80, s80, 5
  s_lshl_b32 s82, s73, 7
  s_add_u32 s80, s80, s82
  v_add_u32 v16, s80, v0
  v_mul_u32_u24 v16, 1280, v16
  v_cmp_gt_u32 vcc, 32, v0
  s_nop 1
  v_cndmask_b32 v17, v17, v16, vcc
  s_branch L_GS_doneL
L_GS_1L:
  s_cmp_ge_u32 s84, 3
  s_cbranch_scc1 L_GS_doneL
  s_cmp_eq_u32 s79, 1
  s_cbranch_scc1 L_GS_UL
  s_cmp_eq_u32 s84, 1
  s_cbranch_scc0 L_GS_doneL
  s_mov_b32 s28, s56
  s_mov_b32 s29, s57
  s_mov_b32 s30, 2211840
  s_mul_i32 s83, s75, 384
  s_add_u32 s83, s83, 663552
  s_mov_b32 s85, 221184
  v_mul_u32_u24 v16, 43, v0
  v_lshrrev_b32 v16, 7, v16
  v_mul_u32_u24 v15, 3, v16
  v_sub_u32 v15, v0, v15
  s_lshl_b32 s81, s81, 3
  v_add_u32 v16, s81, v16
  v_mul_u32_u24 v16, 3456, v16
  v_lshlrev_b32 v15, 7, v15
  v_add_u32 v16, v16, v15
  v_cmp_gt_u32 vcc, 24, v0
  s_nop 1
  v_cndmask_b32 v17, v17, v16, vcc
  s_branch L_GS_doneL
L_GS_UL:
  s_cmp_eq_u32 s84, 1
  s_cselect_b32 s28, s42, s44
  s_cselect_b32 s29, s43, s45
  s_mov_b32 s30, 819200
  s_mul_i32 s80, s75, 96
  s_mul_i32 s81, s81, 12
  s_add_u32 s80, s80, s81
  v_add_u32 v16, s80, v0
  v_min_u32 v16, 639, v16
  v_mul_u32_u24 v16, 1280, v16
  v_cmp_gt_u32 vcc, 12, v0
  s_nop 1
  v_cndmask_b32 v17, v17, v16, vcc
L_GS_doneL:
  s_add_u32 m0, s32, 40960
  s_nop 0
  buffer_load_dwordx4 v2, s[4:7], s86 offen  lds
  s_add_u32 s86, s86, 128
  s_add_u32 m0, s32, 41984
  s_nop 0
  buffer_load_dwordx4 v2, s[4:7], s87 offen  lds
  s_add_u32 s87, s87, 128
  s_add_u32 m0, s32, 43008
  s_nop 0
  buffer_load_dwordx4 v2, s[4:7], s88 offen  lds
  s_add_u32 s88, s88, 128
  s_add_u32 m0, s32, 44032
  s_nop 0
  buffer_load_dwordx4 v2, s[4:7], s89 offen  lds
  s_add_u32 s89, s89, 128
  s_add_u32 m0, s33, 40960
  s_nop 0
  buffer_load_dwordx4 v4, s[8:11], s90 offen  lds
  s_add_u32 s90, s90, s34
  s_add_u32 m0, s33, 41984
  s_nop 0
  buffer_load_dwordx4 v5, s[8:11], s91 offen  lds
  s_add_u32 s91, s91, s34
  s_add_u32 m0, s33, 43008
  s_nop 0
  buffer_load_dwordx4 v6, s[12:15], s92 offen  lds
  s_add_u32 s92, s92, s34
  s_add_u32 m0, s33, 44032
  s_nop 0
  buffer_load_dwordx4 v7, s[12:15], s93 offen  lds
  s_add_u32 s93, s93, s34
  s_add_u32 m0, s33, 45056
  s_nop 0
  buffer_load_dwordx4 v8, s[8:11], s94 offen  lds
  s_add_u32 s94, s94, s34
  s_add_u32 m0, s33, 46080
  s_nop 0
  buffer_load_dwordx4 v9, s[8:11], s95 offen  lds
  s_add_u32 s95, s95, s34
  s_waitcnt vmcnt(10)
  s_barrier
  s_add_u32 m0, s32, 81920
  s_nop 0
  buffer_load_dwordx4 v2, s[4:7], s86 offen  lds
  s_add_u32 s86, s86, 128
  s_add_u32 m0, s32, 82944
  s_nop 0
  buffer_load_dwordx4 v2, s[4:7], s87 offen  lds
  s_add_u32 s87, s87, 128
  s_add_u32 m0, s32, 83968
  s_nop 0
  buffer_load_dwordx4 v2, s[4:7], s88 offen  lds
  s_add_u32 s88, s88, 128
  s_add_u32 m0, s32, 84992
  s_nop 0
  buffer_load_dwordx4 v2, s[4:7], s89 offen  lds
  s_add_u32 s89, s89, 128
  s_add_u32 m0, s33, 81920
  s_nop 0
  buffer_load_dwordx4 v4, s[8:11], s90 offen  lds
  s_add_u32 s90, s90, s34
  s_add_u32 m0, s33, 82944
  s_nop 0
  buffer_load_dwordx4 v5, s[8:11], s91 offen  lds
  s_add_u32 s91, s91, s34
  s_add_u32 m0, s33, 83968
  s_nop 0
  buffer_load_dwordx4 v6, s[12:15], s92 offen  lds
  s_add_u32 s92, s92, s34
  s_add_u32 m0, s33, 84992
  s_nop 0
  buffer_load_dwordx4 v7, s[12:15], s93 offen  lds
  s_add_u32 s93, s93, s34
  s_add_u32 m0, s33, 86016
  s_nop 0
  buffer_load_dwordx4 v8, s[8:11], s94 offen  lds
  s_add_u32 s94, s94, s34
  s_add_u32 m0, s33, 87040
  s_nop 0
  buffer_load_dwordx4 v9, s[8:11], s95 offen  lds
  s_add_u32 s95, s95, s34
  buffer_load_dword v18, v17, s[28:31], s83 offen
  s_add_u32 s83, s83, s85
  s_waitcnt vmcnt(11)
  s_barrier
  s_lshl_b32 s80, s84, 8
  s_add_u32 s80, s80, 143360
  s_mov_b32 s81, 152640
  s_cmp_eq_u32 s84, 3
  s_cselect_b32 s96, s81, s80
  s_add_u32 m0, s32, 0
  s_nop 0
  buffer_load_dwordx4 v2, s[4:7], s86 offen  lds
  s_add_u32 s86, s86, 128
  v_lshlrev_b32 v20, 16, v20
  v_lshlrev_b32 v21, 16, v21
  v_lshlrev_b32 v22, 16, v22
  s_add_u32 m0, s32, 1024
  s_nop 0
  buffer_load_dwordx4 v2, s[4:7], s87 offen  lds
  s_add_u32 s87, s87, 128
  v_mul_f32 v23, 0x3fb8aa3b, v22
  v_exp_f32 v23, v23
  s_nop 0
  s_add_u32 m0, s32, 2048
  s_nop 0
  buffer_load_dwordx4 v2, s[4:7], s88 offen  lds
  s_add_u32 s88, s88, 128
  v_cvt_pk_bf16_f32 v23, v23, v23
  v_and_b32 v23, 0xffff0000, v23
  v_mul_f32 v24, v23, v20
  s_add_u32 m0, s32, 3072
  s_nop 0
  buffer_load_dwordx4 v2, s[4:7], s89 offen  lds
  s_add_u32 s89, s89, 128
  v_mul_f32 v25, v23, v21
  v_mul_f32 v24, 0x3fb8aa3b, v24
  v_exp_f32 v24, v24
  s_add_u32 m0, s33, 0
  s_nop 0
  buffer_load_dwordx4 v4, s[8:11], s90 offen  lds
  s_add_u32 s90, s90, s34
  v_mul_f32 v25, 0.15915494, v25
  v_fract_f32 v25, v25
  v_sin_f32 v26, v25
  s_add_u32 m0, s33, 1024
  s_nop 0
  buffer_load_dwordx4 v5, s[8:11], s91 offen  lds
  s_add_u32 s91, s91, s34
  v_cos_f32 v27, v25
  s_nop 0
  v_mul_f32 v31, v24, v26
  s_add_u32 m0, s33, 2048
  s_nop 0
  buffer_load_dwordx4 v6, s[12:15], s92 offen  lds
  s_add_u32 s92, s92, s34
  v_mul_f32 v30, v24, v27
  v_mul_f32 v32, v30, v30
  v_mul_f32 v33, v30, v31
  s_add_u32 m0, s33, 3072
  s_nop 0
  buffer_load_dwordx4 v7, s[12:15], s93 offen  lds
  s_add_u32 s93, s93, s34
  v_fma_f32 v32, -v31, v31, v32
  v_fma_f32 v33, v31, v30, v33
  s_add_u32 m0, s33, 4096
  s_nop 0
  buffer_load_dwordx4 v8, s[8:11], s94 offen  lds
  s_add_u32 s94, s94, s34
  s_add_u32 m0, s33, 5120
  s_nop 0
  buffer_load_dwordx4 v9, s[8:11], s95 offen  lds
  s_add_u32 s95, s95, s34
  buffer_load_dword v18, v17, s[28:31], s83 offen
  s_add_u32 s83, s83, s85
  s_waitcnt vmcnt(12)
  s_barrier
  s_add_u32 m0, s32, 40960
  s_nop 0
  buffer_load_dwordx4 v2, s[4:7], s86 offen  lds
  s_add_u32 s86, s86, 128
  v_mul_f32 v34, v32, v32
  v_mul_f32 v35, v32, v33
  v_fma_f32 v34, -v33, v33, v34
  s_add_u32 m0, s32, 41984
  s_nop 0
  buffer_load_dwordx4 v2, s[4:7], s87 offen  lds
  s_add_u32 s87, s87, 128
  v_fma_f32 v35, v33, v32, v35
  v_mul_f32 v36, v34, v34
  v_mul_f32 v37, v34, v35
  s_add_u32 m0, s32, 43008
  s_nop 0
  buffer_load_dwordx4 v2, s[4:7], s88 offen  lds
  s_add_u32 s88, s88, 128
  v_fma_f32 v36, -v35, v35, v36
  v_fma_f32 v37, v35, v34, v37
  v_mul_f32 v38, v36, v36
  s_add_u32 m0, s32, 44032
  s_nop 0
  buffer_load_dwordx4 v2, s[4:7], s89 offen  lds
  s_add_u32 s89, s89, 128
  v_mul_f32 v39, v36, v37
  v_fma_f32 v38, -v37, v37, v38
  v_fma_f32 v39, v37, v36, v39
  s_add_u32 m0, s33, 40960
  s_nop 0
  buffer_load_dwordx4 v4, s[8:11], s90 offen  lds
  s_add_u32 s90, s90, s34
  v_mul_f32 v40, v38, v38
  v_mul_f32 v41, v38, v39
  v_fma_f32 v40, -v39, v39, v40
  s_add_u32 m0, s33, 41984
  s_nop 0
  buffer_load_dwordx4 v5, s[8:11], s91 offen  lds
  s_add_u32 s91, s91, s34
  v_fma_f32 v41, v39, v38, v41
  v_mul_f32 v42, v40, v38
  v_mul_f32 v43, v40, v39
  s_add_u32 m0, s33, 43008
  s_nop 0
  buffer_load_dwordx4 v6, s[12:15], s92 offen  lds
  s_add_u32 s92, s92, s34
  v_fma_f32 v42, -v41, v39, v42
  v_fma_f32 v43, v41, v38, v43
  v_mul_f32 v44, v40, v40
  s_add_u32 m0, s33, 44032
  s_nop 0
  buffer_load_dwordx4 v7, s[12:15], s93 offen  lds
  s_add_u32 s93, s93, s34
  v_mul_f32 v45, v40, v41
  v_fma_f32 v44, -v41, v41, v44
  s_add_u32 m0, s33, 45056
  s_nop 0
  buffer_load_dwordx4 v8, s[8:11], s94 offen  lds
  s_add_u32 s94, s94, s34
  s_add_u32 m0, s33, 46080
  s_nop 0
  buffer_load_dwordx4 v9, s[8:11], s95 offen  lds
  s_add_u32 s95, s95, s34
  buffer_load_dword v18, v17, s[28:31], s83 offen
  s_add_u32 s83, s83, s85
  s_waitcnt vmcnt(12)
  s_barrier
  s_add_u32 m0, s32, 81920
  s_nop 0
  buffer_load_dwordx4 v2, s[4:7], s86 offen  lds
  s_add_u32 s86, s86, 128
  v_fma_f32 v45, v41, v40, v45
  v_mul_f32 v46, v44, v44
  v_mul_f32 v47, v44, v45
  s_add_u32 m0, s32, 82944
  s_nop 0
  buffer_load_dwordx4 v2, s[4:7], s87 offen  lds
  s_add_u32 s87, s87, 128
  v_fma_f32 v46, -v45, v45, v46
  v_fma_f32 v47, v45, v44, v47
  v_and_b32 v62, 31, v0
  s_add_u32 m0, s32, 83968
  s_nop 0
  buffer_load_dwordx4 v2, s[4:7], s88 offen  lds
  s_add_u32 s88, s88, 128
  v_lshlrev_b32 v62, 3, v62
  v_add_u32 v62, s96, v62
  v_mul_f32 v48, v46, v46
  s_add_u32 m0, s32, 84992
  s_nop 0
  buffer_load_dwordx4 v2, s[4:7], s89 offen  lds
  s_add_u32 s89, s89, 128
  v_mul_f32 v49, v46, v47
  v_fma_f32 v48, -v47, v47, v48
  v_fma_f32 v49, v47, v46, v49
  s_add_u32 m0, s33, 81920
  s_nop 0
  buffer_load_dwordx4 v4, s[8:11], s90 offen  lds
  s_add_u32 s90, s90, s34
  v_mul_f32 v50, v48, v48
  v_mul_f32 v51, v48, v49
  v_fma_f32 v50, -v49, v49, v50
  s_add_u32 m0, s33, 82944
  s_nop 0
  buffer_load_dwordx4 v5, s[8:11], s91 offen  lds
  s_add_u32 s91, s91, s34
  v_fma_f32 v51, v49, v48, v51
  v_mul_f32 v52, v50, v50
  v_mul_f32 v53, v50, v51
  s_add_u32 m0, s33, 83968
  s_nop 0
  buffer_load_dwordx4 v6, s[12:15], s92 offen  lds
  s_add_u32 s92, s92, s34
  v_fma_f32 v52, -v51, v51, v52
  v_fma_f32 v53, v51, v50, v53
  v_add_f32 v56, -1.0, v30
  s_add_u32 m0, s33, 84992
  s_nop 0
  buffer_load_dwordx4 v7, s[12:15], s93 offen  lds
  s_add_u32 s93, s93, s34
  v_mul_f32 v57, v20, v20
  v_fma_f32 v57, v21, v21, v57
  v_rcp_f32 v57, v57
  s_add_u32 m0, s33, 86016
  s_nop 0
  buffer_load_dwordx4 v8, s[8:11], s94 offen  lds
  s_add_u32 s94, s94, s34
  v_mul_f32 v58, v56, v20
  s_add_u32 m0, s33, 87040
  s_nop 0
  buffer_load_dwordx4 v9, s[8:11], s95 offen  lds
  s_add_u32 s95, s95, s34
  buffer_load_dword v18, v17, s[28:31], s83 offen
  s_add_u32 s83, s83, s85
  s_waitcnt vmcnt(12)
  s_barrier
  s_add_u32 m0, s32, 0
  s_nop 0
  buffer_load_dwordx4 v2, s[4:7], s86 offen  lds
  s_add_u32 s86, s86, 128
  v_fma_f32 v58, v31, v21, v58
  v_mul_f32 v59, v31, v20
  s_add_u32 m0, s32, 1024
  s_nop 0
  buffer_load_dwordx4 v2, s[4:7], s87 offen  lds
  s_add_u32 s87, s87, 128
  v_fma_f32 v59, -v56, v21, v59
  v_add_f32 v57, v57, v57
  s_add_u32 m0, s32, 2048
  s_nop 0
  buffer_load_dwordx4 v2, s[4:7], s88 offen  lds
  s_add_u32 s88, s88, 128
  v_mul_f32 v54, v58, v57
  v_mul_f32 v55, v59, v57
  s_add_u32 m0, s32, 3072
  s_nop 0
  buffer_load_dwordx4 v2, s[4:7], s89 offen  lds
  s_add_u32 s89, s89, 128
  v_mov_b32 v60, 1.0
  v_mov_b32 v61, 0
  s_add_u32 m0, s33, 0
  s_nop 0
  buffer_load_dwordx4 v4, s[8:11], s90 offen  lds
  s_add_u32 s90, s90, s34
  ds_write_b64 v62, v[30:31] offset:0
  ds_write_b64 v62, v[36:37] offset:768
  s_add_u32 m0, s33, 1024
  s_nop 0
  buffer_load_dwordx4 v5, s[8:11], s91 offen  lds
  s_add_u32 s91, s91, s34
  ds_write_b64 v62, v[60:61] offset:1536
  ds_write_b64 v62, v[38:39] offset:2304
  s_add_u32 m0, s33, 2048
  s_nop 0
  buffer_load_dwordx4 v6, s[12:15], s92 offen  lds
  s_add_u32 s92, s92, s34
  ds_write_b64 v62, v[40:41] offset:3072
  ds_write_b64 v62, v[42:43] offset:3840
  s_add_u32 m0, s33, 3072
  s_nop 0
  buffer_load_dwordx4 v7, s[12:15], s93 offen  lds
  s_add_u32 s93, s93, s34
  ds_write_b64 v62, v[44:45] offset:4608
  ds_write_b64 v62, v[46:47] offset:5376
  s_add_u32 m0, s33, 4096
  s_nop 0
  buffer_load_dwordx4 v8, s[8:11], s94 offen  lds
  s_add_u32 s94, s94, s34
  ds_write_b64 v62, v[50:51] offset:6144
  ds_write_b64 v62, v[52:53] offset:6912
  s_add_u32 m0, s33, 5120
  s_nop 0
  buffer_load_dwordx4 v9, s[8:11], s95 offen  lds
  s_add_u32 s95, s95, s34
  ds_write_b64 v62, v[54:55] offset:7680
  s_waitcnt lgkmcnt(0)
  buffer_load_dword v18, v17, s[28:31], s83 offen
  s_add_u32 s83, s83, s85
  s_mov_b32 s20, s68
  s_mov_b32 s21, s69
  s_mov_b32 s22, 256
  s_mov_b32 s23, 0x20000
  v_mov_b32 v12, 0
  buffer_load_dword v99, v12, s[20:23], 0 offen
  s_waitcnt vmcnt(12)
  s_barrier
  s_add_u32 m0, s32, 40960
  s_nop 0
  buffer_load_dwordx4 v2, s[4:7], s86 offen  lds
  s_add_u32 s86, s86, 128
  s_add_u32 m0, s32, 41984
  s_nop 0
  buffer_load_dwordx4 v2, s[4:7], s87 offen  lds
  s_add_u32 s87, s87, 128
  s_add_u32 m0, s32, 43008
  s_nop 0
  buffer_load_dwordx4 v2, s[4:7], s88 offen  lds
  s_add_u32 s88, s88, 128
  s_add_u32 m0, s32, 44032
  s_nop 0
  buffer_load_dwordx4 v2, s[4:7], s89 offen  lds
  s_add_u32 s89, s89, 128
  s_add_u32 m0, s33, 40960
  s_nop 0
  buffer_load_dwordx4 v4, s[8:11], s90 offen  lds
  s_add_u32 s90, s90, s34
  s_add_u32 m0, s33, 41984
  s_nop 0
  buffer_load_dwordx4 v5, s[8:11], s91 offen  lds
  s_add_u32 s91, s91, s34
  s_add_u32 m0, s33, 43008
  s_nop 0
  buffer_load_dwordx4 v6, s[12:15], s92 offen  lds
  s_add_u32 s92, s92, s34
  s_add_u32 m0, s33, 44032
  s_nop 0
  buffer_load_dwordx4 v7, s[12:15], s93 offen  lds
  s_add_u32 s93, s93, s34
  s_add_u32 m0, s33, 45056
  s_nop 0
  buffer_load_dwordx4 v8, s[8:11], s94 offen  lds
  s_add_u32 s94, s94, s34
  s_add_u32 m0, s33, 46080
  s_nop 0
  buffer_load_dwordx4 v9, s[8:11], s95 offen  lds
  s_add_u32 s95, s95, s34
  buffer_load_dword v18, v17, s[28:31], s83 offen
  s_add_u32 s83, s83, s85
  s_waitcnt vmcnt(12)
  s_barrier
  s_add_u32 m0, s32, 81920
  s_nop 0
  buffer_load_dwordx4 v2, s[4:7], s86 offen  lds
  s_add_u32 s86, s86, 128
  s_add_u32 m0, s32, 82944
  s_nop 0
  buffer_load_dwordx4 v2, s[4:7], s87 offen  lds
  s_add_u32 s87, s87, 128
  s_add_u32 m0, s32, 83968
  s_nop 0
  buffer_load_dwordx4 v2, s[4:7], s88 offen  lds
  s_add_u32 s88, s88, 128
  s_add_u32 m0, s32, 84992
  s_nop 0
  buffer_load_dwordx4 v2, s[4:7], s89 offen  lds
  s_add_u32 s89, s89, 128
  s_add_u32 m0, s33, 81920
  s_nop 0
  buffer_load_dwordx4 v4, s[8:11], s90 offen  lds
  s_add_u32 s90, s90, s34
  s_add_u32 m0, s33, 82944
  s_nop 0
  buffer_load_dwordx4 v5, s[8:11], s91 offen  lds
  s_add_u32 s91, s91, s34
  s_add_u32 m0, s33, 83968
  s_nop 0
  buffer_load_dwordx4 v6, s[12:15], s92 offen  lds
  s_add_u32 s92, s92, s34
  s_add_u32 m0, s33, 84992
  s_nop 0
  buffer_load_dwordx4 v7, s[12:15], s93 offen  lds
  s_add_u32 s93, s93, s34
  s_add_u32 m0, s33, 86016
  s_nop 0
  buffer_load_dwordx4 v8, s[8:11], s94 offen  lds
  s_add_u32 s94, s94, s34
  s_add_u32 m0, s33, 87040
  s_nop 0
  buffer_load_dwordx4 v9, s[8:11], s95 offen  lds
  s_add_u32 s95, s95, s34
  buffer_load_dword v18, v17, s[28:31], s83 offen
  s_add_u32 s83, s83, s85
  s_waitcnt vmcnt(12)
  s_barrier
  v_readfirstlane_b32 s78, v99
  s_nop 0
  s_cmp_eq_u32 s78, 0
  s_cbranch_scc0 L_LD_nonce_ok
  s_mov_b32 s20, s68
  s_mov_b32 s21, s69
  s_mov_b32 s22, 256
  s_mov_b32 s23, 0x20000
  v_mov_b32 v11, 0
  s_mov_b32 s80, 0
L_nonce_L:
  buffer_load_dword v10, v11, s[20:23], 0 offen sc1
  s_add_u32 s80, s80, 1
  s_waitcnt vmcnt(0)
  v_readfirstlane_b32 s78, v10
  s_cmp_ge_u32 s80, 2000000
  s_cbranch_scc1 L_nonce_done_L
  s_cmp_eq_u32 s78, 0
  s_cbranch_scc0 L_nonce_done_L
  s_sleep 1
  s_branch L_nonce_L
L_nonce_done_L:
L_LD_nonce_ok:
  s_mul_i32 s85, s84, 14
  s_cmp_eq_u32 s84, 3
  s_cselect_b32 s80, 1, 0
  s_sub_u32 s85, s85, s80
  v_lshlrev_b32 v12, 2, v0
  s_lshl_b32 s81, s77, 9
  s_lshl_b32 s82, s85, 2
  s_add_u32 s81, s81, s82
  s_add_u32 s35, s81, 17039360
  s_mul_i32 s80, s84, 10
  s_add_u32 s80, s80, 38
  s_sub_u32 s80, s80, s85
  s_lshl_b32 s80, s80, 2
  v_add_u32 v14, s80, v12
  v_cmp_le_u32 vcc, 16, v0
  s_nop 1
  v_cndmask_b32 v12, v12, v14, vcc
  v_lshlrev_b32 v1, 4, v0
  buffer_load_dword v13, v12, s[16:19], s35 offen sc1
  s_add_u32 m0, s32, 0
  s_nop 0
  buffer_load_dwordx4 v2, s[4:7], s86 offen  lds
  s_add_u32 s86, s86, 128
  s_add_u32 m0, s32, 1024
  s_nop 0
  buffer_load_dwordx4 v2, s[4:7], s87 offen  lds
  s_add_u32 s87, s87, 128
  s_add_u32 m0, s32, 2048
  s_nop 0
  buffer_load_dwordx4 v2, s[4:7], s88 offen  lds
  s_add_u32 s88, s88, 128
  s_add_u32 m0, s32, 3072
  s_nop 0
  buffer_load_dwordx4 v2, s[4:7], s89 offen  lds
  s_add_u32 s89, s89, 128
  s_add_u32 m0, s33, 0
  s_nop 0
  buffer_load_dwordx4 v4, s[8:11], s90 offen  lds
  s_add_u32 s90, s90, s34
  s_add_u32 m0, s33, 1024
  s_nop 0
  buffer_load_dwordx4 v5, s[8:11], s91 offen  lds
  s_add_u32 s91, s91, s34
  s_add_u32 m0, s33, 2048
  s_nop 0
  buffer_load_dwordx4 v6, s[12:15], s92 offen  lds
  s_add_u32 s92, s92, s34
  s_add_u32 m0, s33, 3072
  s_nop 0
  buffer_load_dwordx4 v7, s[12:15], s93 offen  lds
  s_add_u32 s93, s93, s34
  s_add_u32 m0, s33, 4096
  s_nop 0
  buffer_load_dwordx4 v8, s[8:11], s94 offen  lds
  s_add_u32 s94, s94, s34
  s_add_u32 m0, s33, 5120
  s_nop 0
  buffer_load_dwordx4 v9, s[8:11], s95 offen  lds
  s_add_u32 s95, s95, s34
  s_waitcnt vmcnt(10)
  s_barrier
  s_mov_b32 s86, s84
  s_mul_i32 s87, s86, 20480
  s_mul_i32 s84, s77, 94
  s_add_u32 s84, s84, s85
  s_mul_i32 s84, s84, 5120
  s_add_u32 s84, s84, 12582912
  s_cmp_ge_u32 s86, 2
  s_cselect_b32 s89, 13, 14
  v_cmp_ne_u32 vcc, s78, v13
  s_nop 1
  s_and_b32 s80, vcc_lo, 0x03ff3fff
  s_cbranch_scc1 L_LD_wlate
  buffer_load_dwordx4 v[96:99], v1, s[16:19], s84 offen offset:0 sc1
  buffer_load_dwordx4 v[100:103], v1, s[16:19], s84 offen offset:1024 sc1
  buffer_load_dwordx4 v[104:107], v1, s[16:19], s84 offen offset:2048 sc1
  buffer_load_dwordx4 v[108:111], v1, s[16:19], s84 offen offset:3072 sc1
  s_add_u32 s84, s84, 4096
  buffer_load_dwordx4 v[112:115], v1, s[16:19], s84 offen sc1
  s_add_u32 s84, s84, 1024
  buffer_load_dwordx4 v[116:119], v1, s[16:19], s84 offen offset:0 sc1
  buffer_load_dwordx4 v[120:123], v1, s[16:19], s84 offen offset:1024 sc1
  buffer_load_dwordx4 v[124:127], v1, s[16:19], s84 offen offset:2048 sc1
  buffer_load_dwordx4 v[128:131], v1, s[16:19], s84 offen offset:3072 sc1
  s_add_u32 s84, s84, 4096
  buffer_load_dwordx4 v[132:135], v1, s[16:19], s84 offen sc1
  s_add_u32 s84, s84, 1024
  s_waitcnt vmcnt(10)
  s_barrier
  buffer_load_dwordx4 v[136:139], v1, s[16:19], s84 offen offset:0 sc1
  buffer_load_dwordx4 v[140:143], v1, s[16:19], s84 offen offset:1024 sc1
  buffer_load_dwordx4 v[144:147], v1, s[16:19], s84 offen offset:2048 sc1
  buffer_load_dwordx4 v[148:151], v1, s[16:19], s84 offen offset:3072 sc1
  s_add_u32 s84, s84, 4096
  buffer_load_dwordx4 v[152:155], v1, s[16:19], s84 offen sc1
  s_add_u32 s84, s84, 1024
  buffer_load_dwordx4 v[156:159], v1, s[16:19], s84 offen offset:0 sc1
  buffer_load_dwordx4 v[160:163], v1, s[16:19], s84 offen offset:1024 sc1
  buffer_load_dwordx4 v[164:167], v1, s[16:19], s84 offen offset:2048 sc1
  buffer_load_dwordx4 v[168:171], v1, s[16:19], s84 offen offset:3072 sc1
  s_add_u32 s84, s84, 4096
  buffer_load_dwordx4 v[172:175], v1, s[16:19], s84 offen sc1
  s_add_u32 s84, s84, 1024
  buffer_load_dwordx4 v[176:179], v1, s[16:19], s84 offen offset:0 sc1
  buffer_load_dwordx4 v[180:183], v1, s[16:19], s84 offen offset:1024 sc1
  buffer_load_dwordx4 v[184:187], v1, s[16:19], s84 offen offset:2048 sc1
  buffer_load_dwordx4 v[188:191], v1, s[16:19], s84 offen offset:3072 sc1
  s_add_u32 s84, s84, 4096
  buffer_load_dwordx4 v[192:195], v1, s[16:19], s84 offen sc1
  s_add_u32 s84, s84, 1024
  s_branch L_LD_wdone
L_LD_wlate:
  s_waitcnt vmcnt(0)
  s_barrier
  s_mov_b32 s80, 0
  s_mov_b32 s82, 67059711
  s_mov_b32 s83, 0
L_poll_FW:
  buffer_load_dword v13, v12, s[16:19], s35 offen sc1
  s_add_u32 s80, s80, 1
  s_waitcnt vmcnt(0)
  v_cmp_ne_u32 vcc, s78, v13
  s_cmp_ge_u32 s80, 2000000
  s_cbranch_scc1 L_poll_done_FW
  s_and_b64 vcc, vcc, s[82:83]
  s_cbranch_scc0 L_poll_done_FW
  s_sleep 1
  s_branch L_poll_FW
L_poll_done_FW:
  buffer_load_dwordx4 v[96:99], v1, s[16:19], s84 offen offset:0 sc1
  buffer_load_dwordx4 v[100:103], v1, s[16:19], s84 offen offset:1024 sc1
  buffer_load_dwordx4 v[104:107], v1, s[16:19], s84 offen offset:2048 sc1
  buffer_load_dwordx4 v[108:111], v1, s[16:19], s84 offen offset:3072 sc1
  s_add_u32 s84, s84, 4096
  buffer_load_dwordx4 v[112:115], v1, s[16:19], s84 offen sc1
  s_add_u32 s84, s84, 1024
  buffer_load_dwordx4 v[116:119], v1, s[16:19], s84 offen offset:0 sc1
  buffer_load_dwordx4 v[120:123], v1, s[16:19], s84 offen offset:1024 sc1
  buffer_load_dwordx4 v[124:127], v1, s[16:19], s84 offen offset:2048 sc1
  buffer_load_dwordx4 v[128:131], v1, s[16:19], s84 offen offset:3072 sc1
  s_add_u32 s84, s84, 4096
  buffer_load_dwordx4 v[132:135], v1, s[16:19], s84 offen sc1
  s_add_u32 s84, s84, 1024
  buffer_load_dwordx4 v[136:139], v1, s[16:19], s84 offen offset:0 sc1
  buffer_load_dwordx4 v[140:143], v1, s[16:19], s84 offen offset:1024 sc1
  buffer_load_dwordx4 v[144:147], v1, s[16:19], s84 offen offset:2048 sc1
  buffer_load_dwordx4 v[148:151], v1, s[16:19], s84 offen offset:3072 sc1
  s_add_u32 s84, s84, 4096
  buffer_load_dwordx4 v[152:155], v1, s[16:19], s84 offen sc1
  s_add_u32 s84, s84, 1024
  buffer_load_dwordx4 v[156:159], v1, s[16:19], s84 offen offset:0 sc1
  buffer_load_dwordx4 v[160:163], v1, s[16:19], s84 offen offset:1024 sc1
  buffer_load_dwordx4 v[164:167], v1, s[16:19], s84 offen offset:2048 sc1
  buffer_load_dwordx4 v[168:171], v1, s[16:19], s84 offen offset:3072 sc1
  s_add_u32 s84, s84, 4096
  buffer_load_dwordx4 v[172:175], v1, s[16:19], s84 offen sc1
  s_add_u32 s84, s84, 1024
  buffer_load_dwordx4 v[176:179], v1, s[16:19], s84 offen offset:0 sc1
  buffer_load_dwordx4 v[180:183], v1, s[16:19], s84 offen offset:1024 sc1
  buffer_load_dwordx4 v[184:187], v1, s[16:19], s84 offen offset:2048 sc1
  buffer_load_dwordx4 v[188:191], v1, s[16:19], s84 offen offset:3072 sc1
  s_add_u32 s84, s84, 4096
  buffer_load_dwordx4 v[192:195], v1, s[16:19], s84 offen sc1
  s_add_u32 s84, s84, 1024
L_LD_wdone:
  s_mov_b32 s20, s64
  s_mov_b32 s21, s65
  s_mov_b32 s22, 1280
  s_mov_b32 s23, 0x20000
  s_mov_b32 s24, s36
  s_mov_b32 s25, s37
  s_mov_b32 s26, 2621440
  s_mov_b32 s27, 0x20000
  v_lshlrev_b32 v12, 4, v0
  v_lshlrev_b32 v13, 2, v0
  s_lshl_b32 s80, s2, 3
  s_lshl_b32 s81, s86, 1
  s_add_u32 s80, s80, s81
  s_mul_i32 s81, s80, 1280
  s_add_u32 s82, s81, 1280
  buffer_load_dwordx4 v[16:19], v12, s[20:23], 0 offen
  buffer_load_dword v20, v13, s[20:23], 0 offen offset:1024
  buffer_load_dwordx4 v[22:25], v12, s[24:27], s81 offen
  buffer_load_dword v26, v13, s[24:27], s81 offen offset:1024
  buffer_load_dwordx4 v[28:31], v12, s[24:27], s82 offen
  buffer_load_dword v32, v13, s[24:27], s82 offen offset:1024
  s_mov_b32 s20, s62
  s_mov_b32 s21, s63
  s_mov_b32 s22, 1280
  s_mov_b32 s23, 0x20000
  v_lshrrev_b32 v4, 4, v0
  v_lshlrev_b32 v4, 3, v4
  v_mov_b32 v5, 0x10000000
  s_cmp_eq_u32 s86, 0
  s_cselect_b32 s80, 0, 1
  v_mov_b32 v6, s80
  v_cmp_eq_u32 vcc, 1, v6
  s_nop 1
  v_cndmask_b32 v4, v4, v5, vcc
  s_mul_i32 s81, s77, 160
  buffer_load_dwordx2 v[244:245], v4, s[20:23], s81 offen offset:0
  buffer_load_dwordx2 v[246:247], v4, s[20:23], s81 offen offset:32
  buffer_load_dwordx2 v[248:249], v4, s[20:23], s81 offen offset:64
  buffer_load_dwordx2 v[250:251], v4, s[20:23], s81 offen offset:96
  buffer_load_dwordx2 v[252:253], v4, s[20:23], s81 offen offset:128
  s_mov_b32 s88, s84
  s_mov_b32 s84, s86
  s_waitcnt vmcnt(0)
  v_mov_b32 v40, 0
  v_mov_b32 v41, 0
  v_lshlrev_b32 v36, 16, v16
  v_and_b32 v37, 0xffff0000, v16
  v_lshlrev_b32 v38, 16, v22
  v_and_b32 v39, 0xffff0000, v22
  v_mul_f32 v38, v38, v36
  v_mul_f32 v39, v39, v37
  v_cvt_pk_bf16_f32 v38, v38, v39
  v_lshlrev_b32 v39, 16, v38
  v_and_b32 v38, 0xffff0000, v38
  v_add_f32 v40, v40, v39
  v_add_f32 v40, v40, v38
  v_lshlrev_b32 v38, 16, v28
  v_and_b32 v39, 0xffff0000, v28
  v_mul_f32 v38, v38, v36
  v_mul_f32 v39, v39, v37
  v_cvt_pk_bf16_f32 v38, v38, v39
  v_lshlrev_b32 v39, 16, v38
  v_and_b32 v38, 0xffff0000, v38
  v_add_f32 v41, v41, v39
  v_add_f32 v41, v41, v38
  v_lshlrev_b32 v36, 16, v17
  v_and_b32 v37, 0xffff0000, v17
  v_lshlrev_b32 v38, 16, v23
  v_and_b32 v39, 0xffff0000, v23
  v_mul_f32 v38, v38, v36
  v_mul_f32 v39, v39, v37
  v_cvt_pk_bf16_f32 v38, v38, v39
  v_lshlrev_b32 v39, 16, v38
  v_and_b32 v38, 0xffff0000, v38
  v_add_f32 v40, v40, v39
  v_add_f32 v40, v40, v38
  v_lshlrev_b32 v38, 16, v29
  v_and_b32 v39, 0xffff0000, v29
  v_mul_f32 v38, v38, v36
  v_mul_f32 v39, v39, v37
  v_cvt_pk_bf16_f32 v38, v38, v39
  v_lshlrev_b32 v39, 16, v38
  v_and_b32 v38, 0xffff0000, v38
  v_add_f32 v41, v41, v39
  v_add_f32 v41, v41, v38
  v_lshlrev_b32 v36, 16, v18
  v_and_b32 v37, 0xffff0000, v18
  v_lshlrev_b32 v38, 16, v24
  v_and_b32 v39, 0xffff0000, v24
  v_mul_f32 v38, v38, v36
  v_mul_f32 v39, v39, v37
  v_cvt_pk_bf16_f32 v38, v38, v39
  v_lshlrev_b32 v39, 16, v38
  v_and_b32 v38, 0xffff0000, v38
  v_add_f32 v40, v40, v39
  v_add_f32 v40, v40, v38
  v_lshlrev_b32 v38, 16, v30
  v_and_b32 v39, 0xffff0000, v30
  v_mul_f32 v38, v38, v36
  v_mul_f32 v39, v39, v37
  v_cvt_pk_bf16_f32 v38, v38, v39
  v_lshlrev_b32 v39, 16, v38
  v_and_b32 v38, 0xffff0000, v38
  v_add_f32 v41, v41, v39
  v_add_f32 v41, v41, v38
  v_lshlrev_b32 v36, 16, v19
  v_and_b32 v37, 0xffff0000, v19
  v_lshlrev_b32 v38, 16, v25
  v_and_b32 v39, 0xffff0000, v25
  v_mul_f32 v38, v38, v36
  v_mul_f32 v39, v39, v37
  v_cvt_pk_bf16_f32 v38, v38, v39
  v_lshlrev_b32 v39, 16, v38
  v_and_b32 v38, 0xffff0000, v38
  v_add_f32 v40, v40, v39
  v_add_f32 v40, v40, v38
  v_lshlrev_b32 v38, 16, v31
  v_and_b32 v39, 0xffff0000, v31
  v_mul_f32 v38, v38, v36
  v_mul_f32 v39, v39, v37
  v_cvt_pk_bf16_f32 v38, v38, v39
  v_lshlrev_b32 v39, 16, v38
  v_and_b32 v38, 0xffff0000, v38
  v_add_f32 v41, v41, v39
  v_add_f32 v41, v41, v38
  v_lshlrev_b32 v36, 16, v20
  v_and_b32 v37, 0xffff0000, v20
  v_lshlrev_b32 v38, 16, v26
  v_and_b32 v39, 0xffff0000, v26
  v_mul_f32 v38, v38, v36
  v_mul_f32 v39, v39, v37
  v_cvt_pk_bf16_f32 v38, v38, v39
  v_lshlrev_b32 v39, 16, v38
  v_and_b32 v38, 0xffff0000, v38
  v_add_f32 v40, v40, v39
  v_add_f32 v40, v40, v38
  v_lshlrev_b32 v38, 16, v32
  v_and_b32 v39, 0xffff0000, v32
  v_mul_f32 v38, v38, v36
  v_mul_f32 v39, v39, v37
  v_cvt_pk_bf16_f32 v38, v38, v39
  v_lshlrev_b32 v39, 16, v38
  v_and_b32 v38, 0xffff0000, v38
  v_add_f32 v41, v41, v39
  v_add_f32 v41, v41, v38
  v_add_f32 v40, v40, v40 row_shr:1
  s_nop 0
  v_add_f32 v41, v41, v41 row_shr:1
  v_add_f32 v40, v40, v40 row_shr:2
  s_nop 0
  v_add_f32 v41, v41, v41 row_shr:2
  v_add_f32 v40, v40, v40 row_shr:4
  s_nop 0
  v_add_f32 v41, v41, v41 row_shr:4
  v_add_f32 v40, v40, v40 row_shr:8
  s_nop 0
  v_add_f32 v41, v41, v41 row_shr:8
  v_add_f32 v40, v40, v40 row_bcast:15 row_mask:0xa
  s_nop 0
  v_add_f32 v41, v41, v41 row_bcast:15 row_mask:0xa
  v_add_f32 v40, v40, v40 row_bcast:31 row_mask:0xc
  s_nop 0
  v_add_f32 v41, v41, v41 row_bcast:31 row_mask:0xc
  v_readlane_b32 s80, v40, 63
  v_readlane_b32 s81, v41, 63
  s_nop 0
  v_mov_b32 v42, s80
  v_mov_b32 v43, s81
  v_cmp_eq_u32 vcc, 1, v0
  s_nop 1
  v_cndmask_b32 v42, v42, v43, vcc
  v_cvt_pk_bf16_f32 v42, v42, v42
  v_and_b32 v42, 0xffff0000, v42
  v_mul_f32 v42, 0xbfb8aa3b, v42
  v_exp_f32 v42, v42
  s_nop 0
  v_add_f32 v42, 1.0, v42
  v_rcp_f32 v42, v42
  s_nop 0
  v_cvt_pk_bf16_f32 v42, v42, v42
  v_and_b32 v42, 0xffff0000, v42
  v_mov_b32 v43, s78
  v_lshlrev_b32 v44, 3, v0
  s_lshl_b32 s80, s2, 3
  s_lshl_b32 s81, s84, 1
  s_add_u32 s80, s80, s81
  s_lshl_b32 s80, s80, 3
  s_add_u32 s80, s80, 16777216
  s_mov_b64 exec, 3
  buffer_store_dwordx2 v[42:43], v44, s[16:19], s80 offen sc0 sc1
  s_mov_b64 exec, -1
  s_mov_b32 s84, s88
  v_lshlrev_b32 v16, 16, v244
  v_and_b32 v17, 0xffff0000, v244
  v_lshlrev_b32 v18, 16, v245
  v_and_b32 v19, 0xffff0000, v245
  v_mov_b32 v20, v16
  v_mov_b32 v21, v17
  v_mov_b32 v22, v18
  v_mov_b32 v23, v19
  v_mov_b32 v24, v16
  v_mov_b32 v25, v17
  v_mov_b32 v26, v18
  v_mov_b32 v27, v19
  v_mov_b32 v28, v16
  v_mov_b32 v29, v17
  v_mov_b32 v30, v18
  v_mov_b32 v31, v19
  v_lshlrev_b32 v32, 16, v246
  v_and_b32 v33, 0xffff0000, v246
  v_lshlrev_b32 v34, 16, v247
  v_and_b32 v35, 0xffff0000, v247
  v_mov_b32 v36, v32
  v_mov_b32 v37, v33
  v_mov_b32 v38, v34
  v_mov_b32 v39, v35
  v_mov_b32 v40, v32
  v_mov_b32 v41, v33
  v_mov_b32 v42, v34
  v_mov_b32 v43, v35
  v_mov_b32 v44, v32
  v_mov_b32 v45, v33
  v_mov_b32 v46, v34
  v_mov_b32 v47, v35
  v_lshlrev_b32 v48, 16, v248
  v_and_b32 v49, 0xffff0000, v248
  v_lshlrev_b32 v50, 16, v249
  v_and_b32 v51, 0xffff0000, v249
  v_mov_b32 v52, v48
  v_mov_b32 v53, v49
  v_mov_b32 v54, v50
  v_mov_b32 v55, v51
  v_mov_b32 v56, v48
  v_mov_b32 v57, v49
  v_mov_b32 v58, v50
  v_mov_b32 v59, v51
  v_mov_b32 v60, v48
  v_mov_b32 v61, v49
  v_mov_b32 v62, v50
  v_mov_b32 v63, v51
  v_lshlrev_b32 v64, 16, v250
  v_and_b32 v65, 0xffff0000, v250
  v_lshlrev_b32 v66, 16, v251
  v_and_b32 v67, 0xffff0000, v251
  v_mov_b32 v68, v64
  v_mov_b32 v69, v65
  v_mov_b32 v70, v66
  v_mov_b32 v71, v67
  v_mov_b32 v72, v64
  v_mov_b32 v73, v65
  v_mov_b32 v74, v66
  v_mov_b32 v75, v67
  v_mov_b32 v76, v64
  v_mov_b32 v77, v65
  v_mov_b32 v78, v66
  v_mov_b32 v79, v67
  v_lshlrev_b32 v80, 16, v252
  v_and_b32 v81, 0xffff0000, v252
  v_lshlrev_b32 v82, 16, v253
  v_and_b32 v83, 0xffff0000, v253
  v_mov_b32 v84, v80
  v_mov_b32 v85, v81
  v_mov_b32 v86, v82
  v_mov_b32 v87, v83
  v_mov_b32 v88, v80
  v_mov_b32 v89, v81
  v_mov_b32 v90, v82
  v_mov_b32 v91, v83
  v_mov_b32 v92, v80
  v_mov_b32 v93, v81
  v_mov_b32 v94, v82
  v_mov_b32 v95, v83
  v_mov_b32 v10, 152600
  s_mov_b32 s80, 0
L_lwg_R:
  ds_read_b32 v11, v10
  s_add_u32 s80, s80, 1
  s_waitcnt lgkmcnt(0)
  v_readfirstlane_b32 s81, v11
  s_cmp_ge_u32 s80, 8000000
  s_cbranch_scc1 L_lwg_done_R
  s_cmp_ge_u32 s81, 4
  s_cbranch_scc1 L_lwg_done_R
  s_sleep 1
  s_branch L_lwg_R
L_lwg_done_R:
  s_add_u32 m0, s87, 0
  s_nop 0
  buffer_load_dwordx4 v1, s[16:19], s84 offen sc1 lds
  s_add_u32 s84, s84, 1024
  s_add_u32 m0, s87, 1024
  s_nop 0
  buffer_load_dwordx4 v1, s[16:19], s84 offen sc1 lds
  s_add_u32 s84, s84, 1024
  s_add_u32 m0, s87, 2048
  s_nop 0
  buffer_load_dwordx4 v1, s[16:19], s84 offen sc1 lds
  s_add_u32 s84, s84, 1024
  s_add_u32 m0, s87, 3072
  s_nop 0
  buffer_load_dwordx4 v1, s[16:19], s84 offen sc1 lds
  s_add_u32 s84, s84, 1024
  s_add_u32 m0, s87, 4096
  s_nop 0
  buffer_load_dwordx4 v1, s[16:19], s84 offen sc1 lds
  s_add_u32 s84, s84, 1024
  s_add_u32 m0, s87, 5120
  s_nop 0
  buffer_load_dwordx4 v1, s[16:19], s84 offen sc1 lds
  s_add_u32 s84, s84, 1024
  s_add_u32 m0, s87, 6144
  s_nop 0
  buffer_load_dwordx4 v1, s[16:19], s84 offen sc1 lds
  s_add_u32 s84, s84, 1024
  s_add_u32 m0, s87, 7168
  s_nop 0
  buffer_load_dwordx4 v1, s[16:19], s84 offen sc1 lds
  s_add_u32 s84, s84, 1024
  s_add_u32 m0, s87, 8192
  s_nop 0
  buffer_load_dwordx4 v1, s[16:19], s84 offen sc1 lds
  s_add_u32 s84, s84, 1024
  s_add_u32 m0, s87, 9216
  s_nop 0
  buffer_load_dwordx4 v1, s[16:19], s84 offen sc1 lds
  s_add_u32 s84, s84, 1024
  s_add_u32 m0, s87, 10240
  s_nop 0
  buffer_load_dwordx4 v1, s[16:19], s84 offen sc1 lds
  s_add_u32 s84, s84, 1024
  s_add_u32 m0, s87, 11264
  s_nop 0
  buffer_load_dwordx4 v1, s[16:19], s84 offen sc1 lds
  s_add_u32 s84, s84, 1024
  s_add_u32 m0, s87, 12288
  s_nop 0
  buffer_load_dwordx4 v1, s[16:19], s84 offen sc1 lds
  s_add_u32 s84, s84, 1024
  s_add_u32 m0, s87, 13312
  s_nop 0
  buffer_load_dwordx4 v1, s[16:19], s84 offen sc1 lds
  s_add_u32 s84, s84, 1024
  s_add_u32 m0, s87, 14336
  s_nop 0
  buffer_load_dwordx4 v1, s[16:19], s84 offen sc1 lds
  s_add_u32 s84, s84, 1024
  s_add_u32 m0, s87, 15360
  s_nop 0
  buffer_load_dwordx4 v1, s[16:19], s84 offen sc1 lds
  s_add_u32 s84, s84, 1024
  s_add_u32 m0, s87, 16384
  s_nop 0
  buffer_load_dwordx4 v1, s[16:19], s84 offen sc1 lds
  s_add_u32 s84, s84, 1024
  s_add_u32 m0, s87, 17408
  s_nop 0
  buffer_load_dwordx4 v1, s[16:19], s84 offen sc1 lds
  s_add_u32 s84, s84, 1024
  s_add_u32 m0, s87, 18432
  s_nop 0
  buffer_load_dwordx4 v1, s[16:19], s84 offen sc1 lds
  s_add_u32 s84, s84, 1024
  s_add_u32 m0, s87, 19456
  s_nop 0
  buffer_load_dwordx4 v1, s[16:19], s84 offen sc1 lds
  s_add_u32 s84, s84, 1024
  v_mov_b32 v10, 152604
  v_mov_b32 v11, 1
  s_mov_b64 exec, 1
  ds_add_u32 v10, v11
  s_mov_b64 exec, -1
  s_cmp_eq_u32 s79, 1
  s_cbranch_scc0 L_NOHELP
  s_mul_i32 s80, s86, 10
  s_add_u32 s80, s80, 59
  s_mul_i32 s81, s77, 94
  s_add_u32 s80, s80, s81
  s_mul_i32 s80, s80, 5120
  s_add_u32 s80, s80, 12582912
  s_mul_i32 s81, s86, 15360
  s_add_u32 s81, s81, 81920
  s_add_u32 m0, s81, 0
  s_nop 0
  buffer_load_dwordx4 v1, s[16:19], s80 offen sc1 lds
  s_add_u32 s80, s80, 1024
  s_add_u32 m0, s81, 1024
  s_nop 0
  buffer_load_dwordx4 v1, s[16:19], s80 offen sc1 lds
  s_add_u32 s80, s80, 1024
  s_add_u32 m0, s81, 2048
  s_nop 0
  buffer_load_dwordx4 v1, s[16:19], s80 offen sc1 lds
  s_add_u32 s80, s80, 1024
  s_add_u32 m0, s81, 3072
  s_nop 0
  buffer_load_dwordx4 v1, s[16:19], s80 offen sc1 lds
  s_add_u32 s80, s80, 1024
  s_add_u32 m0, s81, 4096
  s_nop 0
  buffer_load_dwordx4 v1, s[16:19], s80 offen sc1 lds
  s_add_u32 s80, s80, 1024
  s_add_u32 m0, s81, 5120
  s_nop 0
  buffer_load_dwordx4 v1, s[16:19], s80 offen sc1 lds
  s_add_u32 s80, s80, 1024
  s_add_u32 m0, s81, 6144
  s_nop 0
  buffer_load_dwordx4 v1, s[16:19], s80 offen sc1 lds
  s_add_u32 s80, s80, 1024
  s_add_u32 m0, s81, 7168
  s_nop 0
  buffer_load_dwordx4 v1, s[16:19], s80 offen sc1 lds
  s_add_u32 s80, s80, 1024
  s_add_u32 m0, s81, 8192
  s_nop 0
  buffer_load_dwordx4 v1, s[16:19], s80 offen sc1 lds
  s_add_u32 s80, s80, 1024
  s_add_u32 m0, s81, 9216
  s_nop 0
  buffer_load_dwordx4 v1, s[16:19], s80 offen sc1 lds
  s_add_u32 s80, s80, 1024
  s_add_u32 m0, s81, 10240
  s_nop 0
  buffer_load_dwordx4 v1, s[16:19], s80 offen sc1 lds
  s_add_u32 s80, s80, 1024
  s_add_u32 m0, s81, 11264
  s_nop 0
  buffer_load_dwordx4 v1, s[16:19], s80 offen sc1 lds
  s_add_u32 s80, s80, 1024
  s_add_u32 m0, s81, 12288
  s_nop 0
  buffer_load_dwordx4 v1, s[16:19], s80 offen sc1 lds
  s_add_u32 s80, s80, 1024
  s_add_u32 m0, s81, 13312
  s_nop 0
  buffer_load_dwordx4 v1, s[16:19], s80 offen sc1 lds
  s_add_u32 s80, s80, 1024
  s_add_u32 m0, s81, 14336
  s_nop 0
  buffer_load_dwordx4 v1, s[16:19], s80 offen sc1 lds
  s_add_u32 s80, s80, 1024
L_NOHELP:
L_FFN_P2:
  s_mul_i32 s80, s76, 94
  s_add_u32 s85, s85, s80
  s_lshl_b32 s85, s85, 12
  v_add_u32 v3, s87, v1
  s_cmp_eq_u32 s86, 0
  s_cbranch_scc0 L_FFN_lw
  s_lshl_b32 s89, s76, 8
  s_add_u32 s89, s89, 17104896
  s_mov_b32 s80, 0
L_sp_FT:
  s_load_dwordx16 s[40:55], s[70:71], s89 glc
  s_load_dwordx2 s[56:57], s[70:71], s89 offset:64 glc
  s_add_u32 s80, s80, 1
  s_waitcnt lgkmcnt(0)
  s_mov_b32 s81, 0
  s_xor_b32 s82, s40, s78
  s_or_b32 s81, s81, s82
  s_xor_b32 s82, s41, s78
  s_or_b32 s81, s81, s82
  s_xor_b32 s82, s42, s78
  s_or_b32 s81, s81, s82
  s_xor_b32 s82, s43, s78
  s_or_b32 s81, s81, s82
  s_xor_b32 s82, s44, s78
  s_or_b32 s81, s81, s82
  s_xor_b32 s82, s45, s78
  s_or_b32 s81, s81, s82
  s_xor_b32 s82, s46, s78
  s_or_b32 s81, s81, s82
  s_xor_b32 s82, s47, s78
  s_or_b32 s81, s81, s82
  s_xor_b32 s82, s48, s78
  s_or_b32 s81, s81, s82
  s_xor_b32 s82, s49, s78
  s_or_b32 s81, s81, s82
  s_xor_b32 s82, s50, s78
  s_or_b32 s81, s81, s82
  s_xor_b32 s82, s51, s78
  s_or_b32 s81, s81, s82
  s_xor_b32 s82, s52, s78
  s_or_b32 s81, s81, s82
  s_xor_b32 s82, s53, s78
  s_or_b32 s81, s81, s82
  s_xor_b32 s82, s54, s78
  s_or_b32 s81, s81, s82
  s_xor_b32 s82, s55, s78
  s_or_b32 s81, s81, s82
  s_xor_b32 s82, s56, s78
  s_or_b32 s81, s81, s82
  s_xor_b32 s82, s57, s78
  s_or_b32 s81, s81, s82
  s_cmp_ge_u32 s80, 2000000
  s_cbranch_scc1 L_sp_done_FT
  s_cmp_eq_u32 s81, 0
  s_cbranch_scc1 L_sp_done_FT
  s_sleep 1
  s_branch L_sp_FT
L_sp_done_FT:
  v_mov_b32 v10, 152584
  v_mov_b32 v11, 1
  ds_write_b32 v10, v11
  s_branch L_FFN_go
L_FFN_lw:
  v_mov_b32 v10, 152584
  s_mov_b32 s80, 0
L_lw_F:
  ds_read_b32 v11, v10
  s_add_u32 s80, s80, 1
  s_waitcnt lgkmcnt(0)
  v_readfirstlane_b32 s81, v11
  s_cmp_ge_u32 s80, 8000000
  s_cbranch_scc1 L_lw_done_F
  s_cmp_eq_u32 s81, 0
  s_cbranch_scc0 L_lw_done_F
  s_sleep 1
  s_branch L_lw_F
L_lw_done_F:
L_FFN_go:
  s_cmp_eq_u32 s79, 1
  s_cbranch_scc0 L_FFN_nohold
  v_mov_b32 v10, 152608
  s_mov_b32 s80, 0
L_lwg_UH:
  ds_read_b32 v11, v10
  s_add_u32 s80, s80, 1
  s_waitcnt lgkmcnt(0)
  v_readfirstlane_b32 s81, v11
  s_cmp_ge_u32 s80, 8000000
  s_cbranch_scc1 L_lwg_done_UH
  s_cmp_ge_u32 s81, 4
  s_cbranch_scc1 L_lwg_done_UH
  s_sleep 1
  s_branch L_lwg_UH
L_lwg_done_UH:
L_FFN_nohold:
  s_setprio 1
  s_cmp_ge_u32 s86, 2
  s_cbranch_scc1 L_FFN_13
  buffer_load_dwordx4 v[196:199], v1, s[16:19], s85 offen offset:0 sc1
  buffer_load_dwordx4 v[200:203], v1, s[16:19], s85 offen offset:1024 sc1
  buffer_load_dwordx4 v[204:207], v1, s[16:19], s85 offen offset:2048 sc1
  buffer_load_dwordx4 v[208:211], v1, s[16:19], s85 offen offset:3072 sc1
  s_add_u32 s85, s85, 4096
  buffer_load_dwordx4 v[212:215], v1, s[16:19], s85 offen offset:0 sc1
  buffer_load_dwordx4 v[216:219], v1, s[16:19], s85 offen offset:1024 sc1
  buffer_load_dwordx4 v[220:223], v1, s[16:19], s85 offen offset:2048 sc1
  buffer_load_dwordx4 v[224:227], v1, s[16:19], s85 offen offset:3072 sc1
  s_add_u32 s85, s85, 4096
  buffer_load_dwordx4 v[228:231], v1, s[16:19], s85 offen offset:0 sc1
  buffer_load_dwordx4 v[232:235], v1, s[16:19], s85 offen offset:1024 sc1
  buffer_load_dwordx4 v[236:239], v1, s[16:19], s85 offen offset:2048 sc1
  buffer_load_dwordx4 v[240:243], v1, s[16:19], s85 offen offset:3072 sc1
  s_add_u32 s85, s85, 4096
  s_waitcnt vmcnt(8)
  v_mov_b32 v10, 152596
  v_mov_b32 v11, 1
  s_mov_b64 exec, 1
  ds_add_u32 v10, v11
  s_mov_b64 exec, -1
  v_mfma_f32_16x16x32_bf16 v[16:19], v[96:99], v[196:199], v[16:19]
  v_mfma_f32_16x16x32_bf16 v[20:23], v[96:99], v[200:203], v[20:23]
  v_mfma_f32_16x16x32_bf16 v[24:27], v[96:99], v[204:207], v[24:27]
  v_mfma_f32_16x16x32_bf16 v[28:31], v[96:99], v[208:211], v[28:31]
  v_mfma_f32_16x16x32_bf16 v[32:35], v[100:103], v[196:199], v[32:35]
  v_mfma_f32_16x16x32_bf16 v[36:39], v[100:103], v[200:203], v[36:39]
  v_mfma_f32_16x16x32_bf16 v[40:43], v[100:103], v[204:207], v[40:43]
  v_mfma_f32_16x16x32_bf16 v[44:47], v[100:103], v[208:211], v[44:47]
  v_mfma_f32_16x16x32_bf16 v[48:51], v[104:107], v[196:199], v[48:51]
  v_mfma_f32_16x16x32_bf16 v[52:55], v[104:107], v[200:203], v[52:55]
  v_mfma_f32_16x16x32_bf16 v[56:59], v[104:107], v[204:207], v[56:59]
  v_mfma_f32_16x16x32_bf16 v[60:63], v[104:107], v[208:211], v[60:63]
  v_mfma_f32_16x16x32_bf16 v[64:67], v[108:111], v[196:199], v[64:67]
  v_mfma_f32_16x16x32_bf16 v[68:71], v[108:111], v[200:203], v[68:71]
  v_mfma_f32_16x16x32_bf16 v[72:75], v[108:111], v[204:207], v[72:75]
  v_mfma_f32_16x16x32_bf16 v[76:79], v[108:111], v[208:211], v[76:79]
  v_mfma_f32_16x16x32_bf16 v[80:83], v[112:115], v[196:199], v[80:83]
  v_mfma_f32_16x16x32_bf16 v[84:87], v[112:115], v[200:203], v[84:87]
  v_mfma_f32_16x16x32_bf16 v[88:91], v[112:115], v[204:207], v[88:91]
  v_mfma_f32_16x16x32_bf16 v[92:95], v[112:115], v[208:211], v[92:95]
  buffer_load_dwordx4 v[196:199], v1, s[16:19], s85 offen offset:0 sc1
  buffer_load_dwordx4 v[200:203], v1, s[16:19], s85 offen offset:1024 sc1
  buffer_load_dwordx4 v[204:207], v1, s[16:19], s85 offen offset:2048 sc1
  buffer_load_dwordx4 v[208:211], v1, s[16:19], s85 offen offset:3072 sc1
  s_add_u32 s85, s85, 4096
  s_waitcnt vmcnt(8)
  v_mfma_f32_16x16x32_bf16 v[16:19], v[116:119], v[212:215], v[16:19]
  v_mfma_f32_16x16x32_bf16 v[20:23], v[116:119], v[216:219], v[20:23]
  v_mfma_f32_16x16x32_bf16 v[24:27], v[116:119], v[220:223], v[24:27]
  v_mfma_f32_16x16x32_bf16 v[28:31], v[116:119], v[224:227], v[28:31]
  v_mfma_f32_16x16x32_bf16 v[32:35], v[120:123], v[212:215], v[32:35]
  v_mfma_f32_16x16x32_bf16 v[36:39], v[120:123], v[216:219], v[36:39]
  v_mfma_f32_16x16x32_bf16 v[40:43], v[120:123], v[220:223], v[40:43]
  v_mfma_f32_16x16x32_bf16 v[44:47], v[120:123], v[224:227], v[44:47]
  v_mfma_f32_16x16x32_bf16 v[48:51], v[124:127], v[212:215], v[48:51]
  v_mfma_f32_16x16x32_bf16 v[52:55], v[124:127], v[216:219], v[52:55]
  v_mfma_f32_16x16x32_bf16 v[56:59], v[124:127], v[220:223], v[56:59]
  v_mfma_f32_16x16x32_bf16 v[60:63], v[124:127], v[224:227], v[60:63]
  v_mfma_f32_16x16x32_bf16 v[64:67], v[128:131], v[212:215], v[64:67]
  v_mfma_f32_16x16x32_bf16 v[68:71], v[128:131], v[216:219], v[68:71]
  v_mfma_f32_16x16x32_bf16 v[72:75], v[128:131], v[220:223], v[72:75]
  v_mfma_f32_16x16x32_bf16 v[76:79], v[128:131], v[224:227], v[76:79]
  v_mfma_f32_16x16x32_bf16 v[80:83], v[132:135], v[212:215], v[80:83]
  v_mfma_f32_16x16x32_bf16 v[84:87], v[132:135], v[216:219], v[84:87]
  v_mfma_f32_16x16x32_bf16 v[88:91], v[132:135], v[220:223], v[88:91]
  v_mfma_f32_16x16x32_bf16 v[92:95], v[132:135], v[224:227], v[92:95]
  buffer_load_dwordx4 v[212:215], v1, s[16:19], s85 offen offset:0 sc1
  buffer_load_dwordx4 v[216:219], v1, s[16:19], s85 offen offset:1024 sc1
  buffer_load_dwordx4 v[220:223], v1, s[16:19], s85 offen offset:2048 sc1
  buffer_load_dwordx4 v[224:227], v1, s[16:19], s85 offen offset:3072 sc1
  s_add_u32 s85, s85, 4096
  s_waitcnt vmcnt(8)
  v_mfma_f32_16x16x32_bf16 v[16:19], v[136:139], v[228:231], v[16:19]
  v_mfma_f32_16x16x32_bf16 v[20:23], v[136:139], v[232:235], v[20:23]
  v_mfma_f32_16x16x32_bf16 v[24:27], v[136:139], v[236:239], v[24:27]
  v_mfma_f32_16x16x32_bf16 v[28:31], v[136:139], v[240:243], v[28:31]
  v_mfma_f32_16x16x32_bf16 v[32:35], v[140:143], v[228:231], v[32:35]
  v_mfma_f32_16x16x32_bf16 v[36:39], v[140:143], v[232:235], v[36:39]
  v_mfma_f32_16x16x32_bf16 v[40:43], v[140:143], v[236:239], v[40:43]
  v_mfma_f32_16x16x32_bf16 v[44:47], v[140:143], v[240:243], v[44:47]
  v_mfma_f32_16x16x32_bf16 v[48:51], v[144:147], v[228:231], v[48:51]
  v_mfma_f32_16x16x32_bf16 v[52:55], v[144:147], v[232:235], v[52:55]
  v_mfma_f32_16x16x32_bf16 v[56:59], v[144:147], v[236:239], v[56:59]
  v_mfma_f32_16x16x32_bf16 v[60:63], v[144:147], v[240:243], v[60:63]
  v_mfma_f32_16x16x32_bf16 v[64:67], v[148:151], v[228:231], v[64:67]
  v_mfma_f32_16x16x32_bf16 v[68:71], v[148:151], v[232:235], v[68:71]
  v_mfma_f32_16x16x32_bf16 v[72:75], v[148:151], v[236:239], v[72:75]
  v_mfma_f32_16x16x32_bf16 v[76:79], v[148:151], v[240:243], v[76:79]
  v_mfma_f32_16x16x32_bf16 v[80:83], v[152:155], v[228:231], v[80:83]
  v_mfma_f32_16x16x32_bf16 v[84:87], v[152:155], v[232:235], v[84:87]
  v_mfma_f32_16x16x32_bf16 v[88:91], v[152:155], v[236:239], v[88:91]
  v_mfma_f32_16x16x32_bf16 v[92:95], v[152:155], v[240:243], v[92:95]
  buffer_load_dwordx4 v[228:231], v1, s[16:19], s85 offen offset:0 sc1
  buffer_load_dwordx4 v[232:235], v1, s[16:19], s85 offen offset:1024 sc1
  buffer_load_dwordx4 v[236:239], v1, s[16:19], s85 offen offset:2048 sc1
  buffer_load_dwordx4 v[240:243], v1, s[16:19], s85 offen offset:3072 sc1
  s_add_u32 s85, s85, 4096
  s_waitcnt vmcnt(8)
  v_mfma_f32_16x16x32_bf16 v[16:19], v[156:159], v[196:199], v[16:19]
  v_mfma_f32_16x16x32_bf16 v[20:23], v[156:159], v[200:203], v[20:23]
  v_mfma_f32_16x16x32_bf16 v[24:27], v[156:159], v[204:207], v[24:27]
  v_mfma_f32_16x16x32_bf16 v[28:31], v[156:159], v[208:211], v[28:31]
  v_mfma_f32_16x16x32_bf16 v[32:35], v[160:163], v[196:199], v[32:35]
  v_mfma_f32_16x16x32_bf16 v[36:39], v[160:163], v[200:203], v[36:39]
  v_mfma_f32_16x16x32_bf16 v[40:43], v[160:163], v[204:207], v[40:43]
  v_mfma_f32_16x16x32_bf16 v[44:47], v[160:163], v[208:211], v[44:47]
  v_mfma_f32_16x16x32_bf16 v[48:51], v[164:167], v[196:199], v[48:51]
  v_mfma_f32_16x16x32_bf16 v[52:55], v[164:167], v[200:203], v[52:55]
  v_mfma_f32_16x16x32_bf16 v[56:59], v[164:167], v[204:207], v[56:59]
  v_mfma_f32_16x16x32_bf16 v[60:63], v[164:167], v[208:211], v[60:63]
  v_mfma_f32_16x16x32_bf16 v[64:67], v[168:171], v[196:199], v[64:67]
  v_mfma_f32_16x16x32_bf16 v[68:71], v[168:171], v[200:203], v[68:71]
  v_mfma_f32_16x16x32_bf16 v[72:75], v[168:171], v[204:207], v[72:75]
  v_mfma_f32_16x16x32_bf16 v[76:79], v[168:171], v[208:211], v[76:79]
  v_mfma_f32_16x16x32_bf16 v[80:83], v[172:175], v[196:199], v[80:83]
  v_mfma_f32_16x16x32_bf16 v[84:87], v[172:175], v[200:203], v[84:87]
  v_mfma_f32_16x16x32_bf16 v[88:91], v[172:175], v[204:207], v[88:91]
  v_mfma_f32_16x16x32_bf16 v[92:95], v[172:175], v[208:211], v[92:95]
  buffer_load_dwordx4 v[196:199], v1, s[16:19], s85 offen offset:0 sc1
  buffer_load_dwordx4 v[200:203], v1, s[16:19], s85 offen offset:1024 sc1
  buffer_load_dwordx4 v[204:207], v1, s[16:19], s85 offen offset:2048 sc1
  buffer_load_dwordx4 v[208:211], v1, s[16:19], s85 offen offset:3072 sc1
  s_add_u32 s85, s85, 4096
  ds_read_b128 v[96:99], v3 offset:0
  ds_read_b128 v[100:103], v3 offset:1024
  ds_read_b128 v[104:107], v3 offset:2048
  ds_read_b128 v[108:111], v3 offset:3072
  ds_read_b128 v[112:115], v3 offset:4096
  s_waitcnt vmcnt(8)
  v_mfma_f32_16x16x32_bf16 v[16:19], v[176:179], v[212:215], v[16:19]
  v_mfma_f32_16x16x32_bf16 v[20:23], v[176:179], v[216:219], v[20:23]
  v_mfma_f32_16x16x32_bf16 v[24:27], v[176:179], v[220:223], v[24:27]
  v_mfma_f32_16x16x32_bf16 v[28:31], v[176:179], v[224:227], v[28:31]
  v_mfma_f32_16x16x32_bf16 v[32:35], v[180:183], v[212:215], v[32:35]
  v_mfma_f32_16x16x32_bf16 v[36:39], v[180:183], v[216:219], v[36:39]
  v_mfma_f32_16x16x32_bf16 v[40:43], v[180:183], v[220:223], v[40:43]
  v_mfma_f32_16x16x32_bf16 v[44:47], v[180:183], v[224:227], v[44:47]
  v_mfma_f32_16x16x32_bf16 v[48:51], v[184:187], v[212:215], v[48:51]
  v_mfma_f32_16x16x32_bf16 v[52:55], v[184:187], v[216:219], v[52:55]
  v_mfma_f32_16x16x32_bf16 v[56:59], v[184:187], v[220:223], v[56:59]
  v_mfma_f32_16x16x32_bf16 v[60:63], v[184:187], v[224:227], v[60:63]
  v_mfma_f32_16x16x32_bf16 v[64:67], v[188:191], v[212:215], v[64:67]
  v_mfma_f32_16x16x32_bf16 v[68:71], v[188:191], v[216:219], v[68:71]
  v_mfma_f32_16x16x32_bf16 v[72:75], v[188:191], v[220:223], v[72:75]
  v_mfma_f32_16x16x32_bf16 v[76:79], v[188:191], v[224:227], v[76:79]
  v_mfma_f32_16x16x32_bf16 v[80:83], v[192:195], v[212:215], v[80:83]
  v_mfma_f32_16x16x32_bf16 v[84:87], v[192:195], v[216:219], v[84:87]
  v_mfma_f32_16x16x32_bf16 v[88:91], v[192:195], v[220:223], v[88:91]
  v_mfma_f32_16x16x32_bf16 v[92:95], v[192:195], v[224:227], v[92:95]
  buffer_load_dwordx4 v[212:215], v1, s[16:19], s85 offen offset:0 sc1
  buffer_load_dwordx4 v[216:219], v1, s[16:19], s85 offen offset:1024 sc1
  buffer_load_dwordx4 v[220:223], v1, s[16:19], s85 offen offset:2048 sc1
  buffer_load_dwordx4 v[224:227], v1, s[16:19], s85 offen offset:3072 sc1
  s_add_u32 s85, s85, 4096
  buffer_load_dwordx4 v[176:179], v1, s[16:19], s84 offen offset:0 sc1
  buffer_load_dwordx4 v[180:183], v1, s[16:19], s84 offen offset:1024 sc1
  buffer_load_dwordx4 v[184:187], v1, s[16:19], s84 offen offset:2048 sc1
  buffer_load_dwordx4 v[188:191], v1, s[16:19], s84 offen offset:3072 sc1
  s_add_u32 s84, s84, 4096
  buffer_load_dwordx4 v[192:195], v1, s[16:19], s84 offen sc1
  s_add_u32 s84, s84, 1024
  ds_read_b128 v[116:119], v3 offset:5120
  ds_read_b128 v[120:123], v3 offset:6144
  ds_read_b128 v[124:127], v3 offset:7168
  ds_read_b128 v[128:131], v3 offset:8192
  ds_read_b128 v[132:135], v3 offset:9216
  s_waitcnt vmcnt(13) lgkmcnt(0)
  v_mfma_f32_16x16x32_bf16 v[16:19], v[96:99], v[228:231], v[16:19]
  v_mfma_f32_16x16x32_bf16 v[20:23], v[96:99], v[232:235], v[20:23]
  v_mfma_f32_16x16x32_bf16 v[24:27], v[96:99], v[236:239], v[24:27]
  v_mfma_f32_16x16x32_bf16 v[28:31], v[96:99], v[240:243], v[28:31]
  v_mfma_f32_16x16x32_bf16 v[32:35], v[100:103], v[228:231], v[32:35]
  v_mfma_f32_16x16x32_bf16 v[36:39], v[100:103], v[232:235], v[36:39]
  v_mfma_f32_16x16x32_bf16 v[40:43], v[100:103], v[236:239], v[40:43]
  v_mfma_f32_16x16x32_bf16 v[44:47], v[100:103], v[240:243], v[44:47]
  v_mfma_f32_16x16x32_bf16 v[48:51], v[104:107], v[228:231], v[48:51]
  v_mfma_f32_16x16x32_bf16 v[52:55], v[104:107], v[232:235], v[52:55]
  v_mfma_f32_16x16x32_bf16 v[56:59], v[104:107], v[236:239], v[56:59]
  v_mfma_f32_16x16x32_bf16 v[60:63], v[104:107], v[240:243], v[60:63]
  v_mfma_f32_16x16x32_bf16 v[64:67], v[108:111], v[228:231], v[64:67]
  v_mfma_f32_16x16x32_bf16 v[68:71], v[108:111], v[232:235], v[68:71]
  v_mfma_f32_16x16x32_bf16 v[72:75], v[108:111], v[236:239], v[72:75]
  v_mfma_f32_16x16x32_bf16 v[76:79], v[108:111], v[240:243], v[76:79]
  v_mfma_f32_16x16x32_bf16 v[80:83], v[112:115], v[228:231], v[80:83]
  v_mfma_f32_16x16x32_bf16 v[84:87], v[112:115], v[232:235], v[84:87]
  v_mfma_f32_16x16x32_bf16 v[88:91], v[112:115], v[236:239], v[88:91]
  v_mfma_f32_16x16x32_bf16 v[92:95], v[112:115], v[240:243], v[92:95]
  buffer_load_dwordx4 v[228:231], v1, s[16:19], s85 offen offset:0 sc1
  buffer_load_dwordx4 v[232:235], v1, s[16:19], s85 offen offset:1024 sc1
  buffer_load_dwordx4 v[236:239], v1, s[16:19], s85 offen offset:2048 sc1
  buffer_load_dwordx4 v[240:243], v1, s[16:19], s85 offen offset:3072 sc1
  s_add_u32 s85, s85, 4096
  buffer_load_dwordx4 v[96:99], v1, s[16:19], s84 offen offset:0 sc1
  buffer_load_dwordx4 v[100:103], v1, s[16:19], s84 offen offset:1024 sc1
  buffer_load_dwordx4 v[104:107], v1, s[16:19], s84 offen offset:2048 sc1
  buffer_load_dwordx4 v[108:111], v1, s[16:19], s84 offen offset:3072 sc1
  s_add_u32 s84, s84, 4096
  buffer_load_dwordx4 v[112:115], v1, s[16:19], s84 offen sc1
  s_add_u32 s84, s84, 1024
  ds_read_b128 v[136:139], v3 offset:10240
  ds_read_b128 v[140:143], v3 offset:11264
  ds_read_b128 v[144:147], v3 offset:12288
  ds_read_b128 v[148:151], v3 offset:13312
  ds_read_b128 v[152:155], v3 offset:14336
  s_waitcnt vmcnt(18) lgkmcnt(0)
  v_mfma_f32_16x16x32_bf16 v[16:19], v[116:119], v[196:199], v[16:19]
  v_mfma_f32_16x16x32_bf16 v[20:23], v[116:119], v[200:203], v[20:23]
  v_mfma_f32_16x16x32_bf16 v[24:27], v[116:119], v[204:207], v[24:27]
  v_mfma_f32_16x16x32_bf16 v[28:31], v[116:119], v[208:211], v[28:31]
  v_mfma_f32_16x16x32_bf16 v[32:35], v[120:123], v[196:199], v[32:35]
  v_mfma_f32_16x16x32_bf16 v[36:39], v[120:123], v[200:203], v[36:39]
  v_mfma_f32_16x16x32_bf16 v[40:43], v[120:123], v[204:207], v[40:43]
  v_mfma_f32_16x16x32_bf16 v[44:47], v[120:123], v[208:211], v[44:47]
  v_mfma_f32_16x16x32_bf16 v[48:51], v[124:127], v[196:199], v[48:51]
  v_mfma_f32_16x16x32_bf16 v[52:55], v[124:127], v[200:203], v[52:55]
  v_mfma_f32_16x16x32_bf16 v[56:59], v[124:127], v[204:207], v[56:59]
  v_mfma_f32_16x16x32_bf16 v[60:63], v[124:127], v[208:211], v[60:63]
  v_mfma_f32_16x16x32_bf16 v[64:67], v[128:131], v[196:199], v[64:67]
  v_mfma_f32_16x16x32_bf16 v[68:71], v[128:131], v[200:203], v[68:71]
  v_mfma_f32_16x16x32_bf16 v[72:75], v[128:131], v[204:207], v[72:75]
  v_mfma_f32_16x16x32_bf16 v[76:79], v[128:131], v[208:211], v[76:79]
  v_mfma_f32_16x16x32_bf16 v[80:83], v[132:135], v[196:199], v[80:83]
  v_mfma_f32_16x16x32_bf16 v[84:87], v[132:135], v[200:203], v[84:87]
  v_mfma_f32_16x16x32_bf16 v[88:91], v[132:135], v[204:207], v[88:91]
  v_mfma_f32_16x16x32_bf16 v[92:95], v[132:135], v[208:211], v[92:95]
  buffer_load_dwordx4 v[196:199], v1, s[16:19], s85 offen offset:0 sc1
  buffer_load_dwordx4 v[200:203], v1, s[16:19], s85 offen offset:1024 sc1
  buffer_load_dwordx4 v[204:207], v1, s[16:19], s85 offen offset:2048 sc1
  buffer_load_dwordx4 v[208:211], v1, s[16:19], s85 offen offset:3072 sc1
  s_add_u32 s85, s85, 4096
  buffer_load_dwordx4 v[116:119], v1, s[16:19], s84 offen offset:0 sc1
  buffer_load_dwordx4 v[120:123], v1, s[16:19], s84 offen offset:1024 sc1
  buffer_load_dwordx4 v[124:127], v1, s[16:19], s84 offen offset:2048 sc1
  buffer_load_dwordx4 v[128:131], v1, s[16:19], s84 offen offset:3072 sc1
  s_add_u32 s84, s84, 4096
  buffer_load_dwordx4 v[132:135], v1, s[16:19], s84 offen sc1
  s_add_u32 s84, s84, 1024
  ds_read_b128 v[156:159], v3 offset:15360
  ds_read_b128 v[160:163], v3 offset:16384
  ds_read_b128 v[164:167], v3 offset:17408
  ds_read_b128 v[168:171], v3 offset:18432
  ds_read_b128 v[172:175], v3 offset:19456
  s_waitcnt vmcnt(23) lgkmcnt(0)
  v_mfma_f32_16x16x32_bf16 v[16:19], v[136:139], v[212:215], v[16:19]
  v_mfma_f32_16x16x32_bf16 v[20:23], v[136:139], v[216:219], v[20:23]
  v_mfma_f32_16x16x32_bf16 v[24:27], v[136:139], v[220:223], v[24:27]
  v_mfma_f32_16x16x32_bf16 v[28:31], v[136:139], v[224:227], v[28:31]
  v_mfma_f32_16x16x32_bf16 v[32:35], v[140:143], v[212:215], v[32:35]
  v_mfma_f32_16x16x32_bf16 v[36:39], v[140:143], v[216:219], v[36:39]
  v_mfma_f32_16x16x32_bf16 v[40:43], v[140:143], v[220:223], v[40:43]
  v_mfma_f32_16x16x32_bf16 v[44:47], v[140:143], v[224:227], v[44:47]
  v_mfma_f32_16x16x32_bf16 v[48:51], v[144:147], v[212:215], v[48:51]
  v_mfma_f32_16x16x32_bf16 v[52:55], v[144:147], v[216:219], v[52:55]
  v_mfma_f32_16x16x32_bf16 v[56:59], v[144:147], v[220:223], v[56:59]
  v_mfma_f32_16x16x32_bf16 v[60:63], v[144:147], v[224:227], v[60:63]
  v_mfma_f32_16x16x32_bf16 v[64:67], v[148:151], v[212:215], v[64:67]
  v_mfma_f32_16x16x32_bf16 v[68:71], v[148:151], v[216:219], v[68:71]
  v_mfma_f32_16x16x32_bf16 v[72:75], v[148:151], v[220:223], v[72:75]
  v_mfma_f32_16x16x32_bf16 v[76:79], v[148:151], v[224:227], v[76:79]
  v_mfma_f32_16x16x32_bf16 v[80:83], v[152:155], v[212:215], v[80:83]
  v_mfma_f32_16x16x32_bf16 v[84:87], v[152:155], v[216:219], v[84:87]
  v_mfma_f32_16x16x32_bf16 v[88:91], v[152:155], v[220:223], v[88:91]
  v_mfma_f32_16x16x32_bf16 v[92:95], v[152:155], v[224:227], v[92:95]
  buffer_load_dwordx4 v[212:215], v1, s[16:19], s85 offen offset:0 sc1
  buffer_load_dwordx4 v[216:219], v1, s[16:19], s85 offen offset:1024 sc1
  buffer_load_dwordx4 v[220:223], v1, s[16:19], s85 offen offset:2048 sc1
  buffer_load_dwordx4 v[224:227], v1, s[16:19], s85 offen offset:3072 sc1
  s_add_u32 s85, s85, 4096
  buffer_load_dwordx4 v[136:139], v1, s[16:19], s84 offen offset:0 sc1
  buffer_load_dwordx4 v[140:143], v1, s[16:19], s84 offen offset:1024 sc1
  buffer_load_dwordx4 v[144:147], v1, s[16:19], s84 offen offset:2048 sc1
  buffer_load_dwordx4 v[148:151], v1, s[16:19], s84 offen offset:3072 sc1
  s_add_u32 s84, s84, 4096
  buffer_load_dwordx4 v[152:155], v1, s[16:19], s84 offen sc1
  s_add_u32 s84, s84, 1024
  s_waitcnt vmcnt(23) lgkmcnt(0)
  v_mfma_f32_16x16x32_bf16 v[16:19], v[156:159], v[228:231], v[16:19]
  v_mfma_f32_16x16x32_bf16 v[20:23], v[156:159], v[232:235], v[20:23]
  v_mfma_f32_16x16x32_bf16 v[24:27], v[156:159], v[236:239], v[24:27]
  v_mfma_f32_16x16x32_bf16 v[28:31], v[156:159], v[240:243], v[28:31]
  v_mfma_f32_16x16x32_bf16 v[32:35], v[160:163], v[228:231], v[32:35]
  v_mfma_f32_16x16x32_bf16 v[36:39], v[160:163], v[232:235], v[36:39]
  v_mfma_f32_16x16x32_bf16 v[40:43], v[160:163], v[236:239], v[40:43]
  v_mfma_f32_16x16x32_bf16 v[44:47], v[160:163], v[240:243], v[44:47]
  v_mfma_f32_16x16x32_bf16 v[48:51], v[164:167], v[228:231], v[48:51]
  v_mfma_f32_16x16x32_bf16 v[52:55], v[164:167], v[232:235], v[52:55]
  v_mfma_f32_16x16x32_bf16 v[56:59], v[164:167], v[236:239], v[56:59]
  v_mfma_f32_16x16x32_bf16 v[60:63], v[164:167], v[240:243], v[60:63]
  v_mfma_f32_16x16x32_bf16 v[64:67], v[168:171], v[228:231], v[64:67]
  v_mfma_f32_16x16x32_bf16 v[68:71], v[168:171], v[232:235], v[68:71]
  v_mfma_f32_16x16x32_bf16 v[72:75], v[168:171], v[236:239], v[72:75]
  v_mfma_f32_16x16x32_bf16 v[76:79], v[168:171], v[240:243], v[76:79]
  v_mfma_f32_16x16x32_bf16 v[80:83], v[172:175], v[228:231], v[80:83]
  v_mfma_f32_16x16x32_bf16 v[84:87], v[172:175], v[232:235], v[84:87]
  v_mfma_f32_16x16x32_bf16 v[88:91], v[172:175], v[236:239], v[88:91]
  v_mfma_f32_16x16x32_bf16 v[92:95], v[172:175], v[240:243], v[92:95]
  buffer_load_dwordx4 v[228:231], v1, s[16:19], s85 offen offset:0 sc1
  buffer_load_dwordx4 v[232:235], v1, s[16:19], s85 offen offset:1024 sc1
  buffer_load_dwordx4 v[236:239], v1, s[16:19], s85 offen offset:2048 sc1
  buffer_load_dwordx4 v[240:243], v1, s[16:19], s85 offen offset:3072 sc1
  s_add_u32 s85, s85, 4096
  buffer_load_dwordx4 v[156:159], v1, s[16:19], s84 offen offset:0 sc1
  buffer_load_dwordx4 v[160:163], v1, s[16:19], s84 offen offset:1024 sc1
  buffer_load_dwordx4 v[164:167], v1, s[16:19], s84 offen offset:2048 sc1
  buffer_load_dwordx4 v[168:171], v1, s[16:19], s84 offen offset:3072 sc1
  s_add_u32 s84, s84, 4096
  buffer_load_dwordx4 v[172:175], v1, s[16:19], s84 offen sc1
  s_add_u32 s84, s84, 1024
  s_waitcnt vmcnt(23)
  v_mfma_f32_16x16x32_bf16 v[16:19], v[176:179], v[196:199], v[16:19]
  v_mfma_f32_16x16x32_bf16 v[20:23], v[176:179], v[200:203], v[20:23]
  v_mfma_f32_16x16x32_bf16 v[24:27], v[176:179], v[204:207], v[24:27]
  v_mfma_f32_16x16x32_bf16 v[28:31], v[176:179], v[208:211], v[28:31]
  v_mfma_f32_16x16x32_bf16 v[32:35], v[180:183], v[196:199], v[32:35]
  v_mfma_f32_16x16x32_bf16 v[36:39], v[180:183], v[200:203], v[36:39]
  v_mfma_f32_16x16x32_bf16 v[40:43], v[180:183], v[204:207], v[40:43]
  v_mfma_f32_16x16x32_bf16 v[44:47], v[180:183], v[208:211], v[44:47]
  v_mfma_f32_16x16x32_bf16 v[48:51], v[184:187], v[196:199], v[48:51]
  v_mfma_f32_16x16x32_bf16 v[52:55], v[184:187], v[200:203], v[52:55]
  v_mfma_f32_16x16x32_bf16 v[56:59], v[184:187], v[204:207], v[56:59]
  v_mfma_f32_16x16x32_bf16 v[60:63], v[184:187], v[208:211], v[60:63]
  v_mfma_f32_16x16x32_bf16 v[64:67], v[188:191], v[196:199], v[64:67]
  v_mfma_f32_16x16x32_bf16 v[68:71], v[188:191], v[200:203], v[68:71]
  v_mfma_f32_16x16x32_bf16 v[72:75], v[188:191], v[204:207], v[72:75]
  v_mfma_f32_16x16x32_bf16 v[76:79], v[188:191], v[208:211], v[76:79]
  v_mfma_f32_16x16x32_bf16 v[80:83], v[192:195], v[196:199], v[80:83]
  v_mfma_f32_16x16x32_bf16 v[84:87], v[192:195], v[200:203], v[84:87]
  v_mfma_f32_16x16x32_bf16 v[88:91], v[192:195], v[204:207], v[88:91]
  v_mfma_f32_16x16x32_bf16 v[92:95], v[192:195], v[208:211], v[92:95]
  buffer_load_dwordx4 v[196:199], v1, s[16:19], s85 offen offset:0 sc1
  buffer_load_dwordx4 v[200:203], v1, s[16:19], s85 offen offset:1024 sc1
  buffer_load_dwordx4 v[204:207], v1, s[16:19], s85 offen offset:2048 sc1
  buffer_load_dwordx4 v[208:211], v1, s[16:19], s85 offen offset:3072 sc1
  s_add_u32 s85, s85, 4096
  s_waitcnt vmcnt(18)
  v_mfma_f32_16x16x32_bf16 v[16:19], v[96:99], v[212:215], v[16:19]
  v_mfma_f32_16x16x32_bf16 v[20:23], v[96:99], v[216:219], v[20:23]
  v_mfma_f32_16x16x32_bf16 v[24:27], v[96:99], v[220:223], v[24:27]
  v_mfma_f32_16x16x32_bf16 v[28:31], v[96:99], v[224:227], v[28:31]
  v_mfma_f32_16x16x32_bf16 v[32:35], v[100:103], v[212:215], v[32:35]
  v_mfma_f32_16x16x32_bf16 v[36:39], v[100:103], v[216:219], v[36:39]
  v_mfma_f32_16x16x32_bf16 v[40:43], v[100:103], v[220:223], v[40:43]
  v_mfma_f32_16x16x32_bf16 v[44:47], v[100:103], v[224:227], v[44:47]
  v_mfma_f32_16x16x32_bf16 v[48:51], v[104:107], v[212:215], v[48:51]
  v_mfma_f32_16x16x32_bf16 v[52:55], v[104:107], v[216:219], v[52:55]
  v_mfma_f32_16x16x32_bf16 v[56:59], v[104:107], v[220:223], v[56:59]
  v_mfma_f32_16x16x32_bf16 v[60:63], v[104:107], v[224:227], v[60:63]
  v_mfma_f32_16x16x32_bf16 v[64:67], v[108:111], v[212:215], v[64:67]
  v_mfma_f32_16x16x32_bf16 v[68:71], v[108:111], v[216:219], v[68:71]
  v_mfma_f32_16x16x32_bf16 v[72:75], v[108:111], v[220:223], v[72:75]
  v_mfma_f32_16x16x32_bf16 v[76:79], v[108:111], v[224:227], v[76:79]
  v_mfma_f32_16x16x32_bf16 v[80:83], v[112:115], v[212:215], v[80:83]
  v_mfma_f32_16x16x32_bf16 v[84:87], v[112:115], v[216:219], v[84:87]
  v_mfma_f32_16x16x32_bf16 v[88:91], v[112:115], v[220:223], v[88:91]
  v_mfma_f32_16x16x32_bf16 v[92:95], v[112:115], v[224:227], v[92:95]
  buffer_load_dwordx4 v[212:215], v1, s[16:19], s85 offen offset:0 sc1
  buffer_load_dwordx4 v[216:219], v1, s[16:19], s85 offen offset:1024 sc1
  buffer_load_dwordx4 v[220:223], v1, s[16:19], s85 offen offset:2048 sc1
  buffer_load_dwordx4 v[224:227], v1, s[16:19], s85 offen offset:3072 sc1
  s_add_u32 s85, s85, 4096
  s_waitcnt vmcnt(13)
  v_mfma_f32_16x16x32_bf16 v[16:19], v[116:119], v[228:231], v[16:19]
  v_mfma_f32_16x16x32_bf16 v[20:23], v[116:119], v[232:235], v[20:23]
  v_mfma_f32_16x16x32_bf16 v[24:27], v[116:119], v[236:239], v[24:27]
  v_mfma_f32_16x16x32_bf16 v[28:31], v[116:119], v[240:243], v[28:31]
  v_mfma_f32_16x16x32_bf16 v[32:35], v[120:123], v[228:231], v[32:35]
  v_mfma_f32_16x16x32_bf16 v[36:39], v[120:123], v[232:235], v[36:39]
  v_mfma_f32_16x16x32_bf16 v[40:43], v[120:123], v[236:239], v[40:43]
  v_mfma_f32_16x16x32_bf16 v[44:47], v[120:123], v[240:243], v[44:47]
  v_mfma_f32_16x16x32_bf16 v[48:51], v[124:127], v[228:231], v[48:51]
  v_mfma_f32_16x16x32_bf16 v[52:55], v[124:127], v[232:235], v[52:55]
  v_mfma_f32_16x16x32_bf16 v[56:59], v[124:127], v[236:239], v[56:59]
  v_mfma_f32_16x16x32_bf16 v[60:63], v[124:127], v[240:243], v[60:63]
  v_mfma_f32_16x16x32_bf16 v[64:67], v[128:131], v[228:231], v[64:67]
  v_mfma_f32_16x16x32_bf16 v[68:71], v[128:131], v[232:235], v[68:71]
  v_mfma_f32_16x16x32_bf16 v[72:75], v[128:131], v[236:239], v[72:75]
  v_mfma_f32_16x16x32_bf16 v[76:79], v[128:131], v[240:243], v[76:79]
  v_mfma_f32_16x16x32_bf16 v[80:83], v[132:135], v[228:231], v[80:83]
  v_mfma_f32_16x16x32_bf16 v[84:87], v[132:135], v[232:235], v[84:87]
  v_mfma_f32_16x16x32_bf16 v[88:91], v[132:135], v[236:239], v[88:91]
  v_mfma_f32_16x16x32_bf16 v[92:95], v[132:135], v[240:243], v[92:95]
  s_waitcnt vmcnt(4)
  v_mfma_f32_16x16x32_bf16 v[16:19], v[136:139], v[196:199], v[16:19]
  v_mfma_f32_16x16x32_bf16 v[20:23], v[136:139], v[200:203], v[20:23]
  v_mfma_f32_16x16x32_bf16 v[24:27], v[136:139], v[204:207], v[24:27]
  v_mfma_f32_16x16x32_bf16 v[28:31], v[136:139], v[208:211], v[28:31]
  v_mfma_f32_16x16x32_bf16 v[32:35], v[140:143], v[196:199], v[32:35]
  v_mfma_f32_16x16x32_bf16 v[36:39], v[140:143], v[200:203], v[36:39]
  v_mfma_f32_16x16x32_bf16 v[40:43], v[140:143], v[204:207], v[40:43]
  v_mfma_f32_16x16x32_bf16 v[44:47], v[140:143], v[208:211], v[44:47]
  v_mfma_f32_16x16x32_bf16 v[48:51], v[144:147], v[196:199], v[48:51]
  v_mfma_f32_16x16x32_bf16 v[52:55], v[144:147], v[200:203], v[52:55]
  v_mfma_f32_16x16x32_bf16 v[56:59], v[144:147], v[204:207], v[56:59]
  v_mfma_f32_16x16x32_bf16 v[60:63], v[144:147], v[208:211], v[60:63]
  v_mfma_f32_16x16x32_bf16 v[64:67], v[148:151], v[196:199], v[64:67]
  v_mfma_f32_16x16x32_bf16 v[68:71], v[148:151], v[200:203], v[68:71]
  v_mfma_f32_16x16x32_bf16 v[72:75], v[148:151], v[204:207], v[72:75]
  v_mfma_f32_16x16x32_bf16 v[76:79], v[148:151], v[208:211], v[76:79]
  v_mfma_f32_16x16x32_bf16 v[80:83], v[152:155], v[196:199], v[80:83]
  v_mfma_f32_16x16x32_bf16 v[84:87], v[152:155], v[200:203], v[84:87]
  v_mfma_f32_16x16x32_bf16 v[88:91], v[152:155], v[204:207], v[88:91]
  v_mfma_f32_16x16x32_bf16 v[92:95], v[152:155], v[208:211], v[92:95]
  s_waitcnt vmcnt(0)
  v_mfma_f32_16x16x32_bf16 v[16:19], v[156:159], v[212:215], v[16:19]
  v_mfma_f32_16x16x32_bf16 v[20:23], v[156:159], v[216:219], v[20:23]
  v_mfma_f32_16x16x32_bf16 v[24:27], v[156:159], v[220:223], v[24:27]
  v_mfma_f32_16x16x32_bf16 v[28:31], v[156:159], v[224:227], v[28:31]
  v_mfma_f32_16x16x32_bf16 v[32:35], v[160:163], v[212:215], v[32:35]
  v_mfma_f32_16x16x32_bf16 v[36:39], v[160:163], v[216:219], v[36:39]
  v_mfma_f32_16x16x32_bf16 v[40:43], v[160:163], v[220:223], v[40:43]
  v_mfma_f32_16x16x32_bf16 v[44:47], v[160:163], v[224:227], v[44:47]
  v_mfma_f32_16x16x32_bf16 v[48:51], v[164:167], v[212:215], v[48:51]
  v_mfma_f32_16x16x32_bf16 v[52:55], v[164:167], v[216:219], v[52:55]
  v_mfma_f32_16x16x32_bf16 v[56:59], v[164:167], v[220:223], v[56:59]
  v_mfma_f32_16x16x32_bf16 v[60:63], v[164:167], v[224:227], v[60:63]
  v_mfma_f32_16x16x32_bf16 v[64:67], v[168:171], v[212:215], v[64:67]
  v_mfma_f32_16x16x32_bf16 v[68:71], v[168:171], v[216:219], v[68:71]
  v_mfma_f32_16x16x32_bf16 v[72:75], v[168:171], v[220:223], v[72:75]
  v_mfma_f32_16x16x32_bf16 v[76:79], v[168:171], v[224:227], v[76:79]
  v_mfma_f32_16x16x32_bf16 v[80:83], v[172:175], v[212:215], v[80:83]
  v_mfma_f32_16x16x32_bf16 v[84:87], v[172:175], v[216:219], v[84:87]
  v_mfma_f32_16x16x32_bf16 v[88:91], v[172:175], v[220:223], v[88:91]
  v_mfma_f32_16x16x32_bf16 v[92:95], v[172:175], v[224:227], v[92:95]
  s_branch L_FFN_done
L_FFN_13:
  buffer_load_dwordx4 v[196:199], v1, s[16:19], s85 offen offset:0 sc1
  buffer_load_dwordx4 v[200:203], v1, s[16:19], s85 offen offset:1024 sc1
  buffer_load_dwordx4 v[204:207], v1, s[16:19], s85 offen offset:2048 sc1
  buffer_load_dwordx4 v[208:211], v1, s[16:19], s85 offen offset:3072 sc1
  s_add_u32 s85, s85, 4096
  buffer_load_dwordx4 v[212:215], v1, s[16:19], s85 offen offset:0 sc1
  buffer_load_dwordx4 v[216:219], v1, s[16:19], s85 offen offset:1024 sc1
  buffer_load_dwordx4 v[220:223], v1, s[16:19], s85 offen offset:2048 sc1
  buffer_load_dwordx4 v[224:227], v1, s[16:19], s85 offen offset:3072 sc1
  s_add_u32 s85, s85, 4096
  buffer_load_dwordx4 v[228:231], v1, s[16:19], s85 offen offset:0 sc1
  buffer_load_dwordx4 v[232:235], v1, s[16:19], s85 offen offset:1024 sc1
  buffer_load_dwordx4 v[236:239], v1, s[16:19], s85 offen offset:2048 sc1
  buffer_load_dwordx4 v[240:243], v1, s[16:19], s85 offen offset:3072 sc1
  s_add_u32 s85, s85, 4096
  s_waitcnt vmcnt(8)
  v_mov_b32 v10, 152596
  v_mov_b32 v11, 1
  s_mov_b64 exec, 1
  ds_add_u32 v10, v11
  s_mov_b64 exec, -1
  v_mfma_f32_16x16x32_bf16 v[16:19], v[96:99], v[196:199], v[16:19]
  v_mfma_f32_16x16x32_bf16 v[20:23], v[96:99], v[200:203], v[20:23]
  v_mfma_f32_16x16x32_bf16 v[24:27], v[96:99], v[204:207], v[24:27]
  v_mfma_f32_16x16x32_bf16 v[28:31], v[96:99], v[208:211], v[28:31]
  v_mfma_f32_16x16x32_bf16 v[32:35], v[100:103], v[196:199], v[32:35]
  v_mfma_f32_16x16x32_bf16 v[36:39], v[100:103], v[200:203], v[36:39]
  v_mfma_f32_16x16x32_bf16 v[40:43], v[100:103], v[204:207], v[40:43]
  v_mfma_f32_16x16x32_bf16 v[44:47], v[100:103], v[208:211], v[44:47]
  v_mfma_f32_16x16x32_bf16 v[48:51], v[104:107], v[196:199], v[48:51]
  v_mfma_f32_16x16x32_bf16 v[52:55], v[104:107], v[200:203], v[52:55]
  v_mfma_f32_16x16x32_bf16 v[56:59], v[104:107], v[204:207], v[56:59]
  v_mfma_f32_16x16x32_bf16 v[60:63], v[104:107], v[208:211], v[60:63]
  v_mfma_f32_16x16x32_bf16 v[64:67], v[108:111], v[196:199], v[64:67]
  v_mfma_f32_16x16x32_bf16 v[68:71], v[108:111], v[200:203], v[68:71]
  v_mfma_f32_16x16x32_bf16 v[72:75], v[108:111], v[204:207], v[72:75]
  v_mfma_f32_16x16x32_bf16 v[76:79], v[108:111], v[208:211], v[76:79]
  v_mfma_f32_16x16x32_bf16 v[80:83], v[112:115], v[196:199], v[80:83]
  v_mfma_f32_16x16x32_bf16 v[84:87], v[112:115], v[200:203], v[84:87]
  v_mfma_f32_16x16x32_bf16 v[88:91], v[112:115], v[204:207], v[88:91]
  v_mfma_f32_16x16x32_bf16 v[92:95], v[112:115], v[208:211], v[92:95]
  buffer_load_dwordx4 v[196:199], v1, s[16:19], s85 offen offset:0 sc1
  buffer_load_dwordx4 v[200:203], v1, s[16:19], s85 offen offset:1024 sc1
  buffer_load_dwordx4 v[204:207], v1, s[16:19], s85 offen offset:2048 sc1
  buffer_load_dwordx4 v[208:211], v1, s[16:19], s85 offen offset:3072 sc1
  s_add_u32 s85, s85, 4096
  s_waitcnt vmcnt(8)
  v_mfma_f32_16x16x32_bf16 v[16:19], v[116:119], v[212:215], v[16:19]
  v_mfma_f32_16x16x32_bf16 v[20:23], v[116:119], v[216:219], v[20:23]
  v_mfma_f32_16x16x32_bf16 v[24:27], v[116:119], v[220:223], v[24:27]
  v_mfma_f32_16x16x32_bf16 v[28:31], v[116:119], v[224:227], v[28:31]
  v_mfma_f32_16x16x32_bf16 v[32:35], v[120:123], v[212:215], v[32:35]
  v_mfma_f32_16x16x32_bf16 v[36:39], v[120:123], v[216:219], v[36:39]
  v_mfma_f32_16x16x32_bf16 v[40:43], v[120:123], v[220:223], v[40:43]
  v_mfma_f32_16x16x32_bf16 v[44:47], v[120:123], v[224:227], v[44:47]
  v_mfma_f32_16x16x32_bf16 v[48:51], v[124:127], v[212:215], v[48:51]
  v_mfma_f32_16x16x32_bf16 v[52:55], v[124:127], v[216:219], v[52:55]
  v_mfma_f32_16x16x32_bf16 v[56:59], v[124:127], v[220:223], v[56:59]
  v_mfma_f32_16x16x32_bf16 v[60:63], v[124:127], v[224:227], v[60:63]
  v_mfma_f32_16x16x32_bf16 v[64:67], v[128:131], v[212:215], v[64:67]
  v_mfma_f32_16x16x32_bf16 v[68:71], v[128:131], v[216:219], v[68:71]
  v_mfma_f32_16x16x32_bf16 v[72:75], v[128:131], v[220:223], v[72:75]
  v_mfma_f32_16x16x32_bf16 v[76:79], v[128:131], v[224:227], v[76:79]
  v_mfma_f32_16x16x32_bf16 v[80:83], v[132:135], v[212:215], v[80:83]
  v_mfma_f32_16x16x32_bf16 v[84:87], v[132:135], v[216:219], v[84:87]
  v_mfma_f32_16x16x32_bf16 v[88:91], v[132:135], v[220:223], v[88:91]
  v_mfma_f32_16x16x32_bf16 v[92:95], v[132:135], v[224:227], v[92:95]
  buffer_load_dwordx4 v[212:215], v1, s[16:19], s85 offen offset:0 sc1
  buffer_load_dwordx4 v[216:219], v1, s[16:19], s85 offen offset:1024 sc1
  buffer_load_dwordx4 v[220:223], v1, s[16:19], s85 offen offset:2048 sc1
  buffer_load_dwordx4 v[224:227], v1, s[16:19], s85 offen offset:3072 sc1
  s_add_u32 s85, s85, 4096
  s_waitcnt vmcnt(8)
  v_mfma_f32_16x16x32_bf16 v[16:19], v[136:139], v[228:231], v[16:19]
  v_mfma_f32_16x16x32_bf16 v[20:23], v[136:139], v[232:235], v[20:23]
  v_mfma_f32_16x16x32_bf16 v[24:27], v[136:139], v[236:239], v[24:27]
  v_mfma_f32_16x16x32_bf16 v[28:31], v[136:139], v[240:243], v[28:31]
  v_mfma_f32_16x16x32_bf16 v[32:35], v[140:143], v[228:231], v[32:35]
  v_mfma_f32_16x16x32_bf16 v[36:39], v[140:143], v[232:235], v[36:39]
  v_mfma_f32_16x16x32_bf16 v[40:43], v[140:143], v[236:239], v[40:43]
  v_mfma_f32_16x16x32_bf16 v[44:47], v[140:143], v[240:243], v[44:47]
  v_mfma_f32_16x16x32_bf16 v[48:51], v[144:147], v[228:231], v[48:51]
  v_mfma_f32_16x16x32_bf16 v[52:55], v[144:147], v[232:235], v[52:55]
  v_mfma_f32_16x16x32_bf16 v[56:59], v[144:147], v[236:239], v[56:59]
  v_mfma_f32_16x16x32_bf16 v[60:63], v[144:147], v[240:243], v[60:63]
  v_mfma_f32_16x16x32_bf16 v[64:67], v[148:151], v[228:231], v[64:67]
  v_mfma_f32_16x16x32_bf16 v[68:71], v[148:151], v[232:235], v[68:71]
  v_mfma_f32_16x16x32_bf16 v[72:75], v[148:151], v[236:239], v[72:75]
  v_mfma_f32_16x16x32_bf16 v[76:79], v[148:151], v[240:243], v[76:79]
  v_mfma_f32_16x16x32_bf16 v[80:83], v[152:155], v[228:231], v[80:83]
  v_mfma_f32_16x16x32_bf16 v[84:87], v[152:155], v[232:235], v[84:87]
  v_mfma_f32_16x16x32_bf16 v[88:91], v[152:155], v[236:239], v[88:91]
  v_mfma_f32_16x16x32_bf16 v[92:95], v[152:155], v[240:243], v[92:95]
  buffer_load_dwordx4 v[228:231], v1, s[16:19], s85 offen offset:0 sc1
  buffer_load_dwordx4 v[232:235], v1, s[16:19], s85 offen offset:1024 sc1
  buffer_load_dwordx4 v[236:239], v1, s[16:19], s85 offen offset:2048 sc1
  buffer_load_dwordx4 v[240:243], v1, s[16:19], s85 offen offset:3072 sc1
  s_add_u32 s85, s85, 4096
  s_waitcnt vmcnt(8)
  v_mfma_f32_16x16x32_bf16 v[16:19], v[156:159], v[196:199], v[16:19]
  v_mfma_f32_16x16x32_bf16 v[20:23], v[156:159], v[200:203], v[20:23]
  v_mfma_f32_16x16x32_bf16 v[24:27], v[156:159], v[204:207], v[24:27]
  v_mfma_f32_16x16x32_bf16 v[28:31], v[156:159], v[208:211], v[28:31]
  v_mfma_f32_16x16x32_bf16 v[32:35], v[160:163], v[196:199], v[32:35]
  v_mfma_f32_16x16x32_bf16 v[36:39], v[160:163], v[200:203], v[36:39]
  v_mfma_f32_16x16x32_bf16 v[40:43], v[160:163], v[204:207], v[40:43]
  v_mfma_f32_16x16x32_bf16 v[44:47], v[160:163], v[208:211], v[44:47]
  v_mfma_f32_16x16x32_bf16 v[48:51], v[164:167], v[196:199], v[48:51]
  v_mfma_f32_16x16x32_bf16 v[52:55], v[164:167], v[200:203], v[52:55]
  v_mfma_f32_16x16x32_bf16 v[56:59], v[164:167], v[204:207], v[56:59]
  v_mfma_f32_16x16x32_bf16 v[60:63], v[164:167], v[208:211], v[60:63]
  v_mfma_f32_16x16x32_bf16 v[64:67], v[168:171], v[196:199], v[64:67]
  v_mfma_f32_16x16x32_bf16 v[68:71], v[168:171], v[200:203], v[68:71]
  v_mfma_f32_16x16x32_bf16 v[72:75], v[168:171], v[204:207], v[72:75]
  v_mfma_f32_16x16x32_bf16 v[76:79], v[168:171], v[208:211], v[76:79]
  v_mfma_f32_16x16x32_bf16 v[80:83], v[172:175], v[196:199], v[80:83]
  v_mfma_f32_16x16x32_bf16 v[84:87], v[172:175], v[200:203], v[84:87]
  v_mfma_f32_16x16x32_bf16 v[88:91], v[172:175], v[204:207], v[88:91]
  v_mfma_f32_16x16x32_bf16 v[92:95], v[172:175], v[208:211], v[92:95]
  buffer_load_dwordx4 v[196:199], v1, s[16:19], s85 offen offset:0 sc1
  buffer_load_dwordx4 v[200:203], v1, s[16:19], s85 offen offset:1024 sc1
  buffer_load_dwordx4 v[204:207], v1, s[16:19], s85 offen offset:2048 sc1
  buffer_load_dwordx4 v[208:211], v1, s[16:19], s85 offen offset:3072 sc1
  s_add_u32 s85, s85, 4096
  ds_read_b128 v[96:99], v3 offset:0
  ds_read_b128 v[100:103], v3 offset:1024
  ds_read_b128 v[104:107], v3 offset:2048
  ds_read_b128 v[108:111], v3 offset:3072
  ds_read_b128 v[112:115], v3 offset:4096
  s_waitcnt vmcnt(8)
  v_mfma_f32_16x16x32_bf16 v[16:19], v[176:179], v[212:215], v[16:19]
  v_mfma_f32_16x16x32_bf16 v[20:23], v[176:179], v[216:219], v[20:23]
  v_mfma_f32_16x16x32_bf16 v[24:27], v[176:179], v[220:223], v[24:27]
  v_mfma_f32_16x16x32_bf16 v[28:31], v[176:179], v[224:227], v[28:31]
  v_mfma_f32_16x16x32_bf16 v[32:35], v[180:183], v[212:215], v[32:35]
  v_mfma_f32_16x16x32_bf16 v[36:39], v[180:183], v[216:219], v[36:39]
  v_mfma_f32_16x16x32_bf16 v[40:43], v[180:183], v[220:223], v[40:43]
  v_mfma_f32_16x16x32_bf16 v[44:47], v[180:183], v[224:227], v[44:47]
  v_mfma_f32_16x16x32_bf16 v[48:51], v[184:187], v[212:215], v[48:51]
  v_mfma_f32_16x16x32_bf16 v[52:55], v[184:187], v[216:219], v[52:55]
  v_mfma_f32_16x16x32_bf16 v[56:59], v[184:187], v[220:223], v[56:59]
  v_mfma_f32_16x16x32_bf16 v[60:63], v[184:187], v[224:227], v[60:63]
  v_mfma_f32_16x16x32_bf16 v[64:67], v[188:191], v[212:215], v[64:67]
  v_mfma_f32_16x16x32_bf16 v[68:71], v[188:191], v[216:219], v[68:71]
  v_mfma_f32_16x16x32_bf16 v[72:75], v[188:191], v[220:223], v[72:75]
  v_mfma_f32_16x16x32_bf16 v[76:79], v[188:191], v[224:227], v[76:79]
  v_mfma_f32_16x16x32_bf16 v[80:83], v[192:195], v[212:215], v[80:83]
  v_mfma_f32_16x16x32_bf16 v[84:87], v[192:195], v[216:219], v[84:87]
  v_mfma_f32_16x16x32_bf16 v[88:91], v[192:195], v[220:223], v[88:91]
  v_mfma_f32_16x16x32_bf16 v[92:95], v[192:195], v[224:227], v[92:95]
  buffer_load_dwordx4 v[212:215], v1, s[16:19], s85 offen offset:0 sc1
  buffer_load_dwordx4 v[216:219], v1, s[16:19], s85 offen offset:1024 sc1
  buffer_load_dwordx4 v[220:223], v1, s[16:19], s85 offen offset:2048 sc1
  buffer_load_dwordx4 v[224:227], v1, s[16:19], s85 offen offset:3072 sc1
  s_add_u32 s85, s85, 4096
  buffer_load_dwordx4 v[176:179], v1, s[16:19], s84 offen offset:0 sc1
  buffer_load_dwordx4 v[180:183], v1, s[16:19], s84 offen offset:1024 sc1
  buffer_load_dwordx4 v[184:187], v1, s[16:19], s84 offen offset:2048 sc1
  buffer_load_dwordx4 v[188:191], v1, s[16:19], s84 offen offset:3072 sc1
  s_add_u32 s84, s84, 4096
  buffer_load_dwordx4 v[192:195], v1, s[16:19], s84 offen sc1
  s_add_u32 s84, s84, 1024
  ds_read_b128 v[116:119], v3 offset:5120
  ds_read_b128 v[120:123], v3 offset:6144
  ds_read_b128 v[124:127], v3 offset:7168
  ds_read_b128 v[128:131], v3 offset:8192
  ds_read_b128 v[132:135], v3 offset:9216
  s_waitcnt vmcnt(13) lgkmcnt(0)
  v_mfma_f32_16x16x32_bf16 v[16:19], v[96:99], v[228:231], v[16:19]
  v_mfma_f32_16x16x32_bf16 v[20:23], v[96:99], v[232:235], v[20:23]
  v_mfma_f32_16x16x32_bf16 v[24:27], v[96:99], v[236:239], v[24:27]
  v_mfma_f32_16x16x32_bf16 v[28:31], v[96:99], v[240:243], v[28:31]
  v_mfma_f32_16x16x32_bf16 v[32:35], v[100:103], v[228:231], v[32:35]
  v_mfma_f32_16x16x32_bf16 v[36:39], v[100:103], v[232:235], v[36:39]
  v_mfma_f32_16x16x32_bf16 v[40:43], v[100:103], v[236:239], v[40:43]
  v_mfma_f32_16x16x32_bf16 v[44:47], v[100:103], v[240:243], v[44:47]
  v_mfma_f32_16x16x32_bf16 v[48:51], v[104:107], v[228:231], v[48:51]
  v_mfma_f32_16x16x32_bf16 v[52:55], v[104:107], v[232:235], v[52:55]
  v_mfma_f32_16x16x32_bf16 v[56:59], v[104:107], v[236:239], v[56:59]
  v_mfma_f32_16x16x32_bf16 v[60:63], v[104:107], v[240:243], v[60:63]
  v_mfma_f32_16x16x32_bf16 v[64:67], v[108:111], v[228:231], v[64:67]
  v_mfma_f32_16x16x32_bf16 v[68:71], v[108:111], v[232:235], v[68:71]
  v_mfma_f32_16x16x32_bf16 v[72:75], v[108:111], v[236:239], v[72:75]
  v_mfma_f32_16x16x32_bf16 v[76:79], v[108:111], v[240:243], v[76:79]
  v_mfma_f32_16x16x32_bf16 v[80:83], v[112:115], v[228:231], v[80:83]
  v_mfma_f32_16x16x32_bf16 v[84:87], v[112:115], v[232:235], v[84:87]
  v_mfma_f32_16x16x32_bf16 v[88:91], v[112:115], v[236:239], v[88:91]
  v_mfma_f32_16x16x32_bf16 v[92:95], v[112:115], v[240:243], v[92:95]
  buffer_load_dwordx4 v[228:231], v1, s[16:19], s85 offen offset:0 sc1
  buffer_load_dwordx4 v[232:235], v1, s[16:19], s85 offen offset:1024 sc1
  buffer_load_dwordx4 v[236:239], v1, s[16:19], s85 offen offset:2048 sc1
  buffer_load_dwordx4 v[240:243], v1, s[16:19], s85 offen offset:3072 sc1
  s_add_u32 s85, s85, 4096
  buffer_load_dwordx4 v[96:99], v1, s[16:19], s84 offen offset:0 sc1
  buffer_load_dwordx4 v[100:103], v1, s[16:19], s84 offen offset:1024 sc1
  buffer_load_dwordx4 v[104:107], v1, s[16:19], s84 offen offset:2048 sc1
  buffer_load_dwordx4 v[108:111], v1, s[16:19], s84 offen offset:3072 sc1
  s_add_u32 s84, s84, 4096
  buffer_load_dwordx4 v[112:115], v1, s[16:19], s84 offen sc1
  s_add_u32 s84, s84, 1024
  ds_read_b128 v[136:139], v3 offset:10240
  ds_read_b128 v[140:143], v3 offset:11264
  ds_read_b128 v[144:147], v3 offset:12288
  ds_read_b128 v[148:151], v3 offset:13312
  ds_read_b128 v[152:155], v3 offset:14336
  s_waitcnt vmcnt(18) lgkmcnt(0)
  v_mfma_f32_16x16x32_bf16 v[16:19], v[116:119], v[196:199], v[16:19]
  v_mfma_f32_16x16x32_bf16 v[20:23], v[116:119], v[200:203], v[20:23]
  v_mfma_f32_16x16x32_bf16 v[24:27], v[116:119], v[204:207], v[24:27]
  v_mfma_f32_16x16x32_bf16 v[28:31], v[116:119], v[208:211], v[28:31]
  v_mfma_f32_16x16x32_bf16 v[32:35], v[120:123], v[196:199], v[32:35]
  v_mfma_f32_16x16x32_bf16 v[36:39], v[120:123], v[200:203], v[36:39]
  v_mfma_f32_16x16x32_bf16 v[40:43], v[120:123], v[204:207], v[40:43]
  v_mfma_f32_16x16x32_bf16 v[44:47], v[120:123], v[208:211], v[44:47]
  v_mfma_f32_16x16x32_bf16 v[48:51], v[124:127], v[196:199], v[48:51]
  v_mfma_f32_16x16x32_bf16 v[52:55], v[124:127], v[200:203], v[52:55]
  v_mfma_f32_16x16x32_bf16 v[56:59], v[124:127], v[204:207], v[56:59]
  v_mfma_f32_16x16x32_bf16 v[60:63], v[124:127], v[208:211], v[60:63]
  v_mfma_f32_16x16x32_bf16 v[64:67], v[128:131], v[196:199], v[64:67]
  v_mfma_f32_16x16x32_bf16 v[68:71], v[128:131], v[200:203], v[68:71]
  v_mfma_f32_16x16x32_bf16 v[72:75], v[128:131], v[204:207], v[72:75]
  v_mfma_f32_16x16x32_bf16 v[76:79], v[128:131], v[208:211], v[76:79]
  v_mfma_f32_16x16x32_bf16 v[80:83], v[132:135], v[196:199], v[80:83]
  v_mfma_f32_16x16x32_bf16 v[84:87], v[132:135], v[200:203], v[84:87]
  v_mfma_f32_16x16x32_bf16 v[88:91], v[132:135], v[204:207], v[88:91]
  v_mfma_f32_16x16x32_bf16 v[92:95], v[132:135], v[208:211], v[92:95]
  buffer_load_dwordx4 v[196:199], v1, s[16:19], s85 offen offset:0 sc1
  buffer_load_dwordx4 v[200:203], v1, s[16:19], s85 offen offset:1024 sc1
  buffer_load_dwordx4 v[204:207], v1, s[16:19], s85 offen offset:2048 sc1
  buffer_load_dwordx4 v[208:211], v1, s[16:19], s85 offen offset:3072 sc1
  s_add_u32 s85, s85, 4096
  buffer_load_dwordx4 v[116:119], v1, s[16:19], s84 offen offset:0 sc1
  buffer_load_dwordx4 v[120:123], v1, s[16:19], s84 offen offset:1024 sc1
  buffer_load_dwordx4 v[124:127], v1, s[16:19], s84 offen offset:2048 sc1
  buffer_load_dwordx4 v[128:131], v1, s[16:19], s84 offen offset:3072 sc1
  s_add_u32 s84, s84, 4096
  buffer_load_dwordx4 v[132:135], v1, s[16:19], s84 offen sc1
  s_add_u32 s84, s84, 1024
  ds_read_b128 v[156:159], v3 offset:15360
  ds_read_b128 v[160:163], v3 offset:16384
  ds_read_b128 v[164:167], v3 offset:17408
  ds_read_b128 v[168:171], v3 offset:18432
  ds_read_b128 v[172:175], v3 offset:19456
  s_waitcnt vmcnt(23) lgkmcnt(0)
  v_mfma_f32_16x16x32_bf16 v[16:19], v[136:139], v[212:215], v[16:19]
  v_mfma_f32_16x16x32_bf16 v[20:23], v[136:139], v[216:219], v[20:23]
  v_mfma_f32_16x16x32_bf16 v[24:27], v[136:139], v[220:223], v[24:27]
  v_mfma_f32_16x16x32_bf16 v[28:31], v[136:139], v[224:227], v[28:31]
  v_mfma_f32_16x16x32_bf16 v[32:35], v[140:143], v[212:215], v[32:35]
  v_mfma_f32_16x16x32_bf16 v[36:39], v[140:143], v[216:219], v[36:39]
  v_mfma_f32_16x16x32_bf16 v[40:43], v[140:143], v[220:223], v[40:43]
  v_mfma_f32_16x16x32_bf16 v[44:47], v[140:143], v[224:227], v[44:47]
  v_mfma_f32_16x16x32_bf16 v[48:51], v[144:147], v[212:215], v[48:51]
  v_mfma_f32_16x16x32_bf16 v[52:55], v[144:147], v[216:219], v[52:55]
  v_mfma_f32_16x16x32_bf16 v[56:59], v[144:147], v[220:223], v[56:59]
  v_mfma_f32_16x16x32_bf16 v[60:63], v[144:147], v[224:227], v[60:63]
  v_mfma_f32_16x16x32_bf16 v[64:67], v[148:151], v[212:215], v[64:67]
  v_mfma_f32_16x16x32_bf16 v[68:71], v[148:151], v[216:219], v[68:71]
  v_mfma_f32_16x16x32_bf16 v[72:75], v[148:151], v[220:223], v[72:75]
  v_mfma_f32_16x16x32_bf16 v[76:79], v[148:151], v[224:227], v[76:79]
  v_mfma_f32_16x16x32_bf16 v[80:83], v[152:155], v[212:215], v[80:83]
  v_mfma_f32_16x16x32_bf16 v[84:87], v[152:155], v[216:219], v[84:87]
  v_mfma_f32_16x16x32_bf16 v[88:91], v[152:155], v[220:223], v[88:91]
  v_mfma_f32_16x16x32_bf16 v[92:95], v[152:155], v[224:227], v[92:95]
  buffer_load_dwordx4 v[212:215], v1, s[16:19], s85 offen offset:0 sc1
  buffer_load_dwordx4 v[216:219], v1, s[16:19], s85 offen offset:1024 sc1
  buffer_load_dwordx4 v[220:223], v1, s[16:19], s85 offen offset:2048 sc1
  buffer_load_dwordx4 v[224:227], v1, s[16:19], s85 offen offset:3072 sc1
  s_add_u32 s85, s85, 4096
  buffer_load_dwordx4 v[136:139], v1, s[16:19], s84 offen offset:0 sc1
  buffer_load_dwordx4 v[140:143], v1, s[16:19], s84 offen offset:1024 sc1
  buffer_load_dwordx4 v[144:147], v1, s[16:19], s84 offen offset:2048 sc1
  buffer_load_dwordx4 v[148:151], v1, s[16:19], s84 offen offset:3072 sc1
  s_add_u32 s84, s84, 4096
  buffer_load_dwordx4 v[152:155], v1, s[16:19], s84 offen sc1
  s_add_u32 s84, s84, 1024
  s_waitcnt vmcnt(23) lgkmcnt(0)
  v_mfma_f32_16x16x32_bf16 v[16:19], v[156:159], v[228:231], v[16:19]
  v_mfma_f32_16x16x32_bf16 v[20:23], v[156:159], v[232:235], v[20:23]
  v_mfma_f32_16x16x32_bf16 v[24:27], v[156:159], v[236:239], v[24:27]
  v_mfma_f32_16x16x32_bf16 v[28:31], v[156:159], v[240:243], v[28:31]
  v_mfma_f32_16x16x32_bf16 v[32:35], v[160:163], v[228:231], v[32:35]
  v_mfma_f32_16x16x32_bf16 v[36:39], v[160:163], v[232:235], v[36:39]
  v_mfma_f32_16x16x32_bf16 v[40:43], v[160:163], v[236:239], v[40:43]
  v_mfma_f32_16x16x32_bf16 v[44:47], v[160:163], v[240:243], v[44:47]
  v_mfma_f32_16x16x32_bf16 v[48:51], v[164:167], v[228:231], v[48:51]
  v_mfma_f32_16x16x32_bf16 v[52:55], v[164:167], v[232:235], v[52:55]
  v_mfma_f32_16x16x32_bf16 v[56:59], v[164:167], v[236:239], v[56:59]
  v_mfma_f32_16x16x32_bf16 v[60:63], v[164:167], v[240:243], v[60:63]
  v_mfma_f32_16x16x32_bf16 v[64:67], v[168:171], v[228:231], v[64:67]
  v_mfma_f32_16x16x32_bf16 v[68:71], v[168:171], v[232:235], v[68:71]
  v_mfma_f32_16x16x32_bf16 v[72:75], v[168:171], v[236:239], v[72:75]
  v_mfma_f32_16x16x32_bf16 v[76:79], v[168:171], v[240:243], v[76:79]
  v_mfma_f32_16x16x32_bf16 v[80:83], v[172:175], v[228:231], v[80:83]
  v_mfma_f32_16x16x32_bf16 v[84:87], v[172:175], v[232:235], v[84:87]
  v_mfma_f32_16x16x32_bf16 v[88:91], v[172:175], v[236:239], v[88:91]
  v_mfma_f32_16x16x32_bf16 v[92:95], v[172:175], v[240:243], v[92:95]
  buffer_load_dwordx4 v[228:231], v1, s[16:19], s85 offen offset:0 sc1
  buffer_load_dwordx4 v[232:235], v1, s[16:19], s85 offen offset:1024 sc1
  buffer_load_dwordx4 v[236:239], v1, s[16:19], s85 offen offset:2048 sc1
  buffer_load_dwordx4 v[240:243], v1, s[16:19], s85 offen offset:3072 sc1
  s_add_u32 s85, s85, 4096
  s_waitcnt vmcnt(18)
  v_mfma_f32_16x16x32_bf16 v[16:19], v[176:179], v[196:199], v[16:19]
  v_mfma_f32_16x16x32_bf16 v[20:23], v[176:179], v[200:203], v[20:23]
  v_mfma_f32_16x16x32_bf16 v[24:27], v[176:179], v[204:207], v[24:27]
  v_mfma_f32_16x16x32_bf16 v[28:31], v[176:179], v[208:211], v[28:31]
  v_mfma_f32_16x16x32_bf16 v[32:35], v[180:183], v[196:199], v[32:35]
  v_mfma_f32_16x16x32_bf16 v[36:39], v[180:183], v[200:203], v[36:39]
  v_mfma_f32_16x16x32_bf16 v[40:43], v[180:183], v[204:207], v[40:43]
  v_mfma_f32_16x16x32_bf16 v[44:47], v[180:183], v[208:211], v[44:47]
  v_mfma_f32_16x16x32_bf16 v[48:51], v[184:187], v[196:199], v[48:51]
  v_mfma_f32_16x16x32_bf16 v[52:55], v[184:187], v[200:203], v[52:55]
  v_mfma_f32_16x16x32_bf16 v[56:59], v[184:187], v[204:207], v[56:59]
  v_mfma_f32_16x16x32_bf16 v[60:63], v[184:187], v[208:211], v[60:63]
  v_mfma_f32_16x16x32_bf16 v[64:67], v[188:191], v[196:199], v[64:67]
  v_mfma_f32_16x16x32_bf16 v[68:71], v[188:191], v[200:203], v[68:71]
  v_mfma_f32_16x16x32_bf16 v[72:75], v[188:191], v[204:207], v[72:75]
  v_mfma_f32_16x16x32_bf16 v[76:79], v[188:191], v[208:211], v[76:79]
  v_mfma_f32_16x16x32_bf16 v[80:83], v[192:195], v[196:199], v[80:83]
  v_mfma_f32_16x16x32_bf16 v[84:87], v[192:195], v[200:203], v[84:87]
  v_mfma_f32_16x16x32_bf16 v[88:91], v[192:195], v[204:207], v[88:91]
  v_mfma_f32_16x16x32_bf16 v[92:95], v[192:195], v[208:211], v[92:95]
  buffer_load_dwordx4 v[196:199], v1, s[16:19], s85 offen offset:0 sc1
  buffer_load_dwordx4 v[200:203], v1, s[16:19], s85 offen offset:1024 sc1
  buffer_load_dwordx4 v[204:207], v1, s[16:19], s85 offen offset:2048 sc1
  buffer_load_dwordx4 v[208:211], v1, s[16:19], s85 offen offset:3072 sc1
  s_add_u32 s85, s85, 4096
  s_waitcnt vmcnt(13)
  v_mfma_f32_16x16x32_bf16 v[16:19], v[96:99], v[212:215], v[16:19]
  v_mfma_f32_16x16x32_bf16 v[20:23], v[96:99], v[216:219], v[20:23]
  v_mfma_f32_16x16x32_bf16 v[24:27], v[96:99], v[220:223], v[24:27]
  v_mfma_f32_16x16x32_bf16 v[28:31], v[96:99], v[224:227], v[28:31]
  v_mfma_f32_16x16x32_bf16 v[32:35], v[100:103], v[212:215], v[32:35]
  v_mfma_f32_16x16x32_bf16 v[36:39], v[100:103], v[216:219], v[36:39]
  v_mfma_f32_16x16x32_bf16 v[40:43], v[100:103], v[220:223], v[40:43]
  v_mfma_f32_16x16x32_bf16 v[44:47], v[100:103], v[224:227], v[44:47]
  v_mfma_f32_16x16x32_bf16 v[48:51], v[104:107], v[212:215], v[48:51]
  v_mfma_f32_16x16x32_bf16 v[52:55], v[104:107], v[216:219], v[52:55]
  v_mfma_f32_16x16x32_bf16 v[56:59], v[104:107], v[220:223], v[56:59]
  v_mfma_f32_16x16x32_bf16 v[60:63], v[104:107], v[224:227], v[60:63]
  v_mfma_f32_16x16x32_bf16 v[64:67], v[108:111], v[212:215], v[64:67]
  v_mfma_f32_16x16x32_bf16 v[68:71], v[108:111], v[216:219], v[68:71]
  v_mfma_f32_16x16x32_bf16 v[72:75], v[108:111], v[220:223], v[72:75]
  v_mfma_f32_16x16x32_bf16 v[76:79], v[108:111], v[224:227], v[76:79]
  v_mfma_f32_16x16x32_bf16 v[80:83], v[112:115], v[212:215], v[80:83]
  v_mfma_f32_16x16x32_bf16 v[84:87], v[112:115], v[216:219], v[84:87]
  v_mfma_f32_16x16x32_bf16 v[88:91], v[112:115], v[220:223], v[88:91]
  v_mfma_f32_16x16x32_bf16 v[92:95], v[112:115], v[224:227], v[92:95]
  s_waitcnt vmcnt(4)
  v_mfma_f32_16x16x32_bf16 v[16:19], v[116:119], v[228:231], v[16:19]
  v_mfma_f32_16x16x32_bf16 v[20:23], v[116:119], v[232:235], v[20:23]
  v_mfma_f32_16x16x32_bf16 v[24:27], v[116:119], v[236:239], v[24:27]
  v_mfma_f32_16x16x32_bf16 v[28:31], v[116:119], v[240:243], v[28:31]
  v_mfma_f32_16x16x32_bf16 v[32:35], v[120:123], v[228:231], v[32:35]
  v_mfma_f32_16x16x32_bf16 v[36:39], v[120:123], v[232:235], v[36:39]
  v_mfma_f32_16x16x32_bf16 v[40:43], v[120:123], v[236:239], v[40:43]
  v_mfma_f32_16x16x32_bf16 v[44:47], v[120:123], v[240:243], v[44:47]
  v_mfma_f32_16x16x32_bf16 v[48:51], v[124:127], v[228:231], v[48:51]
  v_mfma_f32_16x16x32_bf16 v[52:55], v[124:127], v[232:235], v[52:55]
  v_mfma_f32_16x16x32_bf16 v[56:59], v[124:127], v[236:239], v[56:59]
  v_mfma_f32_16x16x32_bf16 v[60:63], v[124:127], v[240:243], v[60:63]
  v_mfma_f32_16x16x32_bf16 v[64:67], v[128:131], v[228:231], v[64:67]
  v_mfma_f32_16x16x32_bf16 v[68:71], v[128:131], v[232:235], v[68:71]
  v_mfma_f32_16x16x32_bf16 v[72:75], v[128:131], v[236:239], v[72:75]
  v_mfma_f32_16x16x32_bf16 v[76:79], v[128:131], v[240:243], v[76:79]
  v_mfma_f32_16x16x32_bf16 v[80:83], v[132:135], v[228:231], v[80:83]
  v_mfma_f32_16x16x32_bf16 v[84:87], v[132:135], v[232:235], v[84:87]
  v_mfma_f32_16x16x32_bf16 v[88:91], v[132:135], v[236:239], v[88:91]
  v_mfma_f32_16x16x32_bf16 v[92:95], v[132:135], v[240:243], v[92:95]
  s_waitcnt vmcnt(0)
  v_mfma_f32_16x16x32_bf16 v[16:19], v[136:139], v[196:199], v[16:19]
  v_mfma_f32_16x16x32_bf16 v[20:23], v[136:139], v[200:203], v[20:23]
  v_mfma_f32_16x16x32_bf16 v[24:27], v[136:139], v[204:207], v[24:27]
  v_mfma_f32_16x16x32_bf16 v[28:31], v[136:139], v[208:211], v[28:31]
  v_mfma_f32_16x16x32_bf16 v[32:35], v[140:143], v[196:199], v[32:35]
  v_mfma_f32_16x16x32_bf16 v[36:39], v[140:143], v[200:203], v[36:39]
  v_mfma_f32_16x16x32_bf16 v[40:43], v[140:143], v[204:207], v[40:43]
  v_mfma_f32_16x16x32_bf16 v[44:47], v[140:143], v[208:211], v[44:47]
  v_mfma_f32_16x16x32_bf16 v[48:51], v[144:147], v[196:199], v[48:51]
  v_mfma_f32_16x16x32_bf16 v[52:55], v[144:147], v[200:203], v[52:55]
  v_mfma_f32_16x16x32_bf16 v[56:59], v[144:147], v[204:207], v[56:59]
  v_mfma_f32_16x16x32_bf16 v[60:63], v[144:147], v[208:211], v[60:63]
  v_mfma_f32_16x16x32_bf16 v[64:67], v[148:151], v[196:199], v[64:67]
  v_mfma_f32_16x16x32_bf16 v[68:71], v[148:151], v[200:203], v[68:71]
  v_mfma_f32_16x16x32_bf16 v[72:75], v[148:151], v[204:207], v[72:75]
  v_mfma_f32_16x16x32_bf16 v[76:79], v[148:151], v[208:211], v[76:79]
  v_mfma_f32_16x16x32_bf16 v[80:83], v[152:155], v[196:199], v[80:83]
  v_mfma_f32_16x16x32_bf16 v[84:87], v[152:155], v[200:203], v[84:87]
  v_mfma_f32_16x16x32_bf16 v[88:91], v[152:155], v[204:207], v[88:91]
  v_mfma_f32_16x16x32_bf16 v[92:95], v[152:155], v[208:211], v[92:95]
L_FFN_done:
  s_mul_i32 s80, s86, 20480
  v_add_u32 v2, s80, v1
  ds_write_b128 v2, v[16:19] offset:0
  ds_write_b128 v2, v[32:35] offset:1024
  ds_write_b128 v2, v[48:51] offset:2048
  ds_write_b128 v2, v[64:67] offset:3072
  ds_write_b128 v2, v[80:83] offset:4096
  ds_write_b128 v2, v[20:23] offset:5120
  ds_write_b128 v2, v[36:39] offset:6144
  ds_write_b128 v2, v[52:55] offset:7168
  ds_write_b128 v2, v[68:71] offset:8192
  ds_write_b128 v2, v[84:87] offset:9216
  ds_write_b128 v2, v[24:27] offset:10240
  ds_write_b128 v2, v[40:43] offset:11264
  ds_write_b128 v2, v[56:59] offset:12288
  ds_write_b128 v2, v[72:75] offset:13312
  ds_write_b128 v2, v[88:91] offset:14336
  ds_write_b128 v2, v[28:31] offset:15360
  ds_write_b128 v2, v[44:47] offset:16384
  ds_write_b128 v2, v[60:63] offset:17408
  ds_write_b128 v2, v[76:79] offset:18432
  ds_write_b128 v2, v[92:95] offset:19456
  s_waitcnt lgkmcnt(0)
  s_barrier
  s_branch L_END
L_SSM_P2:
  s_waitcnt vmcnt(12)
  s_mul_i32 s87, s72, 10
  s_add_u32 s87, s87, 54
  v_cmp_ne_u32 vcc, s78, v1
  v_lshlrev_b32 v1, 4, v0
  v_lshlrev_b32 v8, 2, v0
  s_and_b32 s80, vcc_lo, 0x3ff
  s_cbranch_scc0 L_SSM_wokP
  s_mov_b32 s80, 0
  s_mov_b32 s82, 1023
  s_mov_b32 s83, 0
L_poll_SWP:
  buffer_load_dword v10, v8, s[16:19], s35 offen sc1
  s_add_u32 s80, s80, 1
  s_waitcnt vmcnt(0)
  v_cmp_ne_u32 vcc, s78, v10
  s_cmp_ge_u32 s80, 2000000
  s_cbranch_scc1 L_poll_done_SWP
  s_and_b64 vcc, vcc, s[82:83]
  s_cbranch_scc0 L_poll_done_SWP
  s_sleep 1
  s_branch L_poll_SWP
L_poll_done_SWP:
L_SSM_wokP:
  s_mul_i32 s84, s77, 94
  s_add_u32 s84, s84, s87
  s_mul_i32 s84, s84, 5120
  s_add_u32 s84, s84, 12582912
  s_mul_i32 s85, s76, 94
  s_add_u32 s85, s85, s87
  s_lshl_b32 s85, s85, 12
  s_mul_i32 s88, s72, 15360
  s_add_u32 s88, s88, 81920
  v_add_u32 v3, s88, v1
  s_cmp_eq_u32 s79, 1
  s_cbranch_scc1 L_SSM_noordP
  v_mov_b32 v10, 152604
  s_mov_b32 s80, 0
L_lwg_OP:
  ds_read_b32 v11, v10
  s_add_u32 s80, s80, 1
  s_waitcnt lgkmcnt(0)
  v_readfirstlane_b32 s81, v11
  s_cmp_ge_u32 s80, 8000000
  s_cbranch_scc1 L_lwg_done_OP
  s_cmp_ge_u32 s81, 4
  s_cbranch_scc1 L_lwg_done_OP
  s_sleep 1
  s_branch L_lwg_OP
L_lwg_done_OP:
L_SSM_noordP:
  s_setprio 2
  buffer_load_dwordx4 v[96:99], v1, s[16:19], s84 offen offset:0 sc1
  buffer_load_dwordx4 v[100:103], v1, s[16:19], s84 offen offset:1024 sc1
  buffer_load_dwordx4 v[104:107], v1, s[16:19], s84 offen offset:2048 sc1
  buffer_load_dwordx4 v[108:111], v1, s[16:19], s84 offen offset:3072 sc1
  s_add_u32 s84, s84, 4096
  buffer_load_dwordx4 v[112:115], v1, s[16:19], s84 offen sc1
  s_add_u32 s84, s84, 1024
  buffer_load_dwordx4 v[116:119], v1, s[16:19], s84 offen offset:0 sc1
  buffer_load_dwordx4 v[120:123], v1, s[16:19], s84 offen offset:1024 sc1
  buffer_load_dwordx4 v[124:127], v1, s[16:19], s84 offen offset:2048 sc1
  buffer_load_dwordx4 v[128:131], v1, s[16:19], s84 offen offset:3072 sc1
  s_add_u32 s84, s84, 4096
  buffer_load_dwordx4 v[132:135], v1, s[16:19], s84 offen sc1
  s_add_u32 s84, s84, 1024
  buffer_load_dwordx4 v[136:139], v1, s[16:19], s84 offen offset:0 sc1
  buffer_load_dwordx4 v[140:143], v1, s[16:19], s84 offen offset:1024 sc1
  buffer_load_dwordx4 v[144:147], v1, s[16:19], s84 offen offset:2048 sc1
  buffer_load_dwordx4 v[148:151], v1, s[16:19], s84 offen offset:3072 sc1
  s_add_u32 s84, s84, 4096
  buffer_load_dwordx4 v[152:155], v1, s[16:19], s84 offen sc1
  s_add_u32 s84, s84, 1024
  buffer_load_dwordx4 v[156:159], v1, s[16:19], s84 offen offset:0 sc1
  buffer_load_dwordx4 v[160:163], v1, s[16:19], s84 offen offset:1024 sc1
  buffer_load_dwordx4 v[164:167], v1, s[16:19], s84 offen offset:2048 sc1
  buffer_load_dwordx4 v[168:171], v1, s[16:19], s84 offen offset:3072 sc1
  s_add_u32 s84, s84, 4096
  buffer_load_dwordx4 v[172:175], v1, s[16:19], s84 offen sc1
  s_add_u32 s84, s84, 1024
  buffer_load_dwordx4 v[176:179], v1, s[16:19], s84 offen offset:0 sc1
  buffer_load_dwordx4 v[180:183], v1, s[16:19], s84 offen offset:1024 sc1
  buffer_load_dwordx4 v[184:187], v1, s[16:19], s84 offen offset:2048 sc1
  buffer_load_dwordx4 v[188:191], v1, s[16:19], s84 offen offset:3072 sc1
  s_add_u32 s84, s84, 4096
  buffer_load_dwordx4 v[192:195], v1, s[16:19], s84 offen sc1
  s_add_u32 s84, s84, 1024
  s_cmp_eq_u32 s79, 1
  s_cbranch_scc1 L_SSM_skipldsP
  s_add_u32 m0, s88, 0
  s_nop 0
  buffer_load_dwordx4 v1, s[16:19], s84 offen sc1 lds
  s_add_u32 s84, s84, 1024
  s_add_u32 m0, s88, 1024
  s_nop 0
  buffer_load_dwordx4 v1, s[16:19], s84 offen sc1 lds
  s_add_u32 s84, s84, 1024
  s_add_u32 m0, s88, 2048
  s_nop 0
  buffer_load_dwordx4 v1, s[16:19], s84 offen sc1 lds
  s_add_u32 s84, s84, 1024
  s_add_u32 m0, s88, 3072
  s_nop 0
  buffer_load_dwordx4 v1, s[16:19], s84 offen sc1 lds
  s_add_u32 s84, s84, 1024
  s_add_u32 m0, s88, 4096
  s_nop 0
  buffer_load_dwordx4 v1, s[16:19], s84 offen sc1 lds
  s_add_u32 s84, s84, 1024
  s_add_u32 m0, s88, 5120
  s_nop 0
  buffer_load_dwordx4 v1, s[16:19], s84 offen sc1 lds
  s_add_u32 s84, s84, 1024
  s_add_u32 m0, s88, 6144
  s_nop 0
  buffer_load_dwordx4 v1, s[16:19], s84 offen sc1 lds
  s_add_u32 s84, s84, 1024
  s_add_u32 m0, s88, 7168
  s_nop 0
  buffer_load_dwordx4 v1, s[16:19], s84 offen sc1 lds
  s_add_u32 s84, s84, 1024
  s_add_u32 m0, s88, 8192
  s_nop 0
  buffer_load_dwordx4 v1, s[16:19], s84 offen sc1 lds
  s_add_u32 s84, s84, 1024
  s_add_u32 m0, s88, 9216
  s_nop 0
  buffer_load_dwordx4 v1, s[16:19], s84 offen sc1 lds
  s_add_u32 s84, s84, 1024
  s_add_u32 m0, s88, 10240
  s_nop 0
  buffer_load_dwordx4 v1, s[16:19], s84 offen sc1 lds
  s_add_u32 s84, s84, 1024
  s_add_u32 m0, s88, 11264
  s_nop 0
  buffer_load_dwordx4 v1, s[16:19], s84 offen sc1 lds
  s_add_u32 s84, s84, 1024
  s_add_u32 m0, s88, 12288
  s_nop 0
  buffer_load_dwordx4 v1, s[16:19], s84 offen sc1 lds
  s_add_u32 s84, s84, 1024
  s_add_u32 m0, s88, 13312
  s_nop 0
  buffer_load_dwordx4 v1, s[16:19], s84 offen sc1 lds
  s_add_u32 s84, s84, 1024
  s_add_u32 m0, s88, 14336
  s_nop 0
  buffer_load_dwordx4 v1, s[16:19], s84 offen sc1 lds
  s_add_u32 s84, s84, 1024
  s_branch L_SSM_ldsdoneP
L_SSM_skipldsP:
  s_add_u32 s84, s84, 15360
L_SSM_ldsdoneP:
L_SSM_P2b:
  s_lshr_b32 s80, s72, 1
  s_lshl_b32 s80, s80, 5
  s_and_b32 s81, s72, 1
  s_lshl_b32 s81, s81, 3
  s_add_u32 s80, s80, s81
  s_lshl_b32 s81, s76, 6
  s_add_u32 s80, s80, s81
  v_bfe_u32 v4, v0, 3, 1
  v_lshlrev_b32 v4, 4, v4
  v_and_b32 v5, 7, v0
  v_add_u32 v4, v4, v5
  v_add_u32 v4, s80, v4
  v_lshrrev_b32 v5, 4, v0
  v_lshlrev_b32 v6, 3, v5
  s_mul_i32 s81, s77, 160
  v_mul_u32_u24 v7, 1280, v4
  v_add_u32 v7, v7, v6
  v_lshlrev_b32 v8, 3, v4
  v_mul_u32_u24 v248, 2560, v4
  v_lshlrev_b32 v5, 4, v5
  v_add_u32 v248, v248, v5
  s_mov_b32 s20, s36
  s_mov_b32 s21, s37
  s_mov_b32 s22, 2621440
  s_mov_b32 s23, 0x20000
  buffer_load_dwordx2 v[196:197], v7, s[20:23], s81 offen offset:0
  buffer_load_dwordx2 v[198:199], v7, s[20:23], s81 offen offset:32
  buffer_load_dwordx2 v[200:201], v7, s[20:23], s81 offen offset:64
  buffer_load_dwordx2 v[202:203], v7, s[20:23], s81 offen offset:96
  buffer_load_dwordx2 v[204:205], v7, s[20:23], s81 offen offset:128
  s_mov_b32 s24, s52
  s_mov_b32 s25, s53
  s_mov_b32 s26, 1280
  s_mov_b32 s27, 0x20000
  buffer_load_dwordx2 v[206:207], v6, s[24:27], s81 offen offset:0
  buffer_load_dwordx2 v[208:209], v6, s[24:27], s81 offen offset:32
  buffer_load_dwordx2 v[210:211], v6, s[24:27], s81 offen offset:64
  buffer_load_dwordx2 v[212:213], v6, s[24:27], s81 offen offset:96
  buffer_load_dwordx2 v[214:215], v6, s[24:27], s81 offen offset:128
  s_mov_b32 s82, 16777216
  buffer_load_dwordx2 v[244:245], v8, s[16:19], s82 offen sc1
  v_mov_b32 v16, 0
  v_mov_b32 v17, 0
  v_mov_b32 v18, 0
  v_mov_b32 v19, 0
  v_mov_b32 v20, 0
  v_mov_b32 v21, 0
  v_mov_b32 v22, 0
  v_mov_b32 v23, 0
  v_mov_b32 v24, 0
  v_mov_b32 v25, 0
  v_mov_b32 v26, 0
  v_mov_b32 v27, 0
  v_mov_b32 v28, 0
  v_mov_b32 v29, 0
  v_mov_b32 v30, 0
  v_mov_b32 v31, 0
  v_mov_b32 v32, 0
  v_mov_b32 v33, 0
  v_mov_b32 v34, 0
  v_mov_b32 v35, 0
  v_mov_b32 v36, 0
  v_mov_b32 v37, 0
  v_mov_b32 v38, 0
  v_mov_b32 v39, 0
  v_mov_b32 v40, 0
  v_mov_b32 v41, 0
  v_mov_b32 v42, 0
  v_mov_b32 v43, 0
  v_mov_b32 v44, 0
  v_mov_b32 v45, 0
  v_mov_b32 v46, 0
  v_mov_b32 v47, 0
  v_mov_b32 v48, 0
  v_mov_b32 v49, 0
  v_mov_b32 v50, 0
  v_mov_b32 v51, 0
  v_mov_b32 v52, 0
  v_mov_b32 v53, 0
  v_mov_b32 v54, 0
  v_mov_b32 v55, 0
  v_mov_b32 v56, 0
  v_mov_b32 v57, 0
  v_mov_b32 v58, 0
  v_mov_b32 v59, 0
  v_mov_b32 v60, 0
  v_mov_b32 v61, 0
  v_mov_b32 v62, 0
  v_mov_b32 v63, 0
  v_mov_b32 v64, 0
  v_mov_b32 v65, 0
  v_mov_b32 v66, 0
  v_mov_b32 v67, 0
  v_mov_b32 v68, 0
  v_mov_b32 v69, 0
  v_mov_b32 v70, 0
  v_mov_b32 v71, 0
  v_mov_b32 v72, 0
  v_mov_b32 v73, 0
  v_mov_b32 v74, 0
  v_mov_b32 v75, 0
  v_mov_b32 v76, 0
  v_mov_b32 v77, 0
  v_mov_b32 v78, 0
  v_mov_b32 v79, 0
  v_mov_b32 v80, 0
  v_mov_b32 v81, 0
  v_mov_b32 v82, 0
  v_mov_b32 v83, 0
  v_mov_b32 v84, 0
  v_mov_b32 v85, 0
  v_mov_b32 v86, 0
  v_mov_b32 v87, 0
  v_mov_b32 v88, 0
  v_mov_b32 v89, 0
  v_mov_b32 v90, 0
  v_mov_b32 v91, 0
  v_mov_b32 v92, 0
  v_mov_b32 v93, 0
  v_mov_b32 v94, 0
  v_mov_b32 v95, 0
  s_waitcnt vmcnt(0)
  s_mov_b32 s80, 0
L_G_chk:
  v_cmp_ne_u32 vcc, s78, v245
  s_add_u32 s80, s80, 1
  s_cmp_ge_u32 s80, 2000000
  s_cbranch_scc1 L_G_ok
  s_cmp_eq_u64 vcc, 0
  s_cbranch_scc1 L_G_ok
  s_sleep 2
  buffer_load_dwordx2 v[244:245], v8, s[16:19], s82 offen sc1
  s_waitcnt vmcnt(0)
  s_branch L_G_chk
L_G_ok:
  v_sub_f32 v246, 1.0, v244
  v_cvt_pk_bf16_f32 v246, v246, v246
  v_and_b32 v246, 0xffff0000, v246
  v_lshlrev_b32 v10, 16, v196
  v_and_b32 v11, 0xffff0000, v196
  v_lshlrev_b32 v12, 16, v197
  v_and_b32 v13, 0xffff0000, v197
  v_lshlrev_b32 v216, 16, v206
  v_and_b32 v217, 0xffff0000, v206
  v_lshlrev_b32 v218, 16, v207
  v_and_b32 v219, 0xffff0000, v207
  v_mul_f32 v216, v216, v10
  v_mul_f32 v217, v217, v11
  v_mul_f32 v218, v218, v12
  v_mul_f32 v219, v219, v13
  v_lshlrev_b32 v10, 16, v198
  v_and_b32 v11, 0xffff0000, v198
  v_lshlrev_b32 v12, 16, v199
  v_and_b32 v13, 0xffff0000, v199
  v_lshlrev_b32 v220, 16, v208
  v_and_b32 v221, 0xffff0000, v208
  v_lshlrev_b32 v222, 16, v209
  v_and_b32 v223, 0xffff0000, v209
  v_mul_f32 v220, v220, v10
  v_mul_f32 v221, v221, v11
  v_mul_f32 v222, v222, v12
  v_mul_f32 v223, v223, v13
  v_lshlrev_b32 v10, 16, v200
  v_and_b32 v11, 0xffff0000, v200
  v_lshlrev_b32 v12, 16, v201
  v_and_b32 v13, 0xffff0000, v201
  v_lshlrev_b32 v224, 16, v210
  v_and_b32 v225, 0xffff0000, v210
  v_lshlrev_b32 v226, 16, v211
  v_and_b32 v227, 0xffff0000, v211
  v_mul_f32 v224, v224, v10
  v_mul_f32 v225, v225, v11
  v_mul_f32 v226, v226, v12
  v_mul_f32 v227, v227, v13
  v_lshlrev_b32 v10, 16, v202
  v_and_b32 v11, 0xffff0000, v202
  v_lshlrev_b32 v12, 16, v203
  v_and_b32 v13, 0xffff0000, v203
  v_lshlrev_b32 v228, 16, v212
  v_and_b32 v229, 0xffff0000, v212
  v_lshlrev_b32 v230, 16, v213
  v_and_b32 v231, 0xffff0000, v213
  v_mul_f32 v228, v228, v10
  v_mul_f32 v229, v229, v11
  v_mul_f32 v230, v230, v12
  v_mul_f32 v231, v231, v13
  v_lshlrev_b32 v10, 16, v204
  v_and_b32 v11, 0xffff0000, v204
  v_lshlrev_b32 v12, 16, v205
  v_and_b32 v13, 0xffff0000, v205
  v_lshlrev_b32 v232, 16, v214
  v_and_b32 v233, 0xffff0000, v214
  v_lshlrev_b32 v234, 16, v215
  v_and_b32 v235, 0xffff0000, v215
  v_mul_f32 v232, v232, v10
  v_mul_f32 v233, v233, v11
  v_mul_f32 v234, v234, v12
  v_mul_f32 v235, v235, v13
  s_cmp_eq_u32 s72, 0
  s_cbranch_scc0 L_PRE_0
  v_mov_b32 v16, v216
  v_mov_b32 v17, v217
  v_mov_b32 v18, v218
  v_mov_b32 v19, v219
  v_mov_b32 v32, v220
  v_mov_b32 v33, v221
  v_mov_b32 v34, v222
  v_mov_b32 v35, v223
  v_mov_b32 v48, v224
  v_mov_b32 v49, v225
  v_mov_b32 v50, v226
  v_mov_b32 v51, v227
  v_mov_b32 v64, v228
  v_mov_b32 v65, v229
  v_mov_b32 v66, v230
  v_mov_b32 v67, v231
  v_mov_b32 v80, v232
  v_mov_b32 v81, v233
  v_mov_b32 v82, v234
  v_mov_b32 v83, v235
L_PRE_0:
  s_cmp_eq_u32 s72, 1
  s_cbranch_scc0 L_PRE_1
  v_mov_b32 v20, v216
  v_mov_b32 v21, v217
  v_mov_b32 v22, v218
  v_mov_b32 v23, v219
  v_mov_b32 v36, v220
  v_mov_b32 v37, v221
  v_mov_b32 v38, v222
  v_mov_b32 v39, v223
  v_mov_b32 v52, v224
  v_mov_b32 v53, v225
  v_mov_b32 v54, v226
  v_mov_b32 v55, v227
  v_mov_b32 v68, v228
  v_mov_b32 v69, v229
  v_mov_b32 v70, v230
  v_mov_b32 v71, v231
  v_mov_b32 v84, v232
  v_mov_b32 v85, v233
  v_mov_b32 v86, v234
  v_mov_b32 v87, v235
L_PRE_1:
  s_cmp_eq_u32 s72, 2
  s_cbranch_scc0 L_PRE_2
  v_mov_b32 v24, v216
  v_mov_b32 v25, v217
  v_mov_b32 v26, v218
  v_mov_b32 v27, v219
  v_mov_b32 v40, v220
  v_mov_b32 v41, v221
  v_mov_b32 v42, v222
  v_mov_b32 v43, v223
  v_mov_b32 v56, v224
  v_mov_b32 v57, v225
  v_mov_b32 v58, v226
  v_mov_b32 v59, v227
  v_mov_b32 v72, v228
  v_mov_b32 v73, v229
  v_mov_b32 v74, v230
  v_mov_b32 v75, v231
  v_mov_b32 v88, v232
  v_mov_b32 v89, v233
  v_mov_b32 v90, v234
  v_mov_b32 v91, v235
L_PRE_2:
  s_cmp_eq_u32 s72, 3
  s_cbranch_scc0 L_PRE_3
  v_mov_b32 v28, v216
  v_mov_b32 v29, v217
  v_mov_b32 v30, v218
  v_mov_b32 v31, v219
  v_mov_b32 v44, v220
  v_mov_b32 v45, v221
  v_mov_b32 v46, v222
  v_mov_b32 v47, v223
  v_mov_b32 v60, v224
  v_mov_b32 v61, v225
  v_mov_b32 v62, v226
  v_mov_b32 v63, v227
  v_mov_b32 v76, v228
  v_mov_b32 v77, v229
  v_mov_b32 v78, v230
  v_mov_b32 v79, v231
  v_mov_b32 v92, v232
  v_mov_b32 v93, v233
  v_mov_b32 v94, v234
  v_mov_b32 v95, v235
L_PRE_3:
  s_cmp_eq_u32 s72, 0
  s_cbranch_scc0 L_SSM_lw
  s_lshl_b32 s89, s76, 8
  s_add_u32 s89, s89, 17105024
  s_mov_b32 s80, 0
L_sp_ST:
  s_load_dwordx8 s[40:47], s[70:71], s89 glc
  s_load_dwordx4 s[48:51], s[70:71], s89 offset:32 glc
  s_load_dwordx2 s[54:55], s[70:71], s89 offset:48 glc
  s_add_u32 s80, s80, 1
  s_waitcnt lgkmcnt(0)
  s_mov_b32 s81, 0
  s_xor_b32 s82, s40, s78
  s_or_b32 s81, s81, s82
  s_xor_b32 s82, s41, s78
  s_or_b32 s81, s81, s82
  s_xor_b32 s82, s42, s78
  s_or_b32 s81, s81, s82
  s_xor_b32 s82, s43, s78
  s_or_b32 s81, s81, s82
  s_xor_b32 s82, s44, s78
  s_or_b32 s81, s81, s82
  s_xor_b32 s82, s45, s78
  s_or_b32 s81, s81, s82
  s_xor_b32 s82, s46, s78
  s_or_b32 s81, s81, s82
  s_xor_b32 s82, s47, s78
  s_or_b32 s81, s81, s82
  s_xor_b32 s82, s48, s78
  s_or_b32 s81, s81, s82
  s_xor_b32 s82, s49, s78
  s_or_b32 s81, s81, s82
  s_xor_b32 s82, s50, s78
  s_or_b32 s81, s81, s82
  s_xor_b32 s82, s51, s78
  s_or_b32 s81, s81, s82
  s_xor_b32 s82, s54, s78
  s_or_b32 s81, s81, s82
  s_xor_b32 s82, s55, s78
  s_or_b32 s81, s81, s82
  s_cmp_ge_u32 s80, 2000000
  s_cbranch_scc1 L_sp_done_ST
  s_cmp_eq_u32 s81, 0
  s_cbranch_scc1 L_sp_done_ST
  s_sleep 1
  s_branch L_sp_ST
L_sp_done_ST:
  s_waitcnt vmcnt(0)
  v_mov_b32 v10, 152588
  v_mov_b32 v11, 1
  ds_write_b32 v10, v11
  s_branch L_SSM_go
L_SSM_lw:
  s_waitcnt vmcnt(0)
  v_mov_b32 v10, 152588
  s_mov_b32 s80, 0
L_lw_S:
  ds_read_b32 v11, v10
  s_add_u32 s80, s80, 1
  s_waitcnt lgkmcnt(0)
  v_readfirstlane_b32 s81, v11
  s_cmp_ge_u32 s80, 8000000
  s_cbranch_scc1 L_lw_done_S
  s_cmp_eq_u32 s81, 0
  s_cbranch_scc0 L_lw_done_S
  s_sleep 1
  s_branch L_lw_S
L_lw_done_S:
L_SSM_go:
  s_cmp_eq_u32 s79, 1
  s_cbranch_scc0 L_SSM_nohw
  v_mov_b32 v10, 152596
  s_mov_b32 s80, 0
L_lwg_H:
  ds_read_b32 v11, v10
  s_add_u32 s80, s80, 1
  s_waitcnt lgkmcnt(0)
  v_readfirstlane_b32 s81, v11
  s_cmp_ge_u32 s80, 8000000
  s_cbranch_scc1 L_lwg_done_H
  s_cmp_ge_u32 s81, 4
  s_cbranch_scc1 L_lwg_done_H
  s_sleep 1
  s_branch L_lwg_H
L_lwg_done_H:
L_SSM_nohw:
  buffer_load_dwordx4 v[196:199], v1, s[16:19], s85 offen offset:0 sc1
  buffer_load_dwordx4 v[200:203], v1, s[16:19], s85 offen offset:1024 sc1
  buffer_load_dwordx4 v[204:207], v1, s[16:19], s85 offen offset:2048 sc1
  buffer_load_dwordx4 v[208:211], v1, s[16:19], s85 offen offset:3072 sc1
  s_add_u32 s85, s85, 4096
  buffer_load_dwordx4 v[212:215], v1, s[16:19], s85 offen offset:0 sc1
  buffer_load_dwordx4 v[216:219], v1, s[16:19], s85 offen offset:1024 sc1
  buffer_load_dwordx4 v[220:223], v1, s[16:19], s85 offen offset:2048 sc1
  buffer_load_dwordx4 v[224:227], v1, s[16:19], s85 offen offset:3072 sc1
  s_add_u32 s85, s85, 4096
  buffer_load_dwordx4 v[228:231], v1, s[16:19], s85 offen offset:0 sc1
  buffer_load_dwordx4 v[232:235], v1, s[16:19], s85 offen offset:1024 sc1
  buffer_load_dwordx4 v[236:239], v1, s[16:19], s85 offen offset:2048 sc1
  buffer_load_dwordx4 v[240:243], v1, s[16:19], s85 offen offset:3072 sc1
  s_add_u32 s85, s85, 4096
  s_waitcnt vmcnt(8)
  v_mfma_f32_16x16x32_bf16 v[16:19], v[96:99], v[196:199], v[16:19]
  v_mfma_f32_16x16x32_bf16 v[20:23], v[96:99], v[200:203], v[20:23]
  v_mfma_f32_16x16x32_bf16 v[24:27], v[96:99], v[204:207], v[24:27]
  v_mfma_f32_16x16x32_bf16 v[28:31], v[96:99], v[208:211], v[28:31]
  v_mfma_f32_16x16x32_bf16 v[32:35], v[100:103], v[196:199], v[32:35]
  v_mfma_f32_16x16x32_bf16 v[36:39], v[100:103], v[200:203], v[36:39]
  v_mfma_f32_16x16x32_bf16 v[40:43], v[100:103], v[204:207], v[40:43]
  v_mfma_f32_16x16x32_bf16 v[44:47], v[100:103], v[208:211], v[44:47]
  v_mfma_f32_16x16x32_bf16 v[48:51], v[104:107], v[196:199], v[48:51]
  v_mfma_f32_16x16x32_bf16 v[52:55], v[104:107], v[200:203], v[52:55]
  v_mfma_f32_16x16x32_bf16 v[56:59], v[104:107], v[204:207], v[56:59]
  v_mfma_f32_16x16x32_bf16 v[60:63], v[104:107], v[208:211], v[60:63]
  v_mfma_f32_16x16x32_bf16 v[64:67], v[108:111], v[196:199], v[64:67]
  v_mfma_f32_16x16x32_bf16 v[68:71], v[108:111], v[200:203], v[68:71]
  v_mfma_f32_16x16x32_bf16 v[72:75], v[108:111], v[204:207], v[72:75]
  v_mfma_f32_16x16x32_bf16 v[76:79], v[108:111], v[208:211], v[76:79]
  v_mfma_f32_16x16x32_bf16 v[80:83], v[112:115], v[196:199], v[80:83]
  v_mfma_f32_16x16x32_bf16 v[84:87], v[112:115], v[200:203], v[84:87]
  v_mfma_f32_16x16x32_bf16 v[88:91], v[112:115], v[204:207], v[88:91]
  v_mfma_f32_16x16x32_bf16 v[92:95], v[112:115], v[208:211], v[92:95]
  buffer_load_dwordx4 v[196:199], v1, s[16:19], s85 offen offset:0 sc1
  buffer_load_dwordx4 v[200:203], v1, s[16:19], s85 offen offset:1024 sc1
  buffer_load_dwordx4 v[204:207], v1, s[16:19], s85 offen offset:2048 sc1
  buffer_load_dwordx4 v[208:211], v1, s[16:19], s85 offen offset:3072 sc1
  s_add_u32 s85, s85, 4096
  s_waitcnt vmcnt(8)
  v_mfma_f32_16x16x32_bf16 v[16:19], v[116:119], v[212:215], v[16:19]
  v_mfma_f32_16x16x32_bf16 v[20:23], v[116:119], v[216:219], v[20:23]
  v_mfma_f32_16x16x32_bf16 v[24:27], v[116:119], v[220:223], v[24:27]
  v_mfma_f32_16x16x32_bf16 v[28:31], v[116:119], v[224:227], v[28:31]
  v_mfma_f32_16x16x32_bf16 v[32:35], v[120:123], v[212:215], v[32:35]
  v_mfma_f32_16x16x32_bf16 v[36:39], v[120:123], v[216:219], v[36:39]
  v_mfma_f32_16x16x32_bf16 v[40:43], v[120:123], v[220:223], v[40:43]
  v_mfma_f32_16x16x32_bf16 v[44:47], v[120:123], v[224:227], v[44:47]
  v_mfma_f32_16x16x32_bf16 v[48:51], v[124:127], v[212:215], v[48:51]
  v_mfma_f32_16x16x32_bf16 v[52:55], v[124:127], v[216:219], v[52:55]
  v_mfma_f32_16x16x32_bf16 v[56:59], v[124:127], v[220:223], v[56:59]
  v_mfma_f32_16x16x32_bf16 v[60:63], v[124:127], v[224:227], v[60:63]
  v_mfma_f32_16x16x32_bf16 v[64:67], v[128:131], v[212:215], v[64:67]
  v_mfma_f32_16x16x32_bf16 v[68:71], v[128:131], v[216:219], v[68:71]
  v_mfma_f32_16x16x32_bf16 v[72:75], v[128:131], v[220:223], v[72:75]
  v_mfma_f32_16x16x32_bf16 v[76:79], v[128:131], v[224:227], v[76:79]
  v_mfma_f32_16x16x32_bf16 v[80:83], v[132:135], v[212:215], v[80:83]
  v_mfma_f32_16x16x32_bf16 v[84:87], v[132:135], v[216:219], v[84:87]
  v_mfma_f32_16x16x32_bf16 v[88:91], v[132:135], v[220:223], v[88:91]
  v_mfma_f32_16x16x32_bf16 v[92:95], v[132:135], v[224:227], v[92:95]
  buffer_load_dwordx4 v[212:215], v1, s[16:19], s85 offen offset:0 sc1
  buffer_load_dwordx4 v[216:219], v1, s[16:19], s85 offen offset:1024 sc1
  buffer_load_dwordx4 v[220:223], v1, s[16:19], s85 offen offset:2048 sc1
  buffer_load_dwordx4 v[224:227], v1, s[16:19], s85 offen offset:3072 sc1
  s_add_u32 s85, s85, 4096
  s_waitcnt vmcnt(8)
  v_mfma_f32_16x16x32_bf16 v[16:19], v[136:139], v[228:231], v[16:19]
  v_mfma_f32_16x16x32_bf16 v[20:23], v[136:139], v[232:235], v[20:23]
  v_mfma_f32_16x16x32_bf16 v[24:27], v[136:139], v[236:239], v[24:27]
  v_mfma_f32_16x16x32_bf16 v[28:31], v[136:139], v[240:243], v[28:31]
  v_mfma_f32_16x16x32_bf16 v[32:35], v[140:143], v[228:231], v[32:35]
  v_mfma_f32_16x16x32_bf16 v[36:39], v[140:143], v[232:235], v[36:39]
  v_mfma_f32_16x16x32_bf16 v[40:43], v[140:143], v[236:239], v[40:43]
  v_mfma_f32_16x16x32_bf16 v[44:47], v[140:143], v[240:243], v[44:47]
  v_mfma_f32_16x16x32_bf16 v[48:51], v[144:147], v[228:231], v[48:51]
  v_mfma_f32_16x16x32_bf16 v[52:55], v[144:147], v[232:235], v[52:55]
  v_mfma_f32_16x16x32_bf16 v[56:59], v[144:147], v[236:239], v[56:59]
  v_mfma_f32_16x16x32_bf16 v[60:63], v[144:147], v[240:243], v[60:63]
  v_mfma_f32_16x16x32_bf16 v[64:67], v[148:151], v[228:231], v[64:67]
  v_mfma_f32_16x16x32_bf16 v[68:71], v[148:151], v[232:235], v[68:71]
  v_mfma_f32_16x16x32_bf16 v[72:75], v[148:151], v[236:239], v[72:75]
  v_mfma_f32_16x16x32_bf16 v[76:79], v[148:151], v[240:243], v[76:79]
  v_mfma_f32_16x16x32_bf16 v[80:83], v[152:155], v[228:231], v[80:83]
  v_mfma_f32_16x16x32_bf16 v[84:87], v[152:155], v[232:235], v[84:87]
  v_mfma_f32_16x16x32_bf16 v[88:91], v[152:155], v[236:239], v[88:91]
  v_mfma_f32_16x16x32_bf16 v[92:95], v[152:155], v[240:243], v[92:95]
  buffer_load_dwordx4 v[228:231], v1, s[16:19], s85 offen offset:0 sc1
  buffer_load_dwordx4 v[232:235], v1, s[16:19], s85 offen offset:1024 sc1
  buffer_load_dwordx4 v[236:239], v1, s[16:19], s85 offen offset:2048 sc1
  buffer_load_dwordx4 v[240:243], v1, s[16:19], s85 offen offset:3072 sc1
  s_add_u32 s85, s85, 4096
  s_waitcnt vmcnt(8)
  v_mfma_f32_16x16x32_bf16 v[16:19], v[156:159], v[196:199], v[16:19]
  v_mfma_f32_16x16x32_bf16 v[20:23], v[156:159], v[200:203], v[20:23]
  v_mfma_f32_16x16x32_bf16 v[24:27], v[156:159], v[204:207], v[24:27]
  v_mfma_f32_16x16x32_bf16 v[28:31], v[156:159], v[208:211], v[28:31]
  v_mfma_f32_16x16x32_bf16 v[32:35], v[160:163], v[196:199], v[32:35]
  v_mfma_f32_16x16x32_bf16 v[36:39], v[160:163], v[200:203], v[36:39]
  v_mfma_f32_16x16x32_bf16 v[40:43], v[160:163], v[204:207], v[40:43]
  v_mfma_f32_16x16x32_bf16 v[44:47], v[160:163], v[208:211], v[44:47]
  v_mfma_f32_16x16x32_bf16 v[48:51], v[164:167], v[196:199], v[48:51]
  v_mfma_f32_16x16x32_bf16 v[52:55], v[164:167], v[200:203], v[52:55]
  v_mfma_f32_16x16x32_bf16 v[56:59], v[164:167], v[204:207], v[56:59]
  v_mfma_f32_16x16x32_bf16 v[60:63], v[164:167], v[208:211], v[60:63]
  v_mfma_f32_16x16x32_bf16 v[64:67], v[168:171], v[196:199], v[64:67]
  v_mfma_f32_16x16x32_bf16 v[68:71], v[168:171], v[200:203], v[68:71]
  v_mfma_f32_16x16x32_bf16 v[72:75], v[168:171], v[204:207], v[72:75]
  v_mfma_f32_16x16x32_bf16 v[76:79], v[168:171], v[208:211], v[76:79]
  v_mfma_f32_16x16x32_bf16 v[80:83], v[172:175], v[196:199], v[80:83]
  v_mfma_f32_16x16x32_bf16 v[84:87], v[172:175], v[200:203], v[84:87]
  v_mfma_f32_16x16x32_bf16 v[88:91], v[172:175], v[204:207], v[88:91]
  v_mfma_f32_16x16x32_bf16 v[92:95], v[172:175], v[208:211], v[92:95]
  buffer_load_dwordx4 v[196:199], v1, s[16:19], s85 offen offset:0 sc1
  buffer_load_dwordx4 v[200:203], v1, s[16:19], s85 offen offset:1024 sc1
  buffer_load_dwordx4 v[204:207], v1, s[16:19], s85 offen offset:2048 sc1
  buffer_load_dwordx4 v[208:211], v1, s[16:19], s85 offen offset:3072 sc1
  s_add_u32 s85, s85, 4096
  buffer_load_dwordx4 v[156:159], v1, s[16:19], s84 offen offset:0 sc1
  buffer_load_dwordx4 v[160:163], v1, s[16:19], s84 offen offset:1024 sc1
  buffer_load_dwordx4 v[164:167], v1, s[16:19], s84 offen offset:2048 sc1
  buffer_load_dwordx4 v[168:171], v1, s[16:19], s84 offen offset:3072 sc1
  s_add_u32 s84, s84, 4096
  buffer_load_dwordx4 v[172:175], v1, s[16:19], s84 offen sc1
  s_add_u32 s84, s84, 1024
  ds_read_b128 v[96:99], v3 offset:0
  ds_read_b128 v[100:103], v3 offset:1024
  ds_read_b128 v[104:107], v3 offset:2048
  ds_read_b128 v[108:111], v3 offset:3072
  ds_read_b128 v[112:115], v3 offset:4096
  s_waitcnt vmcnt(13)
  v_mfma_f32_16x16x32_bf16 v[16:19], v[176:179], v[212:215], v[16:19]
  v_mfma_f32_16x16x32_bf16 v[20:23], v[176:179], v[216:219], v[20:23]
  v_mfma_f32_16x16x32_bf16 v[24:27], v[176:179], v[220:223], v[24:27]
  v_mfma_f32_16x16x32_bf16 v[28:31], v[176:179], v[224:227], v[28:31]
  v_mfma_f32_16x16x32_bf16 v[32:35], v[180:183], v[212:215], v[32:35]
  v_mfma_f32_16x16x32_bf16 v[36:39], v[180:183], v[216:219], v[36:39]
  v_mfma_f32_16x16x32_bf16 v[40:43], v[180:183], v[220:223], v[40:43]
  v_mfma_f32_16x16x32_bf16 v[44:47], v[180:183], v[224:227], v[44:47]
  v_mfma_f32_16x16x32_bf16 v[48:51], v[184:187], v[212:215], v[48:51]
  v_mfma_f32_16x16x32_bf16 v[52:55], v[184:187], v[216:219], v[52:55]
  v_mfma_f32_16x16x32_bf16 v[56:59], v[184:187], v[220:223], v[56:59]
  v_mfma_f32_16x16x32_bf16 v[60:63], v[184:187], v[224:227], v[60:63]
  v_mfma_f32_16x16x32_bf16 v[64:67], v[188:191], v[212:215], v[64:67]
  v_mfma_f32_16x16x32_bf16 v[68:71], v[188:191], v[216:219], v[68:71]
  v_mfma_f32_16x16x32_bf16 v[72:75], v[188:191], v[220:223], v[72:75]
  v_mfma_f32_16x16x32_bf16 v[76:79], v[188:191], v[224:227], v[76:79]
  v_mfma_f32_16x16x32_bf16 v[80:83], v[192:195], v[212:215], v[80:83]
  v_mfma_f32_16x16x32_bf16 v[84:87], v[192:195], v[216:219], v[84:87]
  v_mfma_f32_16x16x32_bf16 v[88:91], v[192:195], v[220:223], v[88:91]
  v_mfma_f32_16x16x32_bf16 v[92:95], v[192:195], v[224:227], v[92:95]
  buffer_load_dwordx4 v[212:215], v1, s[16:19], s85 offen offset:0 sc1
  buffer_load_dwordx4 v[216:219], v1, s[16:19], s85 offen offset:1024 sc1
  buffer_load_dwordx4 v[220:223], v1, s[16:19], s85 offen offset:2048 sc1
  buffer_load_dwordx4 v[224:227], v1, s[16:19], s85 offen offset:3072 sc1
  s_add_u32 s85, s85, 4096
  buffer_load_dwordx4 v[176:179], v1, s[16:19], s84 offen offset:0 sc1
  buffer_load_dwordx4 v[180:183], v1, s[16:19], s84 offen offset:1024 sc1
  buffer_load_dwordx4 v[184:187], v1, s[16:19], s84 offen offset:2048 sc1
  buffer_load_dwordx4 v[188:191], v1, s[16:19], s84 offen offset:3072 sc1
  s_add_u32 s84, s84, 4096
  buffer_load_dwordx4 v[192:195], v1, s[16:19], s84 offen sc1
  s_add_u32 s84, s84, 1024
  ds_read_b128 v[116:119], v3 offset:5120
  ds_read_b128 v[120:123], v3 offset:6144
  ds_read_b128 v[124:127], v3 offset:7168
  ds_read_b128 v[128:131], v3 offset:8192
  ds_read_b128 v[132:135], v3 offset:9216
  s_waitcnt vmcnt(18) lgkmcnt(0)
  v_mfma_f32_16x16x32_bf16 v[16:19], v[96:99], v[228:231], v[16:19]
  v_mfma_f32_16x16x32_bf16 v[20:23], v[96:99], v[232:235], v[20:23]
  v_mfma_f32_16x16x32_bf16 v[24:27], v[96:99], v[236:239], v[24:27]
  v_mfma_f32_16x16x32_bf16 v[28:31], v[96:99], v[240:243], v[28:31]
  v_mfma_f32_16x16x32_bf16 v[32:35], v[100:103], v[228:231], v[32:35]
  v_mfma_f32_16x16x32_bf16 v[36:39], v[100:103], v[232:235], v[36:39]
  v_mfma_f32_16x16x32_bf16 v[40:43], v[100:103], v[236:239], v[40:43]
  v_mfma_f32_16x16x32_bf16 v[44:47], v[100:103], v[240:243], v[44:47]
  v_mfma_f32_16x16x32_bf16 v[48:51], v[104:107], v[228:231], v[48:51]
  v_mfma_f32_16x16x32_bf16 v[52:55], v[104:107], v[232:235], v[52:55]
  v_mfma_f32_16x16x32_bf16 v[56:59], v[104:107], v[236:239], v[56:59]
  v_mfma_f32_16x16x32_bf16 v[60:63], v[104:107], v[240:243], v[60:63]
  v_mfma_f32_16x16x32_bf16 v[64:67], v[108:111], v[228:231], v[64:67]
  v_mfma_f32_16x16x32_bf16 v[68:71], v[108:111], v[232:235], v[68:71]
  v_mfma_f32_16x16x32_bf16 v[72:75], v[108:111], v[236:239], v[72:75]
  v_mfma_f32_16x16x32_bf16 v[76:79], v[108:111], v[240:243], v[76:79]
  v_mfma_f32_16x16x32_bf16 v[80:83], v[112:115], v[228:231], v[80:83]
  v_mfma_f32_16x16x32_bf16 v[84:87], v[112:115], v[232:235], v[84:87]
  v_mfma_f32_16x16x32_bf16 v[88:91], v[112:115], v[236:239], v[88:91]
  v_mfma_f32_16x16x32_bf16 v[92:95], v[112:115], v[240:243], v[92:95]
  buffer_load_dwordx4 v[228:231], v1, s[16:19], s85 offen offset:0 sc1
  buffer_load_dwordx4 v[232:235], v1, s[16:19], s85 offen offset:1024 sc1
  buffer_load_dwordx4 v[236:239], v1, s[16:19], s85 offen offset:2048 sc1
  buffer_load_dwordx4 v[240:243], v1, s[16:19], s85 offen offset:3072 sc1
  s_add_u32 s85, s85, 4096
  ds_read_b128 v[136:139], v3 offset:10240
  ds_read_b128 v[140:143], v3 offset:11264
  ds_read_b128 v[144:147], v3 offset:12288
  ds_read_b128 v[148:151], v3 offset:13312
  ds_read_b128 v[152:155], v3 offset:14336
  s_waitcnt vmcnt(18) lgkmcnt(0)
  v_mfma_f32_16x16x32_bf16 v[16:19], v[116:119], v[196:199], v[16:19]
  v_mfma_f32_16x16x32_bf16 v[20:23], v[116:119], v[200:203], v[20:23]
  v_mfma_f32_16x16x32_bf16 v[24:27], v[116:119], v[204:207], v[24:27]
  v_mfma_f32_16x16x32_bf16 v[28:31], v[116:119], v[208:211], v[28:31]
  v_mfma_f32_16x16x32_bf16 v[32:35], v[120:123], v[196:199], v[32:35]
  v_mfma_f32_16x16x32_bf16 v[36:39], v[120:123], v[200:203], v[36:39]
  v_mfma_f32_16x16x32_bf16 v[40:43], v[120:123], v[204:207], v[40:43]
  v_mfma_f32_16x16x32_bf16 v[44:47], v[120:123], v[208:211], v[44:47]
  v_mfma_f32_16x16x32_bf16 v[48:51], v[124:127], v[196:199], v[48:51]
  v_mfma_f32_16x16x32_bf16 v[52:55], v[124:127], v[200:203], v[52:55]
  v_mfma_f32_16x16x32_bf16 v[56:59], v[124:127], v[204:207], v[56:59]
  v_mfma_f32_16x16x32_bf16 v[60:63], v[124:127], v[208:211], v[60:63]
  v_mfma_f32_16x16x32_bf16 v[64:67], v[128:131], v[196:199], v[64:67]
  v_mfma_f32_16x16x32_bf16 v[68:71], v[128:131], v[200:203], v[68:71]
  v_mfma_f32_16x16x32_bf16 v[72:75], v[128:131], v[204:207], v[72:75]
  v_mfma_f32_16x16x32_bf16 v[76:79], v[128:131], v[208:211], v[76:79]
  v_mfma_f32_16x16x32_bf16 v[80:83], v[132:135], v[196:199], v[80:83]
  v_mfma_f32_16x16x32_bf16 v[84:87], v[132:135], v[200:203], v[84:87]
  v_mfma_f32_16x16x32_bf16 v[88:91], v[132:135], v[204:207], v[88:91]
  v_mfma_f32_16x16x32_bf16 v[92:95], v[132:135], v[208:211], v[92:95]
  buffer_load_dwordx4 v[196:199], v1, s[16:19], s85 offen offset:0 sc1
  buffer_load_dwordx4 v[200:203], v1, s[16:19], s85 offen offset:1024 sc1
  buffer_load_dwordx4 v[204:207], v1, s[16:19], s85 offen offset:2048 sc1
  buffer_load_dwordx4 v[208:211], v1, s[16:19], s85 offen offset:3072 sc1
  s_add_u32 s85, s85, 4096
  s_waitcnt vmcnt(13) lgkmcnt(0)
  v_mfma_f32_16x16x32_bf16 v[16:19], v[136:139], v[212:215], v[16:19]
  v_mfma_f32_16x16x32_bf16 v[20:23], v[136:139], v[216:219], v[20:23]
  v_mfma_f32_16x16x32_bf16 v[24:27], v[136:139], v[220:223], v[24:27]
  v_mfma_f32_16x16x32_bf16 v[28:31], v[136:139], v[224:227], v[28:31]
  v_mfma_f32_16x16x32_bf16 v[32:35], v[140:143], v[212:215], v[32:35]
  v_mfma_f32_16x16x32_bf16 v[36:39], v[140:143], v[216:219], v[36:39]
  v_mfma_f32_16x16x32_bf16 v[40:43], v[140:143], v[220:223], v[40:43]
  v_mfma_f32_16x16x32_bf16 v[44:47], v[140:143], v[224:227], v[44:47]
  v_mfma_f32_16x16x32_bf16 v[48:51], v[144:147], v[212:215], v[48:51]
  v_mfma_f32_16x16x32_bf16 v[52:55], v[144:147], v[216:219], v[52:55]
  v_mfma_f32_16x16x32_bf16 v[56:59], v[144:147], v[220:223], v[56:59]
  v_mfma_f32_16x16x32_bf16 v[60:63], v[144:147], v[224:227], v[60:63]
  v_mfma_f32_16x16x32_bf16 v[64:67], v[148:151], v[212:215], v[64:67]
  v_mfma_f32_16x16x32_bf16 v[68:71], v[148:151], v[216:219], v[68:71]
  v_mfma_f32_16x16x32_bf16 v[72:75], v[148:151], v[220:223], v[72:75]
  v_mfma_f32_16x16x32_bf16 v[76:79], v[148:151], v[224:227], v[76:79]
  v_mfma_f32_16x16x32_bf16 v[80:83], v[152:155], v[212:215], v[80:83]
  v_mfma_f32_16x16x32_bf16 v[84:87], v[152:155], v[216:219], v[84:87]
  v_mfma_f32_16x16x32_bf16 v[88:91], v[152:155], v[220:223], v[88:91]
  v_mfma_f32_16x16x32_bf16 v[92:95], v[152:155], v[224:227], v[92:95]
  s_waitcnt vmcnt(4)
  v_mfma_f32_16x16x32_bf16 v[16:19], v[156:159], v[228:231], v[16:19]
  v_mfma_f32_16x16x32_bf16 v[20:23], v[156:159], v[232:235], v[20:23]
  v_mfma_f32_16x16x32_bf16 v[24:27], v[156:159], v[236:239], v[24:27]
  v_mfma_f32_16x16x32_bf16 v[28:31], v[156:159], v[240:243], v[28:31]
  v_mfma_f32_16x16x32_bf16 v[32:35], v[160:163], v[228:231], v[32:35]
  v_mfma_f32_16x16x32_bf16 v[36:39], v[160:163], v[232:235], v[36:39]
  v_mfma_f32_16x16x32_bf16 v[40:43], v[160:163], v[236:239], v[40:43]
  v_mfma_f32_16x16x32_bf16 v[44:47], v[160:163], v[240:243], v[44:47]
  v_mfma_f32_16x16x32_bf16 v[48:51], v[164:167], v[228:231], v[48:51]
  v_mfma_f32_16x16x32_bf16 v[52:55], v[164:167], v[232:235], v[52:55]
  v_mfma_f32_16x16x32_bf16 v[56:59], v[164:167], v[236:239], v[56:59]
  v_mfma_f32_16x16x32_bf16 v[60:63], v[164:167], v[240:243], v[60:63]
  v_mfma_f32_16x16x32_bf16 v[64:67], v[168:171], v[228:231], v[64:67]
  v_mfma_f32_16x16x32_bf16 v[68:71], v[168:171], v[232:235], v[68:71]
  v_mfma_f32_16x16x32_bf16 v[72:75], v[168:171], v[236:239], v[72:75]
  v_mfma_f32_16x16x32_bf16 v[76:79], v[168:171], v[240:243], v[76:79]
  v_mfma_f32_16x16x32_bf16 v[80:83], v[172:175], v[228:231], v[80:83]
  v_mfma_f32_16x16x32_bf16 v[84:87], v[172:175], v[232:235], v[84:87]
  v_mfma_f32_16x16x32_bf16 v[88:91], v[172:175], v[236:239], v[88:91]
  v_mfma_f32_16x16x32_bf16 v[92:95], v[172:175], v[240:243], v[92:95]
  s_waitcnt vmcnt(0)
  v_mfma_f32_16x16x32_bf16 v[16:19], v[176:179], v[196:199], v[16:19]
  v_mfma_f32_16x16x32_bf16 v[20:23], v[176:179], v[200:203], v[20:23]
  v_mfma_f32_16x16x32_bf16 v[24:27], v[176:179], v[204:207], v[24:27]
  v_mfma_f32_16x16x32_bf16 v[28:31], v[176:179], v[208:211], v[28:31]
  v_mfma_f32_16x16x32_bf16 v[32:35], v[180:183], v[196:199], v[32:35]
  v_mfma_f32_16x16x32_bf16 v[36:39], v[180:183], v[200:203], v[36:39]
  v_mfma_f32_16x16x32_bf16 v[40:43], v[180:183], v[204:207], v[40:43]
  v_mfma_f32_16x16x32_bf16 v[44:47], v[180:183], v[208:211], v[44:47]
  v_mfma_f32_16x16x32_bf16 v[48:51], v[184:187], v[196:199], v[48:51]
  v_mfma_f32_16x16x32_bf16 v[52:55], v[184:187], v[200:203], v[52:55]
  v_mfma_f32_16x16x32_bf16 v[56:59], v[184:187], v[204:207], v[56:59]
  v_mfma_f32_16x16x32_bf16 v[60:63], v[184:187], v[208:211], v[60:63]
  v_mfma_f32_16x16x32_bf16 v[64:67], v[188:191], v[196:199], v[64:67]
  v_mfma_f32_16x16x32_bf16 v[68:71], v[188:191], v[200:203], v[68:71]
  v_mfma_f32_16x16x32_bf16 v[72:75], v[188:191], v[204:207], v[72:75]
  v_mfma_f32_16x16x32_bf16 v[76:79], v[188:191], v[208:211], v[76:79]
  v_mfma_f32_16x16x32_bf16 v[80:83], v[192:195], v[196:199], v[80:83]
  v_mfma_f32_16x16x32_bf16 v[84:87], v[192:195], v[200:203], v[84:87]
  v_mfma_f32_16x16x32_bf16 v[88:91], v[192:195], v[204:207], v[88:91]
  v_mfma_f32_16x16x32_bf16 v[92:95], v[192:195], v[208:211], v[92:95]
  s_mul_i32 s83, s72, 15360
  s_add_u32 s83, s83, 81920
  v_add_u32 v7, s83, v1
  s_cmp_eq_u32 s72, 0
  s_cbranch_scc0 L_YW_0
  ds_write_b128 v7, v[20:23] offset:0
  ds_write_b128 v7, v[36:39] offset:1024
  ds_write_b128 v7, v[52:55] offset:2048
  ds_write_b128 v7, v[68:71] offset:3072
  ds_write_b128 v7, v[84:87] offset:4096
  ds_write_b128 v7, v[24:27] offset:5120
  ds_write_b128 v7, v[40:43] offset:6144
  ds_write_b128 v7, v[56:59] offset:7168
  ds_write_b128 v7, v[72:75] offset:8192
  ds_write_b128 v7, v[88:91] offset:9216
  ds_write_b128 v7, v[28:31] offset:10240
  ds_write_b128 v7, v[44:47] offset:11264
  ds_write_b128 v7, v[60:63] offset:12288
  ds_write_b128 v7, v[76:79] offset:13312
  ds_write_b128 v7, v[92:95] offset:14336
  v_mov_b32 v130, v16
  v_mov_b32 v131, v17
  v_mov_b32 v132, v18
  v_mov_b32 v133, v19
  v_mov_b32 v134, v32
  v_mov_b32 v135, v33
  v_mov_b32 v136, v34
  v_mov_b32 v137, v35
  v_mov_b32 v138, v48
  v_mov_b32 v139, v49
  v_mov_b32 v140, v50
  v_mov_b32 v141, v51
  v_mov_b32 v142, v64
  v_mov_b32 v143, v65
  v_mov_b32 v144, v66
  v_mov_b32 v145, v67
  v_mov_b32 v146, v80
  v_mov_b32 v147, v81
  v_mov_b32 v148, v82
  v_mov_b32 v149, v83
  s_branch L_YW_done
L_YW_0:
  s_cmp_eq_u32 s72, 1
  s_cbranch_scc0 L_YW_1
  ds_write_b128 v7, v[16:19] offset:0
  ds_write_b128 v7, v[32:35] offset:1024
  ds_write_b128 v7, v[48:51] offset:2048
  ds_write_b128 v7, v[64:67] offset:3072
  ds_write_b128 v7, v[80:83] offset:4096
  ds_write_b128 v7, v[24:27] offset:5120
  ds_write_b128 v7, v[40:43] offset:6144
  ds_write_b128 v7, v[56:59] offset:7168
  ds_write_b128 v7, v[72:75] offset:8192
  ds_write_b128 v7, v[88:91] offset:9216
  ds_write_b128 v7, v[28:31] offset:10240
  ds_write_b128 v7, v[44:47] offset:11264
  ds_write_b128 v7, v[60:63] offset:12288
  ds_write_b128 v7, v[76:79] offset:13312
  ds_write_b128 v7, v[92:95] offset:14336
  v_mov_b32 v130, v20
  v_mov_b32 v131, v21
  v_mov_b32 v132, v22
  v_mov_b32 v133, v23
  v_mov_b32 v134, v36
  v_mov_b32 v135, v37
  v_mov_b32 v136, v38
  v_mov_b32 v137, v39
  v_mov_b32 v138, v52
  v_mov_b32 v139, v53
  v_mov_b32 v140, v54
  v_mov_b32 v141, v55
  v_mov_b32 v142, v68
  v_mov_b32 v143, v69
  v_mov_b32 v144, v70
  v_mov_b32 v145, v71
  v_mov_b32 v146, v84
  v_mov_b32 v147, v85
  v_mov_b32 v148, v86
  v_mov_b32 v149, v87
  s_branch L_YW_done
L_YW_1:
  s_cmp_eq_u32 s72, 2
  s_cbranch_scc0 L_YW_2
  ds_write_b128 v7, v[16:19] offset:0
  ds_write_b128 v7, v[32:35] offset:1024
  ds_write_b128 v7, v[48:51] offset:2048
  ds_write_b128 v7, v[64:67] offset:3072
  ds_write_b128 v7, v[80:83] offset:4096
  ds_write_b128 v7, v[20:23] offset:5120
  ds_write_b128 v7, v[36:39] offset:6144
  ds_write_b128 v7, v[52:55] offset:7168
  ds_write_b128 v7, v[68:71] offset:8192
  ds_write_b128 v7, v[84:87] offset:9216
  ds_write_b128 v7, v[28:31] offset:10240
  ds_write_b128 v7, v[44:47] offset:11264
  ds_write_b128 v7, v[60:63] offset:12288
  ds_write_b128 v7, v[76:79] offset:13312
  ds_write_b128 v7, v[92:95] offset:14336
  v_mov_b32 v130, v24
  v_mov_b32 v131, v25
  v_mov_b32 v132, v26
  v_mov_b32 v133, v27
  v_mov_b32 v134, v40
  v_mov_b32 v135, v41
  v_mov_b32 v136, v42
  v_mov_b32 v137, v43
  v_mov_b32 v138, v56
  v_mov_b32 v139, v57
  v_mov_b32 v140, v58
  v_mov_b32 v141, v59
  v_mov_b32 v142, v72
  v_mov_b32 v143, v73
  v_mov_b32 v144, v74
  v_mov_b32 v145, v75
  v_mov_b32 v146, v88
  v_mov_b32 v147, v89
  v_mov_b32 v148, v90
  v_mov_b32 v149, v91
  s_branch L_YW_done
L_YW_2:
  s_cmp_eq_u32 s72, 3
  s_cbranch_scc0 L_YW_3
  ds_write_b128 v7, v[16:19] offset:0
  ds_write_b128 v7, v[32:35] offset:1024
  ds_write_b128 v7, v[48:51] offset:2048
  ds_write_b128 v7, v[64:67] offset:3072
  ds_write_b128 v7, v[80:83] offset:4096
  ds_write_b128 v7, v[20:23] offset:5120
  ds_write_b128 v7, v[36:39] offset:6144
  ds_write_b128 v7, v[52:55] offset:7168
  ds_write_b128 v7, v[68:71] offset:8192
  ds_write_b128 v7, v[84:87] offset:9216
  ds_write_b128 v7, v[24:27] offset:10240
  ds_write_b128 v7, v[40:43] offset:11264
  ds_write_b128 v7, v[56:59] offset:12288
  ds_write_b128 v7, v[72:75] offset:13312
  ds_write_b128 v7, v[88:91] offset:14336
  v_mov_b32 v130, v28
  v_mov_b32 v131, v29
  v_mov_b32 v132, v30
  v_mov_b32 v133, v31
  v_mov_b32 v134, v44
  v_mov_b32 v135, v45
  v_mov_b32 v136, v46
  v_mov_b32 v137, v47
  v_mov_b32 v138, v60
  v_mov_b32 v139, v61
  v_mov_b32 v140, v62
  v_mov_b32 v141, v63
  v_mov_b32 v142, v76
  v_mov_b32 v143, v77
  v_mov_b32 v144, v78
  v_mov_b32 v145, v79
  v_mov_b32 v146, v92
  v_mov_b32 v147, v93
  v_mov_b32 v148, v94
  v_mov_b32 v149, v95
  s_branch L_YW_done
L_YW_3:
L_YW_done:
  s_cmp_ge_u32 0, s72
  s_cselect_b32 s80, 1, 0
  s_cselect_b32 s81, 0, 1
  s_sub_u32 s81, s72, s81
  s_mul_i32 s80, s80, 15360
  s_mul_i32 s81, s81, 5120
  s_add_u32 s80, s80, s81
  s_add_u32 s80, s80, 81920
  v_add_u32 v8, s80, v1
  s_cmp_ge_u32 1, s72
  s_cselect_b32 s80, 2, 1
  s_cselect_b32 s81, 0, 1
  s_sub_u32 s81, s72, s81
  s_mul_i32 s80, s80, 15360
  s_mul_i32 s81, s81, 5120
  s_add_u32 s80, s80, s81
  s_add_u32 s80, s80, 81920
  v_add_u32 v9, s80, v1
  s_cmp_ge_u32 2, s72
  s_cselect_b32 s80, 3, 2
  s_cselect_b32 s81, 0, 1
  s_sub_u32 s81, s72, s81
  s_mul_i32 s80, s80, 15360
  s_mul_i32 s81, s81, 5120
  s_add_u32 s80, s80, s81
  s_add_u32 s80, s80, 81920
  v_add_u32 v10, s80, v1
  s_mul_i32 s80, s72, 5120
  v_add_u32 v11, s80, v1
  v_add_u32 v12, 40960, v11
  s_mov_b32 s28, s66
  s_mov_b32 s29, s67
  s_mov_b32 s30, 5242880
  s_mov_b32 s31, 0x20000
  s_mul_i32 s81, s77, 320
  s_waitcnt lgkmcnt(0)
  s_barrier
  ds_read_b128 v[16:19], v8 offset:0
  ds_read_b128 v[36:39], v9 offset:0
  ds_read_b128 v[56:59], v10 offset:0
  ds_read_b128 v[150:153], v11 offset:0
  ds_read_b128 v[170:173], v11 offset:20480
  ds_read_b128 v[190:193], v12 offset:0
  ds_read_b128 v[210:213], v12 offset:20480
  ds_read_b128 v[20:23], v8 offset:1024
  ds_read_b128 v[40:43], v9 offset:1024
  ds_read_b128 v[60:63], v10 offset:1024
  ds_read_b128 v[154:157], v11 offset:1024
  ds_read_b128 v[174:177], v11 offset:21504
  ds_read_b128 v[194:197], v12 offset:1024
  ds_read_b128 v[214:217], v12 offset:21504
  ds_read_b128 v[24:27], v8 offset:2048
  ds_read_b128 v[44:47], v9 offset:2048
  ds_read_b128 v[64:67], v10 offset:2048
  ds_read_b128 v[158:161], v11 offset:2048
  ds_read_b128 v[178:181], v11 offset:22528
  ds_read_b128 v[198:201], v12 offset:2048
  ds_read_b128 v[218:221], v12 offset:22528
  ds_read_b128 v[28:31], v8 offset:3072
  ds_read_b128 v[48:51], v9 offset:3072
  ds_read_b128 v[68:71], v10 offset:3072
  ds_read_b128 v[162:165], v11 offset:3072
  ds_read_b128 v[182:185], v11 offset:23552
  ds_read_b128 v[202:205], v12 offset:3072
  ds_read_b128 v[222:225], v12 offset:23552
  ds_read_b128 v[32:35], v8 offset:4096
  ds_read_b128 v[52:55], v9 offset:4096
  ds_read_b128 v[72:75], v10 offset:4096
  ds_read_b128 v[166:169], v11 offset:4096
  ds_read_b128 v[186:189], v11 offset:24576
  ds_read_b128 v[206:209], v12 offset:4096
  ds_read_b128 v[226:229], v12 offset:24576
  s_waitcnt lgkmcnt(15)
  v_pk_add_f32 v[16:17], v[16:17], v[36:37]
  v_pk_add_f32 v[130:131], v[130:131], v[56:57]
  v_pk_add_f32 v[150:151], v[150:151], v[170:171]
  v_pk_add_f32 v[190:191], v[190:191], v[210:211]
  v_pk_add_f32 v[18:19], v[18:19], v[38:39]
  v_pk_add_f32 v[132:133], v[132:133], v[58:59]
  v_pk_add_f32 v[152:153], v[152:153], v[172:173]
  v_pk_add_f32 v[192:193], v[192:193], v[212:213]
  v_pk_add_f32 v[36:37], v[130:131], v[16:17]
  v_pk_add_f32 v[170:171], v[150:151], v[190:191]
  v_pk_add_f32 v[38:39], v[132:133], v[18:19]
  v_pk_add_f32 v[172:173], v[152:153], v[192:193]
  v_pk_mul_f32 v[56:57], v[36:37], v[244:245] op_sel:[0,0] op_sel_hi:[1,0]
  v_pk_mul_f32 v[58:59], v[38:39], v[244:245] op_sel:[0,0] op_sel_hi:[1,0]
  v_pk_fma_f32 v[96:97], v[170:171], v[246:247], v[56:57] op_sel:[0,0,0] op_sel_hi:[1,0,1]
  v_pk_fma_f32 v[98:99], v[172:173], v[246:247], v[58:59] op_sel:[0,0,0] op_sel_hi:[1,0,1]
  buffer_store_dwordx4 v[96:99], v248, s[28:31], s81 offen offset:0
  s_waitcnt lgkmcnt(15)
  v_pk_add_f32 v[20:21], v[20:21], v[40:41]
  v_pk_add_f32 v[134:135], v[134:135], v[60:61]
  v_pk_add_f32 v[154:155], v[154:155], v[174:175]
  v_pk_add_f32 v[194:195], v[194:195], v[214:215]
  v_pk_add_f32 v[22:23], v[22:23], v[42:43]
  v_pk_add_f32 v[136:137], v[136:137], v[62:63]
  v_pk_add_f32 v[156:157], v[156:157], v[176:177]
  v_pk_add_f32 v[196:197], v[196:197], v[216:217]
  v_pk_add_f32 v[40:41], v[134:135], v[20:21]
  v_pk_add_f32 v[174:175], v[154:155], v[194:195]
  v_pk_add_f32 v[42:43], v[136:137], v[22:23]
  v_pk_add_f32 v[176:177], v[156:157], v[196:197]
  v_pk_mul_f32 v[60:61], v[40:41], v[244:245] op_sel:[0,0] op_sel_hi:[1,0]
  v_pk_mul_f32 v[62:63], v[42:43], v[244:245] op_sel:[0,0] op_sel_hi:[1,0]
  v_pk_fma_f32 v[100:101], v[174:175], v[246:247], v[60:61] op_sel:[0,0,0] op_sel_hi:[1,0,1]
  v_pk_fma_f32 v[102:103], v[176:177], v[246:247], v[62:63] op_sel:[0,0,0] op_sel_hi:[1,0,1]
  buffer_store_dwordx4 v[100:103], v248, s[28:31], s81 offen offset:64
  s_waitcnt lgkmcnt(14)
  v_pk_add_f32 v[24:25], v[24:25], v[44:45]
  v_pk_add_f32 v[138:139], v[138:139], v[64:65]
  v_pk_add_f32 v[158:159], v[158:159], v[178:179]
  v_pk_add_f32 v[198:199], v[198:199], v[218:219]
  v_pk_add_f32 v[26:27], v[26:27], v[46:47]
  v_pk_add_f32 v[140:141], v[140:141], v[66:67]
  v_pk_add_f32 v[160:161], v[160:161], v[180:181]
  v_pk_add_f32 v[200:201], v[200:201], v[220:221]
  v_pk_add_f32 v[44:45], v[138:139], v[24:25]
  v_pk_add_f32 v[178:179], v[158:159], v[198:199]
  v_pk_add_f32 v[46:47], v[140:141], v[26:27]
  v_pk_add_f32 v[180:181], v[160:161], v[200:201]
  v_pk_mul_f32 v[64:65], v[44:45], v[244:245] op_sel:[0,0] op_sel_hi:[1,0]
  v_pk_mul_f32 v[66:67], v[46:47], v[244:245] op_sel:[0,0] op_sel_hi:[1,0]
  v_pk_fma_f32 v[104:105], v[178:179], v[246:247], v[64:65] op_sel:[0,0,0] op_sel_hi:[1,0,1]
  v_pk_fma_f32 v[106:107], v[180:181], v[246:247], v[66:67] op_sel:[0,0,0] op_sel_hi:[1,0,1]
  buffer_store_dwordx4 v[104:107], v248, s[28:31], s81 offen offset:128
  s_waitcnt lgkmcnt(7)
  v_pk_add_f32 v[28:29], v[28:29], v[48:49]
  v_pk_add_f32 v[142:143], v[142:143], v[68:69]
  v_pk_add_f32 v[162:163], v[162:163], v[182:183]
  v_pk_add_f32 v[202:203], v[202:203], v[222:223]
  v_pk_add_f32 v[30:31], v[30:31], v[50:51]
  v_pk_add_f32 v[144:145], v[144:145], v[70:71]
  v_pk_add_f32 v[164:165], v[164:165], v[184:185]
  v_pk_add_f32 v[204:205], v[204:205], v[224:225]
  v_pk_add_f32 v[48:49], v[142:143], v[28:29]
  v_pk_add_f32 v[182:183], v[162:163], v[202:203]
  v_pk_add_f32 v[50:51], v[144:145], v[30:31]
  v_pk_add_f32 v[184:185], v[164:165], v[204:205]
  v_pk_mul_f32 v[68:69], v[48:49], v[244:245] op_sel:[0,0] op_sel_hi:[1,0]
  v_pk_mul_f32 v[70:71], v[50:51], v[244:245] op_sel:[0,0] op_sel_hi:[1,0]
  v_pk_fma_f32 v[108:109], v[182:183], v[246:247], v[68:69] op_sel:[0,0,0] op_sel_hi:[1,0,1]
  v_pk_fma_f32 v[110:111], v[184:185], v[246:247], v[70:71] op_sel:[0,0,0] op_sel_hi:[1,0,1]
  buffer_store_dwordx4 v[108:111], v248, s[28:31], s81 offen offset:192
  s_waitcnt lgkmcnt(0)
  v_pk_add_f32 v[32:33], v[32:33], v[52:53]
  v_pk_add_f32 v[146:147], v[146:147], v[72:73]
  v_pk_add_f32 v[166:167], v[166:167], v[186:187]
  v_pk_add_f32 v[206:207], v[206:207], v[226:227]
  v_pk_add_f32 v[34:35], v[34:35], v[54:55]
  v_pk_add_f32 v[148:149], v[148:149], v[74:75]
  v_pk_add_f32 v[168:169], v[168:169], v[188:189]
  v_pk_add_f32 v[208:209], v[208:209], v[228:229]
  v_pk_add_f32 v[52:53], v[146:147], v[32:33]
  v_pk_add_f32 v[186:187], v[166:167], v[206:207]
  v_pk_add_f32 v[54:55], v[148:149], v[34:35]
  v_pk_add_f32 v[188:189], v[168:169], v[208:209]
  v_pk_mul_f32 v[72:73], v[52:53], v[244:245] op_sel:[0,0] op_sel_hi:[1,0]
  v_pk_mul_f32 v[74:75], v[54:55], v[244:245] op_sel:[0,0] op_sel_hi:[1,0]
  v_pk_fma_f32 v[112:113], v[186:187], v[246:247], v[72:73] op_sel:[0,0,0] op_sel_hi:[1,0,1]
  v_pk_fma_f32 v[114:115], v[188:189], v[246:247], v[74:75] op_sel:[0,0,0] op_sel_hi:[1,0,1]
  buffer_store_dwordx4 v[112:115], v248, s[28:31], s81 offen offset:256
  s_branch L_END
L_END:
  s_endpgm
L_CODE_END:
.section .rodata,"a"
.p2align 6
.amdhsa_kernel gated_mix__ssm_conv_s5__dense_activation_squared_relu__prompt_kernel
  .amdhsa_next_free_vgpr 256
  .amdhsa_next_free_sgpr 102
  .amdhsa_accum_offset 256
  .amdhsa_group_segment_fixed_size 0
  .amdhsa_kernarg_size 144
  .amdhsa_user_sgpr_count 2
  .amdhsa_user_sgpr_kernarg_segment_ptr 1
  .amdhsa_system_sgpr_workgroup_id_x 1
.end_amdhsa_kernel
```
